```python
import torch

def _softmax(x, axis=-1):
    return torch.softmax(x, dim=axis)
def _gelu(x):
    return torch.nn.functional.gelu(x, approximate="tanh")
def _silu(x):
    return torch.nn.functional.silu(x)
def _sigmoid(x):
    return torch.sigmoid(x)
def _layernorm(x, axis=-1, eps=1e-5):
    m = x.mean(dim=axis, keepdim=True)
    v = x.var(dim=axis, keepdim=True, unbiased=False)
    return (x - m) / torch.sqrt(v + eps)
def _scatter_add(tgt, idx, src, axis=0):
    return tgt.clone().index_add_(axis, idx, src)
def _segment_sum(src, seg, n):
    out = torch.zeros((n,) + src.shape[1:], dtype=src.dtype)
    return out.index_add_(0, seg, src)
def _pad(x, pw):
    flat = tuple(v for pair in reversed(pw) for v in pair)
    return torch.nn.functional.pad(x, flat)

kernel_name = 'recurrent_scan__spectral_gfnet__glu_gated_reglu__prompt'

def setup_inputs():

    _w = (lambda a: (lambda t: t.to(torch.bfloat16) if t.is_floating_point() else t)(torch.as_tensor(a)))
    def _A_setup():
        B, S, D = 1, 2048, 512
        Df = D // 2 + 1
        return {
            "x": _w((lambda *s: torch.randn(*s, dtype=torch.bfloat16) * 0.2)(B, S, D)),
            "w_r": _w((lambda *s: torch.randn(*s, dtype=torch.bfloat16) * 1.6)(S, Df) * 0.02),
            "w_i": _w((lambda *s: torch.randn(*s, dtype=torch.bfloat16) * 1.6)(S, Df) * 0.02),
        }
    _A_in = _A_setup()

    def _B_setup():
        B, S, D, F = 1, 2048, 512, 1792
        return {
            "x": _w((lambda *s: torch.randn(*s, dtype=torch.bfloat16) * 0.2)(B, S, D)),
            "W_gate": _w((lambda *s: torch.randn(*s, dtype=torch.bfloat16) * 0.8)(D, F) * (2.0 / D) ** 0.5),
            "W_up": _w((lambda *s: torch.randn(*s, dtype=torch.bfloat16) * 0.8)(D, F) * (2.0 / D) ** 0.5),
            "W_down": _w((lambda *s: torch.randn(*s, dtype=torch.bfloat16) * 0.8)(F, D) * (1.0 / F) ** 0.5),
        }
    _B_in = _B_setup()

    return {
        "A_x": _A_in["x"],
        "A_w_r": _A_in["w_r"],
        "A_w_i": _A_in["w_i"],
        "B_x": _B_in["x"],
        "B_W_gate": _B_in["W_gate"],
        "B_W_up": _B_in["W_up"],
        "B_W_down": _B_in["W_down"],
    }

def reference(A_x, A_w_r, A_w_i, B_x, B_W_gate, B_W_up, B_W_down):
    def _A_ref(x, w_r, w_i):
        B, S, D = x.shape
        X = (lambda x, axes=(-2,-1): torch.fft.rfft2(x.float(), dim=axes))(x, axes=(-2, -1))
        W = w_r + 1j * w_i
        X = X * W
        y = (lambda x, s, axes=(-2,-1): torch.fft.irfft2(x, s=s, dim=axes).to(torch.bfloat16))(X, (S, D), axes=(-2, -1))
        return y

    def _B_ref(x, W_gate, W_up, W_down):
        gate = torch.einsum("bsd,df->bsf", x, W_gate)
        up = torch.einsum("bsd,df->bsf", x, W_up)
        gate = gate * (lambda x, dt: x.to(dt))(gate > 0, gate.dtype)
        h = gate * up
        return torch.einsum("bsf,fd->bsd", h, W_down)

    x = A_x
    xn = _layernorm(x, axis=-1)
    s = _A_ref(xn, A_w_r, A_w_i)
    g = _silu(_B_ref(xn, B_W_gate, B_W_up, B_W_down))
    return x + s * g
```

```asm
; @launch kernel=recurrent_scan__spectral_gfnet__glu_gated_reglu__prompt_kernel grid=(256,1,1) block=(512,1,1) lds=163840
.amdgcn_target "amdgcn-amd-amdhsa--gfx950"
.text
.globl recurrent_scan__spectral_gfnet__glu_gated_reglu__prompt_kernel
.type recurrent_scan__spectral_gfnet__glu_gated_reglu__prompt_kernel,@function
.p2align 8
recurrent_scan__spectral_gfnet__glu_gated_reglu__prompt_kernel:
k1_kernel:
  s_cmp_ge_u32 s2, 256
  s_cbranch_scc1 k1_end
  s_load_dwordx2 s[4:5], s[0:1], 0
  s_load_dwordx4 s[8:11], s[0:1], 8
  s_load_dwordx4 s[12:15], s[0:1], 32
  s_load_dwordx2 s[6:7], s[0:1], 72
  s_load_dwordx2 s[60:61], s[0:1], 48
  s_load_dwordx2 s[68:69], s[0:1], 64
  s_memrealtime s[70:71]
  v_lshrrev_b32 v1, 6, v0
  v_and_b32 v2, 63, v0
  s_nop 0
  v_readfirstlane_b32 s3, v1

  s_and_b32 s16, s2, 7
  s_lshr_b32 s17, s2, 3
  s_and_b32 s18, s16, 1
  s_lshl_b32 s18, s18, 3
  s_and_b32 s58, s17, 7
  s_add_u32 s18, s18, s58
  s_lshr_b32 s19, s16, 1
  s_lshl_b32 s19, s19, 2
  s_lshr_b32 s20, s17, 3
  s_add_u32 s19, s19, s20
  s_lshl_b32 s59, s20, 2
  s_and_b32 s20, s3, 3
  s_lshr_b32 s21, s3, 2
  s_lshl_b32 s22, s18, 2
  s_add_u32 s22, s22, s20
  v_lshlrev_b32 v9, 4, v2

  s_getpc_b64 s[64:65]
  s_add_u32 s64, s64, k1_kernel@rel32@lo+4
  s_addc_u32 s65, s65, k1_kernel@rel32@hi+12
  s_mov_b32 s66, code_end-k1_kernel
  s_mov_b32 s67, 0x20000
  s_lshl_b32 s57, s17, 1
  s_add_u32 s57, s57, s3
  s_lshl_b32 s57, s57, 10
  s_cmp_lt_u32 s3, 2
  s_cselect_b32 s57, s57, 0x7f000000

  buffer_load_dwordx4 v[12:15], v9, s[64:67], s57 offen
  s_getpc_b64 s[24:25]
  s_add_u32 s24, s24, tab_F@rel32@lo+4
  s_addc_u32 s25, s25, tab_F@rel32@hi+12
  s_mov_b32 s26, 524288
  s_mov_b32 s27, 0x20000
  s_lshl_b32 s50, s21, 4
  s_lshl_b32 s51, s50, 6
  s_add_u32 s51, s51, s22
  s_lshl_b32 s51, s51, 10
  s_lshl_b32 s52, s20, 5
  s_add_u32 s52, s52, s50
  s_lshl_b32 s52, s52, 10
  s_lshl_b32 s53, s58, 3
  v_xor_b32 v3, s53, v2
  s_waitcnt lgkmcnt(0)

  s_mov_b32 s28, s4
  s_mov_b32 s29, s5
  s_mov_b32 s30, 2097152
  s_mov_b32 s31, 0x20000
  s_xor_b32 s54, s59, 0
  v_xor_b32 v4, s54, v3
  v_lshlrev_b32 v4, 4, v4
  s_lshl_b32 s55, s54, 10
  s_add_u32 m0, s52, s55
  s_lshl_b32 s55, s54, 16
  s_add_u32 s53, s51, s55

  buffer_load_dwordx4 v4, s[28:31], s53 offen lds
  s_xor_b32 s54, s59, 1
  v_xor_b32 v4, s54, v3
  v_lshlrev_b32 v4, 4, v4
  s_lshl_b32 s55, s54, 10
  s_add_u32 m0, s52, s55
  s_lshl_b32 s55, s54, 16
  s_add_u32 s53, s51, s55

  buffer_load_dwordx4 v4, s[28:31], s53 offen lds
  s_xor_b32 s54, s59, 2
  v_xor_b32 v4, s54, v3
  v_lshlrev_b32 v4, 4, v4
  s_lshl_b32 s55, s54, 10
  s_add_u32 m0, s52, s55
  s_lshl_b32 s55, s54, 16
  s_add_u32 s53, s51, s55

  buffer_load_dwordx4 v4, s[28:31], s53 offen lds
  s_xor_b32 s54, s59, 3
  v_xor_b32 v4, s54, v3
  v_lshlrev_b32 v4, 4, v4
  s_lshl_b32 s55, s54, 10
  s_add_u32 m0, s52, s55
  s_lshl_b32 s55, s54, 16
  s_add_u32 s53, s51, s55

  buffer_load_dwordx4 v4, s[28:31], s53 offen lds
  s_xor_b32 s54, s59, 4
  v_xor_b32 v4, s54, v3
  v_lshlrev_b32 v4, 4, v4
  s_lshl_b32 s55, s54, 10
  s_add_u32 m0, s52, s55
  s_lshl_b32 s55, s54, 16
  s_add_u32 s53, s51, s55

  buffer_load_dwordx4 v4, s[28:31], s53 offen lds
  s_xor_b32 s54, s59, 5
  v_xor_b32 v4, s54, v3
  v_lshlrev_b32 v4, 4, v4
  s_lshl_b32 s55, s54, 10
  s_add_u32 m0, s52, s55
  s_lshl_b32 s55, s54, 16
  s_add_u32 s53, s51, s55

  buffer_load_dwordx4 v4, s[28:31], s53 offen lds
  s_xor_b32 s54, s59, 6
  v_xor_b32 v4, s54, v3
  v_lshlrev_b32 v4, 4, v4
  s_lshl_b32 s55, s54, 10
  s_add_u32 m0, s52, s55
  s_lshl_b32 s55, s54, 16
  s_add_u32 s53, s51, s55

  buffer_load_dwordx4 v4, s[28:31], s53 offen lds
  s_xor_b32 s54, s59, 7
  v_xor_b32 v4, s54, v3
  v_lshlrev_b32 v4, 4, v4
  s_lshl_b32 s55, s54, 10
  s_add_u32 m0, s52, s55
  s_lshl_b32 s55, s54, 16
  s_add_u32 s53, s51, s55

  buffer_load_dwordx4 v4, s[28:31], s53 offen lds
  s_xor_b32 s54, s59, 8
  v_xor_b32 v4, s54, v3
  v_lshlrev_b32 v4, 4, v4
  s_lshl_b32 s55, s54, 10
  s_add_u32 m0, s52, s55
  s_lshl_b32 s55, s54, 16
  s_add_u32 s53, s51, s55

  buffer_load_dwordx4 v4, s[28:31], s53 offen lds
  s_xor_b32 s54, s59, 9
  v_xor_b32 v4, s54, v3
  v_lshlrev_b32 v4, 4, v4
  s_lshl_b32 s55, s54, 10
  s_add_u32 m0, s52, s55
  s_lshl_b32 s55, s54, 16
  s_add_u32 s53, s51, s55

  buffer_load_dwordx4 v4, s[28:31], s53 offen lds
  s_xor_b32 s54, s59, 10
  v_xor_b32 v4, s54, v3
  v_lshlrev_b32 v4, 4, v4
  s_lshl_b32 s55, s54, 10
  s_add_u32 m0, s52, s55
  s_lshl_b32 s55, s54, 16
  s_add_u32 s53, s51, s55

  buffer_load_dwordx4 v4, s[28:31], s53 offen lds
  s_xor_b32 s54, s59, 11
  v_xor_b32 v4, s54, v3
  v_lshlrev_b32 v4, 4, v4
  s_lshl_b32 s55, s54, 10
  s_add_u32 m0, s52, s55
  s_lshl_b32 s55, s54, 16
  s_add_u32 s53, s51, s55

  buffer_load_dwordx4 v4, s[28:31], s53 offen lds
  s_xor_b32 s54, s59, 12
  v_xor_b32 v4, s54, v3
  v_lshlrev_b32 v4, 4, v4
  s_lshl_b32 s55, s54, 10
  s_add_u32 m0, s52, s55
  s_lshl_b32 s55, s54, 16
  s_add_u32 s53, s51, s55

  buffer_load_dwordx4 v4, s[28:31], s53 offen lds
  s_xor_b32 s54, s59, 13
  v_xor_b32 v4, s54, v3
  v_lshlrev_b32 v4, 4, v4
  s_lshl_b32 s55, s54, 10
  s_add_u32 m0, s52, s55
  s_lshl_b32 s55, s54, 16
  s_add_u32 s53, s51, s55

  buffer_load_dwordx4 v4, s[28:31], s53 offen lds
  s_xor_b32 s54, s59, 14
  v_xor_b32 v4, s54, v3
  v_lshlrev_b32 v4, 4, v4
  s_lshl_b32 s55, s54, 10
  s_add_u32 m0, s52, s55
  s_lshl_b32 s55, s54, 16
  s_add_u32 s53, s51, s55

  buffer_load_dwordx4 v4, s[28:31], s53 offen lds
  s_xor_b32 s54, s59, 15
  v_xor_b32 v4, s54, v3
  v_lshlrev_b32 v4, 4, v4
  s_lshl_b32 s55, s54, 10
  s_add_u32 m0, s52, s55
  s_lshl_b32 s55, s54, 16
  s_add_u32 s53, s51, s55

  buffer_load_dwordx4 v4, s[28:31], s53 offen lds
  s_xor_b32 s54, s3, s58
  s_lshl_b32 s54, s54, 12
  s_lshl_b32 s55, s19, 15
  s_add_u32 s54, s54, s55
  s_lshl_b32 s55, s3, 12
  s_add_u32 m0, s55, 131072
  s_nop 0

  s_mov_b32 s72, s54
  s_mov_b32 s73, m0
  s_mov_b32 s64, s24
  s_mov_b32 s65, s25
  s_mov_b32 s66, 524288
  s_mov_b32 s32, s8
  s_mov_b32 s33, s9
  s_mov_b32 s34, 1052672
  s_mov_b32 s35, 0x20000
  s_mov_b32 s36, s10
  s_mov_b32 s37, s11
  s_mov_b32 s38, 1052672
  s_mov_b32 s39, 0x20000
  s_lshr_b32 s62, s2, 2
  s_lshl_b32 s62, s62, 2
  s_lshr_b32 s63, s3, 1
  s_add_u32 s62, s62, s63
  s_lshr_b32 s63, s62, 4
  s_lshl_b32 s63, s63, 7
  s_and_b32 s62, s62, 15
  s_add_u32 s63, s63, s62
  s_and_b32 s62, s3, 1
  s_lshl_b32 s62, s62, 4
  s_add_u32 s63, s63, s62
  s_mul_i32 s63, s63, 514
  s_and_b32 s62, s2, 3
  s_lshl_b32 s62, s62, 7
  s_add_u32 s63, s63, s62
  v_lshlrev_b32 v5, 1, v2

  buffer_load_ushort v96, v5, s[32:35], s63 offen
  buffer_load_ushort v100, v5, s[36:39], s63 offen
  s_add_u32 s63, s63, 16448
  buffer_load_ushort v97, v5, s[32:35], s63 offen
  buffer_load_ushort v101, v5, s[36:39], s63 offen
  s_add_u32 s63, s63, 16448
  buffer_load_ushort v98, v5, s[32:35], s63 offen
  buffer_load_ushort v102, v5, s[36:39], s63 offen
  s_add_u32 s63, s63, 16448
  buffer_load_ushort v99, v5, s[32:35], s63 offen
  buffer_load_ushort v103, v5, s[36:39], s63 offen
  v_mov_b32 v106, 0x7fffff00
  s_cmp_eq_u32 s3, 7
  s_cbranch_scc0 k1_nosp1
  s_lshr_b32 s62, s2, 4
  s_lshl_b32 s62, s62, 7
  s_and_b32 s63, s2, 15
  s_add_u32 s62, s62, s63
  v_and_b32 v4, 3, v2
  v_lshlrev_b32 v4, 5, v4
  v_and_b32 v5, 4, v2
  v_lshl_add_u32 v4, v5, 2, v4
  v_add_u32 v4, s62, v4
  s_movk_i32 s63, 514
  v_mul_lo_u32 v5, v4, s63
  v_lshrrev_b32 v6, 3, v2
  v_cmp_eq_u32 vcc, 1, v6
  v_add_u32 v30, 512, v5
  s_nop 0
  v_cndmask_b32 v5, v30, v5, vcc
  v_mov_b32 v30, 0x7fffff00
  v_cmp_gt_u32 vcc, 24, v2
  s_nop 1
  v_cndmask_b32 v5, v30, v5, vcc
  buffer_load_ushort v104, v5, s[32:35], 0 offen
  buffer_load_ushort v105, v5, s[36:39], 0 offen
  v_sub_u32 v5, 2048, v4
  v_and_b32 v5, 2047, v5
  v_cmp_eq_u32 s[62:63], 0, v6
  s_nop 1
  v_cndmask_b32 v4, v5, v4, s[62:63]
  v_lshrrev_b32 v5, 7, v4
  v_lshlrev_b32 v5, 9, v5
  v_and_b32 v31, 15, v4
  v_lshl_add_u32 v5, v31, 5, v5
  v_and_b32 v31, 16, v4
  v_add_u32 v5, v5, v31
  v_bfe_u32 v31, v4, 5, 2
  v_lshl_add_u32 v5, v31, 2, v5
  v_lshl_add_u32 v5, v6, 13, v5
  v_add_u32 v5, 14680064, v5
  v_cndmask_b32 v106, v30, v5, vcc
k1_nosp1:

  s_mov_b32 s40, s6
  s_mov_b32 s41, s7
  s_mov_b32 s42, 268435456
  s_mov_b32 s43, 0x20000
  s_getpc_b64 s[32:33]
  s_add_u32 s32, s32, tab_G@rel32@lo+4
  s_addc_u32 s33, s33, tab_G@rel32@hi+12
  s_mov_b32 s34, 583680
  s_lshl_b32 s62, s19, 7
  s_lshl_b32 s63, s21, 6
  s_add_u32 s62, s62, s63
  s_add_u32 s62, s62, 581632
  v_lshrrev_b32 v5, 5, v2
  v_lshlrev_b32 v5, 4, v5

  buffer_load_dwordx4 v[112:115], v5, s[32:35], s62 offen
  buffer_load_dwordx4 v[116:119], v5, s[32:35], s62 offen offset:32
  s_and_b32 s23, s3, 1
  s_cmp_eq_u32 s23, 0
  s_cselect_b32 s44, s12, s14
  s_cselect_b32 s45, s13, s15
  s_mov_b32 s46, 1835008
  s_mov_b32 s47, 0x20000
  s_movk_i32 s48, 3584
  s_mul_i32 s49, s19, 224
  v_lshrrev_b32 v8, 4, v2
  v_and_b32 v6, 15, v2
  v_lshrrev_b32 v6, 1, v6
  v_lshlrev_b32 v10, 1, v8
  v_xor_b32 v6, v6, v10
  v_xor_b32 v6, s23, v6
  v_lshlrev_b32 v6, 5, v6
  v_and_b32 v10, 1, v2
  v_lshlrev_b32 v10, 4, v10
  v_add_u32 v6, v6, v10
  v_mul_lo_u32 v8, v8, s48
  v_add_u32 v6, v6, v8
  v_add_u32 v1, s49, v6
  s_lshr_b32 s50, s3, 1
  s_lshl_b32 s50, s50, 3
  s_mul_i32 s52, s50, s48
  s_lshl_b32 s53, s50, 8
  s_lshl_b32 s54, s23, 13
  s_add_u32 s53, s53, s54
  s_lshl_b32 s54, s48, 2
  s_lshl_b32 s55, s48, 5
  s_lshl_b32 s58, s58, 1
  v_add_u32 v1, s52, v1
  v_add_u32 v4, s54, v1

  v_lshrrev_b32 v10, 4, v2
  v_and_b32 v6, 15, v2
  v_lshrrev_b32 v31, 2, v6
  v_and_b32 v6, 3, v6
  v_lshrrev_b32 v30, 1, v10
  v_lshlrev_b32 v30, 3, v30
  v_add_u32 v30, v30, v31
  v_lshlrev_b32 v30, 8, v30
  v_lshl_add_u32 v30, v6, 3, v30
  v_and_b32 v10, 1, v10
  v_lshl_add_u32 v30, v10, 13, v30
  v_lshlrev_b32 v31, 1, v31
  v_xor_b32 v31, v31, v10
  s_mul_i32 s57, s21, 3

  v_xor_b32 v10, s57, v31
  v_lshl_add_u32 v16, v10, 5, v30
  v_add_u32 v20, 98304, v16
  s_add_u32 s57, s57, 1

  v_xor_b32 v10, s57, v31
  v_lshl_add_u32 v17, v10, 5, v30
  v_add_u32 v21, 98304, v17
  s_add_u32 s57, s57, 1

  v_xor_b32 v10, s57, v31
  v_lshl_add_u32 v18, v10, 5, v30
  v_add_u32 v22, 98304, v18
  s_add_u32 s57, s57, 1

  v_xor_b32 v10, s57, v31
  v_lshl_add_u32 v19, v10, 5, v30
  v_add_u32 v23, 98304, v19
  s_add_u32 s57, s57, 1

  v_and_b32 v10, 31, v2
  v_lshrrev_b32 v6, 5, v2
  v_and_b32 v31, 15, v2
  v_xor_b32 v6, v6, v31
  s_lshl_b32 s57, s20, 15
  v_lshlrev_b32 v10, 10, v10
  v_add_u32 v10, s57, v10

  v_xor_b32 v31, 0, v6
  v_lshl_add_u32 v80, v31, 4, v10
  v_xor_b32 v31, 2, v6
  v_lshl_add_u32 v81, v31, 4, v10
  v_xor_b32 v31, 4, v6
  v_lshl_add_u32 v82, v31, 4, v10
  v_xor_b32 v31, 6, v6
  v_lshl_add_u32 v83, v31, 4, v10
  v_xor_b32 v31, 8, v6
  v_lshl_add_u32 v84, v31, 4, v10
  v_xor_b32 v31, 10, v6
  v_lshl_add_u32 v85, v31, 4, v10
  v_xor_b32 v31, 12, v6
  v_lshl_add_u32 v86, v31, 4, v10
  v_xor_b32 v31, 14, v6
  v_lshl_add_u32 v87, v31, 4, v10
  s_mov_b32 s26, 0x3f803f80
  s_mov_b32 s27, 0xffff0000
  v_mov_b32 v24, 0
  v_mov_b32 v25, 0
  v_mov_b32 v26, 0
  v_mov_b32 v27, 0
  s_lshl_b32 s57, s21, 6
  s_lshl_b32 s62, s21, 14
  s_add_u32 s62, s62, 131072
  v_add_u32 v5, s62, v9

  s_waitcnt vmcnt(10)
  s_barrier
  s_mov_b32 m0, s73
  s_nop 0
  buffer_load_dwordx4 v9, s[64:67], s72 offen offset:0 lds
  buffer_load_dwordx4 v9, s[64:67], s72 offen offset:1024 lds
  buffer_load_dwordx4 v9, s[64:67], s72 offen offset:2048 lds
  buffer_load_dwordx4 v9, s[64:67], s72 offen offset:3072 lds
  ds_read_b128 v[128:131], v80 offset:0
  ds_read_b128 v[132:135], v81 offset:0
  ds_read_b128 v[136:139], v82 offset:0
  ds_read_b128 v[140:143], v83 offset:0
  ds_read_b128 v[144:147], v84 offset:0
  ds_read_b128 v[148:151], v85 offset:0
  ds_read_b128 v[152:155], v86 offset:0
  ds_read_b128 v[156:159], v87 offset:0
  ds_read_b128 v[160:163], v80 offset:256
  ds_read_b128 v[164:167], v81 offset:256
  ds_read_b128 v[168:171], v82 offset:256
  ds_read_b128 v[172:175], v83 offset:256
  ds_read_b128 v[176:179], v84 offset:256
  ds_read_b128 v[180:183], v85 offset:256
  ds_read_b128 v[184:187], v86 offset:256
  ds_read_b128 v[188:191], v87 offset:256
  ds_read_b128 v[192:195], v80 offset:512
  ds_read_b128 v[196:199], v81 offset:512
  ds_read_b128 v[200:203], v82 offset:512
  ds_read_b128 v[204:207], v83 offset:512
  ds_read_b128 v[208:211], v84 offset:512
  ds_read_b128 v[212:215], v85 offset:512
  ds_read_b128 v[216:219], v86 offset:512
  ds_read_b128 v[220:223], v87 offset:512
  ds_read_b128 v[224:227], v80 offset:768
  ds_read_b128 v[228:231], v81 offset:768
  ds_read_b128 v[232:235], v82 offset:768
  ds_read_b128 v[236:239], v83 offset:768
  ds_read_b128 v[240:243], v84 offset:768
  ds_read_b128 v[244:247], v85 offset:768
  ds_read_b128 v[248:251], v86 offset:768
  ds_read_b128 v[252:255], v87 offset:768
  s_waitcnt vmcnt(6)
  v_lshl_or_b32 v108, v100, 16, v96
  v_lshl_or_b32 v109, v101, 16, v97
  v_lshl_or_b32 v110, v102, 16, v98
  v_lshl_or_b32 v111, v103, 16, v99
  s_cmp_eq_u32 s3, 7
  s_cbranch_scc0 k1_nosp2
  v_lshl_or_b32 v104, v105, 16, v104
  buffer_store_dword v104, v106, s[40:43], 0 offen sc1
  v_mov_b32 v30, 0
  v_mov_b32 v31, 0x7fffff00
  v_cmp_eq_u32 vcc, 0, v2
  s_lshl_b32 s51, s2, 4
  s_add_u32 s51, s51, 15728640
  v_cndmask_b32 v31, v31, v30, vcc
  buffer_store_dword v30, v31, s[40:43], s51 offen sc1
  s_add_u32 s51, s51, 8192
  buffer_store_dword v30, v31, s[40:43], s51 offen sc1
  s_add_u32 s51, s51, 8192
  buffer_store_dword v30, v31, s[40:43], s51 offen sc1
  s_cmp_eq_u32 s2, 0
  s_cbranch_scc0 k1_nosp2
  s_or_b32 s70, s70, 1
  v_mov_b32 v31, s70
  s_mov_b64 exec, 1
  global_store_dword v30, v31, s[68:69] sc1
  s_mov_b64 exec, -1
k1_nosp2:

  s_waitcnt lgkmcnt(14)
  s_set_gpr_idx_on s57, gpr_idx(SRC0,SRC1)
  v_dot2_f32_bf16 v24, v128, s26, v24
  v_dot2_f32_bf16 v26, v128, v128, v26
  v_dot2_f32_bf16 v25, v129, s26, v25
  v_dot2_f32_bf16 v27, v129, v129, v27
  v_dot2_f32_bf16 v24, v130, s26, v24
  v_dot2_f32_bf16 v26, v130, v130, v26
  v_dot2_f32_bf16 v25, v131, s26, v25
  v_dot2_f32_bf16 v27, v131, v131, v27
  v_dot2_f32_bf16 v24, v132, s26, v24
  v_dot2_f32_bf16 v26, v132, v132, v26
  v_dot2_f32_bf16 v25, v133, s26, v25
  v_dot2_f32_bf16 v27, v133, v133, v27
  v_dot2_f32_bf16 v24, v134, s26, v24
  v_dot2_f32_bf16 v26, v134, v134, v26
  v_dot2_f32_bf16 v25, v135, s26, v25
  v_dot2_f32_bf16 v27, v135, v135, v27
  s_waitcnt lgkmcnt(12)
  v_dot2_f32_bf16 v24, v136, s26, v24
  v_dot2_f32_bf16 v26, v136, v136, v26
  v_dot2_f32_bf16 v25, v137, s26, v25
  v_dot2_f32_bf16 v27, v137, v137, v27
  v_dot2_f32_bf16 v24, v138, s26, v24
  v_dot2_f32_bf16 v26, v138, v138, v26
  v_dot2_f32_bf16 v25, v139, s26, v25
  v_dot2_f32_bf16 v27, v139, v139, v27
  v_dot2_f32_bf16 v24, v140, s26, v24
  v_dot2_f32_bf16 v26, v140, v140, v26
  v_dot2_f32_bf16 v25, v141, s26, v25
  v_dot2_f32_bf16 v27, v141, v141, v27
  v_dot2_f32_bf16 v24, v142, s26, v24
  v_dot2_f32_bf16 v26, v142, v142, v26
  v_dot2_f32_bf16 v25, v143, s26, v25
  v_dot2_f32_bf16 v27, v143, v143, v27
  s_waitcnt lgkmcnt(10)
  v_dot2_f32_bf16 v24, v144, s26, v24
  v_dot2_f32_bf16 v26, v144, v144, v26
  v_dot2_f32_bf16 v25, v145, s26, v25
  v_dot2_f32_bf16 v27, v145, v145, v27
  v_dot2_f32_bf16 v24, v146, s26, v24
  v_dot2_f32_bf16 v26, v146, v146, v26
  v_dot2_f32_bf16 v25, v147, s26, v25
  v_dot2_f32_bf16 v27, v147, v147, v27
  v_dot2_f32_bf16 v24, v148, s26, v24
  v_dot2_f32_bf16 v26, v148, v148, v26
  v_dot2_f32_bf16 v25, v149, s26, v25
  v_dot2_f32_bf16 v27, v149, v149, v27
  v_dot2_f32_bf16 v24, v150, s26, v24
  v_dot2_f32_bf16 v26, v150, v150, v26
  v_dot2_f32_bf16 v25, v151, s26, v25
  v_dot2_f32_bf16 v27, v151, v151, v27
  s_waitcnt lgkmcnt(8)
  v_dot2_f32_bf16 v24, v152, s26, v24
  v_dot2_f32_bf16 v26, v152, v152, v26
  v_dot2_f32_bf16 v25, v153, s26, v25
  v_dot2_f32_bf16 v27, v153, v153, v27
  v_dot2_f32_bf16 v24, v154, s26, v24
  v_dot2_f32_bf16 v26, v154, v154, v26
  v_dot2_f32_bf16 v25, v155, s26, v25
  v_dot2_f32_bf16 v27, v155, v155, v27
  v_dot2_f32_bf16 v24, v156, s26, v24
  v_dot2_f32_bf16 v26, v156, v156, v26
  v_dot2_f32_bf16 v25, v157, s26, v25
  v_dot2_f32_bf16 v27, v157, v157, v27
  v_dot2_f32_bf16 v24, v158, s26, v24
  v_dot2_f32_bf16 v26, v158, v158, v26
  v_dot2_f32_bf16 v25, v159, s26, v25
  v_dot2_f32_bf16 v27, v159, v159, v27
  s_waitcnt lgkmcnt(6)
  v_dot2_f32_bf16 v24, v160, s26, v24
  v_dot2_f32_bf16 v26, v160, v160, v26
  v_dot2_f32_bf16 v25, v161, s26, v25
  v_dot2_f32_bf16 v27, v161, v161, v27
  v_dot2_f32_bf16 v24, v162, s26, v24
  v_dot2_f32_bf16 v26, v162, v162, v26
  v_dot2_f32_bf16 v25, v163, s26, v25
  v_dot2_f32_bf16 v27, v163, v163, v27
  v_dot2_f32_bf16 v24, v164, s26, v24
  v_dot2_f32_bf16 v26, v164, v164, v26
  v_dot2_f32_bf16 v25, v165, s26, v25
  v_dot2_f32_bf16 v27, v165, v165, v27
  v_dot2_f32_bf16 v24, v166, s26, v24
  v_dot2_f32_bf16 v26, v166, v166, v26
  v_dot2_f32_bf16 v25, v167, s26, v25
  v_dot2_f32_bf16 v27, v167, v167, v27
  s_waitcnt lgkmcnt(4)
  v_dot2_f32_bf16 v24, v168, s26, v24
  v_dot2_f32_bf16 v26, v168, v168, v26
  v_dot2_f32_bf16 v25, v169, s26, v25
  v_dot2_f32_bf16 v27, v169, v169, v27
  v_dot2_f32_bf16 v24, v170, s26, v24
  v_dot2_f32_bf16 v26, v170, v170, v26
  v_dot2_f32_bf16 v25, v171, s26, v25
  v_dot2_f32_bf16 v27, v171, v171, v27
  v_dot2_f32_bf16 v24, v172, s26, v24
  v_dot2_f32_bf16 v26, v172, v172, v26
  v_dot2_f32_bf16 v25, v173, s26, v25
  v_dot2_f32_bf16 v27, v173, v173, v27
  v_dot2_f32_bf16 v24, v174, s26, v24
  v_dot2_f32_bf16 v26, v174, v174, v26
  v_dot2_f32_bf16 v25, v175, s26, v25
  v_dot2_f32_bf16 v27, v175, v175, v27
  s_waitcnt vmcnt(0)
  s_waitcnt lgkmcnt(0)
  s_barrier
  s_set_gpr_idx_off
  s_xor_b32 s56, s58, 0
  s_add_u32 m0, s53, 0
  s_mul_i32 s56, s56, s55
  buffer_load_dwordx4 v1, s[44:47], s56 offen lds
  s_add_u32 m0, s53, 1024
  s_nop 0
  buffer_load_dwordx4 v4, s[44:47], s56 offen lds
  s_xor_b32 s56, s58, 1
  s_add_u32 m0, s53, 16384
  s_mul_i32 s56, s56, s55
  buffer_load_dwordx4 v1, s[44:47], s56 offen lds
  s_add_u32 m0, s53, 17408
  s_nop 0
  buffer_load_dwordx4 v4, s[44:47], s56 offen lds
  ds_read_b128 v[32:35], v5 offset:0
  ds_read_b128 v[36:39], v5 offset:1024
  ds_read_b128 v[40:43], v5 offset:2048
  ds_read_b128 v[44:47], v5 offset:3072
  ds_read_b128 v[48:51], v5 offset:4096
  ds_read_b128 v[52:55], v5 offset:5120
  ds_read_b128 v[56:59], v5 offset:6144
  ds_read_b128 v[60:63], v5 offset:7168
  s_set_gpr_idx_on s57, gpr_idx(SRC0,SRC1)
  v_dot2_f32_bf16 v24, v176, s26, v24
  v_dot2_f32_bf16 v26, v176, v176, v26
  v_dot2_f32_bf16 v25, v177, s26, v25
  v_dot2_f32_bf16 v27, v177, v177, v27
  v_dot2_f32_bf16 v24, v178, s26, v24
  v_dot2_f32_bf16 v26, v178, v178, v26
  v_dot2_f32_bf16 v25, v179, s26, v25
  v_dot2_f32_bf16 v27, v179, v179, v27
  v_dot2_f32_bf16 v24, v180, s26, v24
  v_dot2_f32_bf16 v26, v180, v180, v26
  v_dot2_f32_bf16 v25, v181, s26, v25
  v_dot2_f32_bf16 v27, v181, v181, v27
  v_dot2_f32_bf16 v24, v182, s26, v24
  v_dot2_f32_bf16 v26, v182, v182, v26
  v_dot2_f32_bf16 v25, v183, s26, v25
  v_dot2_f32_bf16 v27, v183, v183, v27
  v_dot2_f32_bf16 v24, v184, s26, v24
  v_dot2_f32_bf16 v26, v184, v184, v26
  v_dot2_f32_bf16 v25, v185, s26, v25
  v_dot2_f32_bf16 v27, v185, v185, v27
  v_dot2_f32_bf16 v24, v186, s26, v24
  v_dot2_f32_bf16 v26, v186, v186, v26
  v_dot2_f32_bf16 v25, v187, s26, v25
  v_dot2_f32_bf16 v27, v187, v187, v27
  v_dot2_f32_bf16 v24, v188, s26, v24
  v_dot2_f32_bf16 v26, v188, v188, v26
  v_dot2_f32_bf16 v25, v189, s26, v25
  v_dot2_f32_bf16 v27, v189, v189, v27
  v_dot2_f32_bf16 v24, v190, s26, v24
  v_dot2_f32_bf16 v26, v190, v190, v26
  v_dot2_f32_bf16 v25, v191, s26, v25
  v_dot2_f32_bf16 v27, v191, v191, v27
  s_set_gpr_idx_off
  s_cmp_eq_u32 s21, 0
  s_cbranch_scc0 k1_mini1
  s_waitcnt lgkmcnt(0)
  v_mfma_f32_32x32x16_bf16 v[64:79], v[32:35], v[128:131], 0
  ds_read_b128 v[32:35], v5 offset:8192
  s_waitcnt lgkmcnt(7)
  v_mfma_f32_32x32x16_bf16 v[64:79], v[36:39], v[132:135], v[64:79]
  ds_read_b128 v[36:39], v5 offset:9216
  s_waitcnt lgkmcnt(7)
  v_mfma_f32_32x32x16_bf16 v[64:79], v[40:43], v[136:139], v[64:79]
  ds_read_b128 v[40:43], v5 offset:10240
  s_waitcnt lgkmcnt(7)
  v_mfma_f32_32x32x16_bf16 v[64:79], v[44:47], v[140:143], v[64:79]
  ds_read_b128 v[44:47], v5 offset:11264
  s_waitcnt lgkmcnt(7)
  v_mfma_f32_32x32x16_bf16 v[64:79], v[48:51], v[144:147], v[64:79]
  ds_read_b128 v[48:51], v5 offset:12288
  s_waitcnt lgkmcnt(7)
  v_mfma_f32_32x32x16_bf16 v[64:79], v[52:55], v[148:151], v[64:79]
  ds_read_b128 v[52:55], v5 offset:13312
  s_waitcnt lgkmcnt(7)
  v_mfma_f32_32x32x16_bf16 v[64:79], v[56:59], v[152:155], v[64:79]
  ds_read_b128 v[56:59], v5 offset:14336
  s_waitcnt lgkmcnt(7)
  v_mfma_f32_32x32x16_bf16 v[64:79], v[60:63], v[156:159], v[64:79]
  ds_read_b128 v[60:63], v5 offset:15360
  s_waitcnt lgkmcnt(7)
  v_mfma_f32_32x32x16_bf16 v[64:79], v[32:35], v[160:163], v[64:79]
  s_waitcnt lgkmcnt(6)
  v_mfma_f32_32x32x16_bf16 v[64:79], v[36:39], v[164:167], v[64:79]
  s_waitcnt lgkmcnt(5)
  v_mfma_f32_32x32x16_bf16 v[64:79], v[40:43], v[168:171], v[64:79]
  s_waitcnt lgkmcnt(4)
  v_mfma_f32_32x32x16_bf16 v[64:79], v[44:47], v[172:175], v[64:79]
  s_waitcnt lgkmcnt(3)
  v_mfma_f32_32x32x16_bf16 v[64:79], v[48:51], v[176:179], v[64:79]
  s_waitcnt lgkmcnt(2)
  v_mfma_f32_32x32x16_bf16 v[64:79], v[52:55], v[180:183], v[64:79]
  s_waitcnt lgkmcnt(1)
  v_mfma_f32_32x32x16_bf16 v[64:79], v[56:59], v[184:187], v[64:79]
  s_waitcnt lgkmcnt(0)
  v_mfma_f32_32x32x16_bf16 v[64:79], v[60:63], v[188:191], v[64:79]
  s_branch k1_minid
k1_mini1:
  s_waitcnt lgkmcnt(0)
  v_mfma_f32_32x32x16_bf16 v[64:79], v[32:35], v[192:195], 0
  ds_read_b128 v[32:35], v5 offset:8192
  s_waitcnt lgkmcnt(7)
  v_mfma_f32_32x32x16_bf16 v[64:79], v[36:39], v[196:199], v[64:79]
  ds_read_b128 v[36:39], v5 offset:9216
  s_waitcnt lgkmcnt(7)
  v_mfma_f32_32x32x16_bf16 v[64:79], v[40:43], v[200:203], v[64:79]
  ds_read_b128 v[40:43], v5 offset:10240
  s_waitcnt lgkmcnt(7)
  v_mfma_f32_32x32x16_bf16 v[64:79], v[44:47], v[204:207], v[64:79]
  ds_read_b128 v[44:47], v5 offset:11264
  s_waitcnt lgkmcnt(7)
  v_mfma_f32_32x32x16_bf16 v[64:79], v[48:51], v[208:211], v[64:79]
  ds_read_b128 v[48:51], v5 offset:12288
  s_waitcnt lgkmcnt(7)
  v_mfma_f32_32x32x16_bf16 v[64:79], v[52:55], v[212:215], v[64:79]
  ds_read_b128 v[52:55], v5 offset:13312
  s_waitcnt lgkmcnt(7)
  v_mfma_f32_32x32x16_bf16 v[64:79], v[56:59], v[216:219], v[64:79]
  ds_read_b128 v[56:59], v5 offset:14336
  s_waitcnt lgkmcnt(7)
  v_mfma_f32_32x32x16_bf16 v[64:79], v[60:63], v[220:223], v[64:79]
  ds_read_b128 v[60:63], v5 offset:15360
  s_waitcnt lgkmcnt(7)
  v_mfma_f32_32x32x16_bf16 v[64:79], v[32:35], v[224:227], v[64:79]
  s_waitcnt lgkmcnt(6)
  v_mfma_f32_32x32x16_bf16 v[64:79], v[36:39], v[228:231], v[64:79]
  s_waitcnt lgkmcnt(5)
  v_mfma_f32_32x32x16_bf16 v[64:79], v[40:43], v[232:235], v[64:79]
  s_waitcnt lgkmcnt(4)
  v_mfma_f32_32x32x16_bf16 v[64:79], v[44:47], v[236:239], v[64:79]
  s_waitcnt lgkmcnt(3)
  v_mfma_f32_32x32x16_bf16 v[64:79], v[48:51], v[240:243], v[64:79]
  s_waitcnt lgkmcnt(2)
  v_mfma_f32_32x32x16_bf16 v[64:79], v[52:55], v[244:247], v[64:79]
  s_waitcnt lgkmcnt(1)
  v_mfma_f32_32x32x16_bf16 v[64:79], v[56:59], v[248:251], v[64:79]
  s_waitcnt lgkmcnt(0)
  v_mfma_f32_32x32x16_bf16 v[64:79], v[60:63], v[252:255], v[64:79]
k1_minid:
  s_xor_b32 s56, s58, 2
  s_add_u32 m0, s53, 32768
  s_mul_i32 s56, s56, s55
  buffer_load_dwordx4 v1, s[44:47], s56 offen lds
  s_add_u32 m0, s53, 33792
  s_nop 0
  buffer_load_dwordx4 v4, s[44:47], s56 offen lds
  s_xor_b32 s56, s58, 3
  s_add_u32 m0, s53, 49152
  s_mul_i32 s56, s56, s55
  buffer_load_dwordx4 v1, s[44:47], s56 offen lds
  s_add_u32 m0, s53, 50176
  s_nop 0
  buffer_load_dwordx4 v4, s[44:47], s56 offen lds
  v_add_f32 v24, v24, v25
  v_add_f32 v25, v26, v27
  v_mov_b32 v26, v24
  v_mov_b32 v27, v25
  s_lshl_b32 s57, s3, 9
  s_add_u32 s57, s57, 69632
  v_lshlrev_b32 v10, 3, v2
  v_permlane32_swap_b32 v24, v26
  v_permlane32_swap_b32 v25, v27
  v_add_u32 v10, s57, v10
  v_add_f32 v24, v24, v26
  v_add_f32 v25, v25, v27
  v_xor_b32 v6, 0x800, v10
  ds_write_b64 v10, v[24:25]
  s_lshl_b32 s57, s3, 2
  s_add_u32 s57, s57, 65536
  v_mov_b32 v11, s57
  v_mov_b32 v10, 0
  ds_write_b32 v11, v10
  v_and_b32 v3, 7, v2
  v_xor_b32 v30, s3, v3
  v_lshlrev_b32 v30, 4, v30
  v_lshl_add_u32 v30, v2, 7, v30
  v_add_u32 v30, 73728, v30
  ds_write_b128 v30, v[108:111]
  v_lshlrev_b32 v3, 2, v3
  v_add_u32 v3, 65536, v3
  s_lshl_b32 s57, s3, 11
  s_add_u32 s57, s57, 81920
  v_add_u32 v30, s57, v9
  v_xor_b32 v31, 0x2000, v30
  s_cmp_eq_u32 s21, 0
  s_cbranch_scc0 k1_px1
  ds_write_b128 v30, v[72:75]
  ds_write_b128 v30, v[76:79] offset:1024
  s_branch k1_pxd
k1_px1:
  ds_write_b128 v30, v[64:67]
  ds_write_b128 v30, v[68:71] offset:1024

  v_mov_b32 v64, v72
  v_mov_b32 v65, v73
  v_mov_b32 v66, v74
  v_mov_b32 v67, v75
  v_mov_b32 v68, v76
  v_mov_b32 v69, v77
  v_mov_b32 v70, v78
  v_mov_b32 v71, v79
k1_pxd:
  s_mov_b32 s28, s60
  s_mov_b32 s29, s61
  s_mov_b32 s30, 1835008
  s_lshr_b32 s50, s2, 3
  s_lshl_b32 s50, s50, 3
  s_add_u32 s50, s50, s3
  s_mul_i32 s62, s50, 7168
  s_mul_i32 s63, s50, 3072
  v_lshrrev_b32 v28, 3, v2
  v_and_b32 v5, 7, v2
  v_xor_b32 v29, v28, v5
  v_lshlrev_b32 v29, 4, v29
  v_lshl_add_u32 v29, v28, 7, v29
  s_lshl_b32 s57, s3, 10
  s_add_u32 s57, s57, 73728
  v_add_u32 v29, s57, v29
  v_lshlrev_b32 v5, 4, v5
  v_lshl_add_u32 v5, v28, 13, v5
  s_and_b32 s57, s2, 3
  s_lshl_b32 s57, s57, 3
  s_add_u32 s57, s57, s3
  s_lshl_b32 s57, s57, 16
  s_lshr_b32 s51, s2, 2
  s_lshl_b32 s51, s51, 7
  s_add_u32 s57, s57, s51
  s_add_u32 s51, s57, 12582912

  s_waitcnt vmcnt(4)
  s_waitcnt lgkmcnt(0)
  s_barrier
  ds_read_b64 v[26:27], v6
  ds_read_b128 v[96:99], v29
  ds_read_b128 v[72:75], v31
  ds_read_b128 v[76:79], v31 offset:1024
  s_waitcnt lgkmcnt(2)
  v_add_f32 v24, v24, v26
  v_add_f32 v25, v25, v27
  v_mul_f32 v24, 0x3b000000, v24
  v_mul_f32 v25, 0x3b000000, v25
  v_fma_f32 v8, -v24, v24, v25
  v_cvt_pk_bf16_f32 v27, v24, v24
  v_lshlrev_b32 v27, 16, v27
  v_sub_f32 v7, 0, v27
  v_mul_f32 v29, v24, v24
  v_mul_f32 v30, 0x43800000, v8
  v_cmp_gt_f32 vcc, v29, v30

  buffer_store_dwordx4 v[96:99], v5, s[40:43], s51 offen sc1
  s_cbranch_vccz k1_fast
  v_mov_b32 v28, 0
  v_mov_b32 v29, 0
  s_mov_b32 s56, 0
k1_slow:
  s_set_gpr_idx_on s56, gpr_idx(SRC1)
  v_lshlrev_b32 v30, 16, v128
  v_and_b32 v31, s27, v128
  s_set_gpr_idx_off
  v_add_f32 v30, v7, v30
  v_add_f32 v31, v7, v31
  v_fma_f32 v28, v30, v30, v28
  v_fma_f32 v29, v31, v31, v29
  s_add_u32 s56, s56, 1
  s_cmp_lt_u32 s56, 128
  s_cbranch_scc1 k1_slow
  v_add_f32 v28, v28, v29
  v_mov_b32 v29, v28
  v_sub_f32 v26, v24, v27
  s_nop 0
  v_permlane32_swap_b32 v28, v29
  v_add_f32 v28, v28, v29
  v_mul_f32 v28, 0x3b000000, v28
  v_fma_f32 v8, -v26, v26, v28
k1_fast:
  v_max_f32 v28, 0, v8
  v_cvt_pk_bf16_f32 v28, v28, v28
  v_lshlrev_b32 v28, 16, v28
  v_add_f32 v28, 0x3727c5ac, v28
  v_cvt_pk_bf16_f32 v28, v28, v28
  v_lshlrev_b32 v28, 16, v28
  v_sqrt_f32 v28, v28
  v_and_b32 v30, 31, v2
  v_cvt_pk_bf16_f32 v28, v28, v28
  v_lshlrev_b32 v28, 16, v28
  v_rcp_f32 v8, v28
  v_lshlrev_b32 v30, 1, v30
  v_lshrrev_b32 v31, 5, v2
  v_lshl_add_u32 v30, v31, 10, v30
  s_lshl_b32 s57, s20, 6
  s_lshl_b32 s56, s21, 12
  s_add_u32 s57, s57, s56
  s_add_u32 s57, s57, 155648
  v_add_u32 v30, s57, v30
  s_waitcnt lgkmcnt(0)

  v_add_f32 v64, v64, v72
  v_add_f32 v65, v65, v73
  v_add_f32 v66, v66, v74
  v_add_f32 v67, v67, v75
  v_add_f32 v68, v68, v76
  v_add_f32 v69, v69, v77
  v_add_f32 v70, v70, v78
  v_add_f32 v71, v71, v79
  v_fma_f32 v64, v7, v112, v64
  v_fma_f32 v65, v7, v113, v65
  v_fma_f32 v66, v7, v114, v66
  v_fma_f32 v67, v7, v115, v67
  v_fma_f32 v68, v7, v116, v68
  v_fma_f32 v69, v7, v117, v69
  v_fma_f32 v70, v7, v118, v70
  v_fma_f32 v71, v7, v119, v71
  v_mul_f32 v64, v8, v64
  v_mul_f32 v65, v8, v65
  v_mul_f32 v66, v8, v66
  v_mul_f32 v67, v8, v67
  v_mul_f32 v68, v8, v68
  v_mul_f32 v69, v8, v69
  v_mul_f32 v70, v8, v70
  v_mul_f32 v71, v8, v71
  v_cvt_f16_f32 v64, v64
  v_cvt_f16_f32 v65, v65
  v_cvt_f16_f32 v66, v66
  v_cvt_f16_f32 v67, v67
  v_cvt_f16_f32 v68, v68
  v_cvt_f16_f32 v69, v69
  v_cvt_f16_f32 v70, v70
  v_cvt_f16_f32 v71, v71
  ds_write_b16 v30, v64 offset:0
  ds_write_b16 v30, v65 offset:256
  ds_write_b16 v30, v66 offset:512
  ds_write_b16 v30, v67 offset:768
  ds_write_b16 v30, v68 offset:2048
  ds_write_b16 v30, v69 offset:2304
  ds_write_b16 v30, v70 offset:2560
  ds_write_b16 v30, v71 offset:2816
  s_lshl_b32 s57, s3, 10
  s_add_u32 s57, s57, 155648
  v_add_u32 v5, s57, v9
  v_lshrrev_b32 v6, 4, v2
  v_lshlrev_b32 v6, 12, v6
  v_and_b32 v31, 15, v2
  v_lshl_add_u32 v6, v31, 4, v6
  s_lshl_b32 s51, s19, 5
  s_lshl_b32 s57, s3, 2
  s_add_u32 s51, s51, s57
  s_lshl_b32 s51, s51, 12
  s_lshl_b32 s57, s18, 8
  s_add_u32 s51, s51, s57
  s_add_u32 s51, s51, 8388608

  s_cmp_eq_u32 s21, 0
  s_cbranch_scc0 k1_ch1

  ds_read_b64_tr_b16 v[32:33], v16 offset:0
  ds_read_b64_tr_b16 v[34:35], v16 offset:1024
  ds_read_b64_tr_b16 v[36:37], v17 offset:0
  ds_read_b64_tr_b16 v[38:39], v17 offset:1024
  ds_read_b64_tr_b16 v[40:41], v18 offset:0
  ds_read_b64_tr_b16 v[42:43], v18 offset:1024
  v_lshlrev_b32 v24, 16, v128
  v_and_b32 v25, s27, v128
  v_lshlrev_b32 v26, 16, v129
  v_and_b32 v27, s27, v129
  v_lshlrev_b32 v28, 16, v130
  v_and_b32 v29, s27, v130
  v_lshlrev_b32 v30, 16, v131
  v_and_b32 v31, s27, v131
  v_add_f32 v24, v7, v24
  v_add_f32 v25, v7, v25
  v_add_f32 v26, v7, v26
  v_add_f32 v27, v7, v27
  v_add_f32 v28, v7, v28
  v_add_f32 v29, v7, v29
  v_add_f32 v30, v7, v30
  v_add_f32 v31, v7, v31
  v_cvt_pk_bf16_f32 v128, v24, v25
  v_cvt_pk_bf16_f32 v129, v26, v27
  v_cvt_pk_bf16_f32 v130, v28, v29
  v_cvt_pk_bf16_f32 v131, v30, v31
  ds_read_b64_tr_b16 v[48:49], v16 offset:4096
  ds_read_b64_tr_b16 v[50:51], v16 offset:5120
  ds_read_b64_tr_b16 v[52:53], v17 offset:4096
  ds_read_b64_tr_b16 v[54:55], v17 offset:5120
  ds_read_b64_tr_b16 v[56:57], v18 offset:4096
  ds_read_b64_tr_b16 v[58:59], v18 offset:5120
  s_waitcnt lgkmcnt(6)
  s_waitcnt vmcnt(3)
  v_mov_b32 v10, 1
  ds_write_b32 v11, v10
  v_mfma_f32_32x32x16_bf16 v[64:79], v[32:35], v[128:131], 0
  v_lshlrev_b32 v24, 16, v132
  v_and_b32 v25, s27, v132
  v_lshlrev_b32 v26, 16, v133
  v_and_b32 v27, s27, v133
  v_lshlrev_b32 v28, 16, v134
  v_and_b32 v29, s27, v134
  v_lshlrev_b32 v30, 16, v135
  s_xor_b32 s56, s58, 4
  s_add_u32 m0, s53, 98304
  s_mul_i32 s56, s56, s55
  buffer_load_dwordx4 v1, s[44:47], s56 offen lds
  v_mfma_f32_32x32x16_bf16 v[80:95], v[36:39], v[128:131], 0
  v_and_b32 v31, s27, v135
  v_add_f32 v24, v7, v24
  v_add_f32 v25, v7, v25
  v_add_f32 v26, v7, v26
  v_add_f32 v27, v7, v27
  v_add_f32 v28, v7, v28
  v_add_f32 v29, v7, v29
  v_mfma_f32_32x32x16_bf16 v[96:111], v[40:43], v[128:131], 0
  v_add_f32 v30, v7, v30
  v_add_f32 v31, v7, v31
  v_cvt_pk_bf16_f32 v132, v24, v25
  v_cvt_pk_bf16_f32 v133, v26, v27
  v_cvt_pk_bf16_f32 v134, v28, v29
  v_cvt_pk_bf16_f32 v135, v30, v31
  s_add_u32 m0, s53, 99328
  s_nop 0
  buffer_load_dwordx4 v4, s[44:47], s56 offen lds
  ds_read_b64_tr_b16 v[32:33], v16 offset:16384
  ds_read_b64_tr_b16 v[34:35], v16 offset:17408
  ds_read_b64_tr_b16 v[36:37], v17 offset:16384
  ds_read_b64_tr_b16 v[38:39], v17 offset:17408
  ds_read_b64_tr_b16 v[40:41], v18 offset:16384
  ds_read_b64_tr_b16 v[42:43], v18 offset:17408
  s_waitcnt lgkmcnt(6)
  v_mfma_f32_32x32x16_bf16 v[64:79], v[48:51], v[132:135], v[64:79]
  v_lshlrev_b32 v24, 16, v136
  v_and_b32 v25, s27, v136
  v_lshlrev_b32 v26, 16, v137
  v_and_b32 v27, s27, v137
  v_lshlrev_b32 v28, 16, v138
  v_and_b32 v29, s27, v138
  v_lshlrev_b32 v30, 16, v139
  s_xor_b32 s56, s58, 5
  s_add_u32 m0, s53, 114688
  s_mul_i32 s56, s56, s55
  buffer_load_dwordx4 v1, s[44:47], s56 offen lds
  v_mfma_f32_32x32x16_bf16 v[80:95], v[52:55], v[132:135], v[80:95]
  v_and_b32 v31, s27, v139
  v_add_f32 v24, v7, v24
  v_add_f32 v25, v7, v25
  v_add_f32 v26, v7, v26
  v_add_f32 v27, v7, v27
  v_add_f32 v28, v7, v28
  v_add_f32 v29, v7, v29
  v_mfma_f32_32x32x16_bf16 v[96:111], v[56:59], v[132:135], v[96:111]
  v_add_f32 v30, v7, v30
  v_add_f32 v31, v7, v31
  v_cvt_pk_bf16_f32 v136, v24, v25
  v_cvt_pk_bf16_f32 v137, v26, v27
  v_cvt_pk_bf16_f32 v138, v28, v29
  v_cvt_pk_bf16_f32 v139, v30, v31
  s_add_u32 m0, s53, 115712
  s_nop 0
  buffer_load_dwordx4 v4, s[44:47], s56 offen lds
  ds_read_b32 v0, v3
  ds_read_b64_tr_b16 v[48:49], v16 offset:20480
  ds_read_b64_tr_b16 v[50:51], v16 offset:21504
  ds_read_b64_tr_b16 v[52:53], v17 offset:20480
  ds_read_b64_tr_b16 v[54:55], v17 offset:21504
  ds_read_b64_tr_b16 v[56:57], v18 offset:20480
  ds_read_b64_tr_b16 v[58:59], v18 offset:21504
  s_waitcnt lgkmcnt(6)
  s_waitcnt vmcnt(5)
  v_mov_b32 v10, 2
  ds_write_b32 v11, v10
  v_mfma_f32_32x32x16_bf16 v[64:79], v[32:35], v[136:139], v[64:79]
  v_lshlrev_b32 v24, 16, v140
  v_and_b32 v25, s27, v140
  v_lshlrev_b32 v26, 16, v141
  v_and_b32 v27, s27, v141
  v_lshlrev_b32 v28, 16, v142
  v_and_b32 v29, s27, v142
  v_lshlrev_b32 v30, 16, v143
  s_xor_b32 s56, s58, 6
  s_add_u32 m0, s53, 131072
  s_mul_i32 s56, s56, s55
  buffer_load_dwordx4 v1, s[44:47], s56 offen lds
  v_mfma_f32_32x32x16_bf16 v[80:95], v[36:39], v[136:139], v[80:95]
  v_and_b32 v31, s27, v143
  v_add_f32 v24, v7, v24
  v_add_f32 v25, v7, v25
  v_add_f32 v26, v7, v26
  v_add_f32 v27, v7, v27
  v_add_f32 v28, v7, v28
  v_add_f32 v29, v7, v29
  v_mfma_f32_32x32x16_bf16 v[96:111], v[40:43], v[136:139], v[96:111]
  v_add_f32 v30, v7, v30
  v_add_f32 v31, v7, v31
  v_cvt_pk_bf16_f32 v140, v24, v25
  v_cvt_pk_bf16_f32 v141, v26, v27
  v_cvt_pk_bf16_f32 v142, v28, v29
  v_cvt_pk_bf16_f32 v143, v30, v31
  s_add_u32 m0, s53, 132096
  s_nop 0
  buffer_load_dwordx4 v4, s[44:47], s56 offen lds
k1_spin0_1:
  v_cmp_gt_u32 vcc, 1, v0
  s_cbranch_vccz k1_ok0_1
  ds_read_b32 v0, v3
  s_waitcnt lgkmcnt(0)
  s_branch k1_spin0_1
k1_ok0_1:

  ds_read_b128 v[12:15], v5
  ds_read_b64_tr_b16 v[32:33], v16 offset:32768
  ds_read_b64_tr_b16 v[34:35], v16 offset:33792
  ds_read_b64_tr_b16 v[36:37], v17 offset:32768
  ds_read_b64_tr_b16 v[38:39], v17 offset:33792
  ds_read_b64_tr_b16 v[40:41], v18 offset:32768
  ds_read_b64_tr_b16 v[42:43], v18 offset:33792
  s_waitcnt lgkmcnt(6)
  v_mfma_f32_32x32x16_bf16 v[64:79], v[48:51], v[140:143], v[64:79]
  v_lshlrev_b32 v24, 16, v144
  v_and_b32 v25, s27, v144
  v_lshlrev_b32 v26, 16, v145
  v_and_b32 v27, s27, v145
  v_lshlrev_b32 v28, 16, v146
  v_and_b32 v29, s27, v146
  v_lshlrev_b32 v30, 16, v147
  v_mfma_f32_32x32x16_bf16 v[80:95], v[52:55], v[140:143], v[80:95]
  v_and_b32 v31, s27, v147
  v_add_f32 v24, v7, v24
  v_add_f32 v25, v7, v25
  v_add_f32 v26, v7, v26
  v_add_f32 v27, v7, v27
  v_add_f32 v28, v7, v28
  v_add_f32 v29, v7, v29
  v_mfma_f32_32x32x16_bf16 v[96:111], v[56:59], v[140:143], v[96:111]
  v_add_f32 v30, v7, v30
  v_add_f32 v31, v7, v31
  v_cvt_pk_bf16_f32 v144, v24, v25
  v_cvt_pk_bf16_f32 v145, v26, v27
  v_cvt_pk_bf16_f32 v146, v28, v29
  v_cvt_pk_bf16_f32 v147, v30, v31
  s_mov_b32 s72, 524288
  s_lshl_b32 s57, s3, 11
  s_add_u32 s73, s57, 565248
  s_add_u32 s24, s57, 573440
  s_lshl_b32 s57, s3, 12
  s_add_u32 s16, s57, 528384
  s_add_u32 s17, s57, 544768
  s_mov_b32 s25, 561152

  ds_read_b32 v0, v3
  ds_read_b64_tr_b16 v[48:49], v16 offset:36864
  ds_read_b64_tr_b16 v[50:51], v16 offset:37888
  ds_read_b64_tr_b16 v[52:53], v17 offset:36864
  ds_read_b64_tr_b16 v[54:55], v17 offset:37888
  ds_read_b64_tr_b16 v[56:57], v18 offset:36864
  ds_read_b64_tr_b16 v[58:59], v18 offset:37888
  s_waitcnt lgkmcnt(6)
  buffer_store_dwordx4 v[12:15], v6, s[40:43], s51 offen sc1
  v_mov_b32 v5, 0
  global_load_dword v5, v5, s[68:69] sc1
  s_waitcnt vmcnt(6)
  v_mov_b32 v10, 3
  ds_write_b32 v11, v10
  v_mfma_f32_32x32x16_bf16 v[64:79], v[32:35], v[144:147], v[64:79]
  v_lshlrev_b32 v24, 16, v148
  v_and_b32 v25, s27, v148
  v_lshlrev_b32 v26, 16, v149
  v_and_b32 v27, s27, v149
  v_lshlrev_b32 v28, 16, v150
  v_and_b32 v29, s27, v150
  v_lshlrev_b32 v30, 16, v151
  v_mfma_f32_32x32x16_bf16 v[80:95], v[36:39], v[144:147], v[80:95]
  v_and_b32 v31, s27, v151
  v_add_f32 v24, v7, v24
  v_add_f32 v25, v7, v25
  v_add_f32 v26, v7, v26
  v_add_f32 v27, v7, v27
  v_add_f32 v28, v7, v28
  v_add_f32 v29, v7, v29
  v_mfma_f32_32x32x16_bf16 v[96:111], v[40:43], v[144:147], v[96:111]
  v_add_f32 v30, v7, v30
  v_add_f32 v31, v7, v31
  v_cvt_pk_bf16_f32 v148, v24, v25
  v_cvt_pk_bf16_f32 v149, v26, v27
  v_cvt_pk_bf16_f32 v150, v28, v29
  v_cvt_pk_bf16_f32 v151, v30, v31
  buffer_load_dwordx4 v[128:131], v9, s[32:35], s72 offen offset:0
k1_spin0_2:
  v_cmp_gt_u32 vcc, 2, v0
  s_cbranch_vccz k1_ok0_2
  ds_read_b32 v0, v3
  s_waitcnt lgkmcnt(0)
  s_branch k1_spin0_2
k1_ok0_2:

  ds_read_b64_tr_b16 v[32:33], v16 offset:49152
  ds_read_b64_tr_b16 v[34:35], v16 offset:50176
  ds_read_b64_tr_b16 v[36:37], v17 offset:49152
  ds_read_b64_tr_b16 v[38:39], v17 offset:50176
  ds_read_b64_tr_b16 v[40:41], v18 offset:49152
  ds_read_b64_tr_b16 v[42:43], v18 offset:50176
  s_waitcnt lgkmcnt(6)
  v_mfma_f32_32x32x16_bf16 v[64:79], v[48:51], v[148:151], v[64:79]
  v_lshlrev_b32 v24, 16, v152
  v_and_b32 v25, s27, v152
  v_lshlrev_b32 v26, 16, v153
  v_and_b32 v27, s27, v153
  v_lshlrev_b32 v28, 16, v154
  v_and_b32 v29, s27, v154
  v_lshlrev_b32 v30, 16, v155
  v_mfma_f32_32x32x16_bf16 v[80:95], v[52:55], v[148:151], v[80:95]
  v_and_b32 v31, s27, v155
  v_add_f32 v24, v7, v24
  v_add_f32 v25, v7, v25
  v_add_f32 v26, v7, v26
  v_add_f32 v27, v7, v27
  v_add_f32 v28, v7, v28
  v_add_f32 v29, v7, v29
  v_mfma_f32_32x32x16_bf16 v[96:111], v[56:59], v[148:151], v[96:111]
  v_add_f32 v30, v7, v30
  v_add_f32 v31, v7, v31
  v_cvt_pk_bf16_f32 v152, v24, v25
  v_cvt_pk_bf16_f32 v153, v26, v27
  v_cvt_pk_bf16_f32 v154, v28, v29
  v_cvt_pk_bf16_f32 v155, v30, v31
  buffer_load_dwordx4 v[132:135], v9, s[32:35], s72 offen offset:1024
  ds_read_b32 v0, v3
  ds_read_b64_tr_b16 v[48:49], v16 offset:53248
  ds_read_b64_tr_b16 v[50:51], v16 offset:54272
  ds_read_b64_tr_b16 v[52:53], v17 offset:53248
  ds_read_b64_tr_b16 v[54:55], v17 offset:54272
  ds_read_b64_tr_b16 v[56:57], v18 offset:53248
  ds_read_b64_tr_b16 v[58:59], v18 offset:54272
  s_waitcnt lgkmcnt(6)
  s_waitcnt vmcnt(6)
  v_mov_b32 v10, 4
  ds_write_b32 v11, v10
  v_mfma_f32_32x32x16_bf16 v[64:79], v[32:35], v[152:155], v[64:79]
  v_lshlrev_b32 v24, 16, v156
  v_and_b32 v25, s27, v156
  v_lshlrev_b32 v26, 16, v157
  v_and_b32 v27, s27, v157
  v_lshlrev_b32 v28, 16, v158
  v_and_b32 v29, s27, v158
  v_lshlrev_b32 v30, 16, v159
  v_mfma_f32_32x32x16_bf16 v[80:95], v[36:39], v[152:155], v[80:95]
  v_and_b32 v31, s27, v159
  v_add_f32 v24, v7, v24
  v_add_f32 v25, v7, v25
  v_add_f32 v26, v7, v26
  v_add_f32 v27, v7, v27
  v_add_f32 v28, v7, v28
  v_add_f32 v29, v7, v29
  v_mfma_f32_32x32x16_bf16 v[96:111], v[40:43], v[152:155], v[96:111]
  v_add_f32 v30, v7, v30
  v_add_f32 v31, v7, v31
  v_cvt_pk_bf16_f32 v156, v24, v25
  v_cvt_pk_bf16_f32 v157, v26, v27
  v_cvt_pk_bf16_f32 v158, v28, v29
  v_cvt_pk_bf16_f32 v159, v30, v31
  buffer_load_dwordx4 v[136:139], v9, s[32:35], s72 offen offset:2048
k1_spin0_3:
  v_cmp_gt_u32 vcc, 3, v0
  s_cbranch_vccz k1_ok0_3
  ds_read_b32 v0, v3
  s_waitcnt lgkmcnt(0)
  s_branch k1_spin0_3
k1_ok0_3:

  ds_read_b64_tr_b16 v[32:33], v20 offset:0
  ds_read_b64_tr_b16 v[34:35], v20 offset:1024
  ds_read_b64_tr_b16 v[36:37], v21 offset:0
  ds_read_b64_tr_b16 v[38:39], v21 offset:1024
  ds_read_b64_tr_b16 v[40:41], v22 offset:0
  ds_read_b64_tr_b16 v[42:43], v22 offset:1024
  s_waitcnt lgkmcnt(6)
  v_mfma_f32_32x32x16_bf16 v[64:79], v[48:51], v[156:159], v[64:79]
  v_lshlrev_b32 v24, 16, v160
  v_and_b32 v25, s27, v160
  v_lshlrev_b32 v26, 16, v161
  v_and_b32 v27, s27, v161
  v_lshlrev_b32 v28, 16, v162
  v_and_b32 v29, s27, v162
  v_lshlrev_b32 v30, 16, v163
  s_xor_b32 s56, s58, 7
  s_add_u32 m0, s53, 147456
  s_mul_i32 s56, s56, s55
  buffer_load_dwordx4 v1, s[44:47], s56 offen lds
  v_mfma_f32_32x32x16_bf16 v[80:95], v[52:55], v[156:159], v[80:95]
  v_and_b32 v31, s27, v163
  v_add_f32 v24, v7, v24
  v_add_f32 v25, v7, v25
  v_add_f32 v26, v7, v26
  v_add_f32 v27, v7, v27
  v_add_f32 v28, v7, v28
  v_add_f32 v29, v7, v29
  v_mfma_f32_32x32x16_bf16 v[96:111], v[56:59], v[156:159], v[96:111]
  v_add_f32 v30, v7, v30
  v_add_f32 v31, v7, v31
  v_cvt_pk_bf16_f32 v160, v24, v25
  v_cvt_pk_bf16_f32 v161, v26, v27
  v_cvt_pk_bf16_f32 v162, v28, v29
  v_cvt_pk_bf16_f32 v163, v30, v31
  s_add_u32 m0, s53, 148480
  s_nop 0
  buffer_load_dwordx4 v4, s[44:47], s56 offen lds
  buffer_load_dwordx4 v[140:143], v9, s[32:35], s72 offen offset:3072
  ds_read_b32 v0, v3
  ds_read_b64_tr_b16 v[48:49], v20 offset:4096
  ds_read_b64_tr_b16 v[50:51], v20 offset:5120
  ds_read_b64_tr_b16 v[52:53], v21 offset:4096
  ds_read_b64_tr_b16 v[54:55], v21 offset:5120
  ds_read_b64_tr_b16 v[56:57], v22 offset:4096
  ds_read_b64_tr_b16 v[58:59], v22 offset:5120
  s_waitcnt lgkmcnt(6)
  s_waitcnt vmcnt(8)
  v_mov_b32 v10, 5
  ds_write_b32 v11, v10
  v_mfma_f32_32x32x16_bf16 v[64:79], v[32:35], v[160:163], v[64:79]
  v_lshlrev_b32 v24, 16, v164
  v_and_b32 v25, s27, v164
  v_lshlrev_b32 v26, 16, v165
  v_and_b32 v27, s27, v165
  v_lshlrev_b32 v28, 16, v166
  v_and_b32 v29, s27, v166
  v_lshlrev_b32 v30, 16, v167
  s_xor_b32 s56, s58, 8
  s_add_u32 m0, s53, 0
  s_mul_i32 s56, s56, s55
  buffer_load_dwordx4 v1, s[44:47], s56 offen lds
  v_mfma_f32_32x32x16_bf16 v[80:95], v[36:39], v[160:163], v[80:95]
  v_and_b32 v31, s27, v167
  v_add_f32 v24, v7, v24
  v_add_f32 v25, v7, v25
  v_add_f32 v26, v7, v26
  v_add_f32 v27, v7, v27
  v_add_f32 v28, v7, v28
  v_add_f32 v29, v7, v29
  v_mfma_f32_32x32x16_bf16 v[96:111], v[40:43], v[160:163], v[96:111]
  v_add_f32 v30, v7, v30
  v_add_f32 v31, v7, v31
  v_cvt_pk_bf16_f32 v164, v24, v25
  v_cvt_pk_bf16_f32 v165, v26, v27
  v_cvt_pk_bf16_f32 v166, v28, v29
  v_cvt_pk_bf16_f32 v167, v30, v31
  s_add_u32 m0, s53, 1024
  s_nop 0
  buffer_load_dwordx4 v4, s[44:47], s56 offen lds
  buffer_load_dwordx4 v[144:147], v9, s[32:35], s73 offen offset:0
k1_spin0_4:
  v_cmp_gt_u32 vcc, 4, v0
  s_cbranch_vccz k1_ok0_4
  ds_read_b32 v0, v3
  s_waitcnt lgkmcnt(0)
  s_branch k1_spin0_4
k1_ok0_4:

  ds_read_b64_tr_b16 v[32:33], v20 offset:16384
  ds_read_b64_tr_b16 v[34:35], v20 offset:17408
  ds_read_b64_tr_b16 v[36:37], v21 offset:16384
  ds_read_b64_tr_b16 v[38:39], v21 offset:17408
  ds_read_b64_tr_b16 v[40:41], v22 offset:16384
  ds_read_b64_tr_b16 v[42:43], v22 offset:17408
  s_waitcnt lgkmcnt(6)
  v_mfma_f32_32x32x16_bf16 v[64:79], v[48:51], v[164:167], v[64:79]
  v_lshlrev_b32 v24, 16, v168
  v_and_b32 v25, s27, v168
  v_lshlrev_b32 v26, 16, v169
  v_and_b32 v27, s27, v169
  v_lshlrev_b32 v28, 16, v170
  v_and_b32 v29, s27, v170
  v_lshlrev_b32 v30, 16, v171
  s_xor_b32 s56, s58, 9
  s_add_u32 m0, s53, 16384
  s_mul_i32 s56, s56, s55
  buffer_load_dwordx4 v1, s[44:47], s56 offen lds
  v_mfma_f32_32x32x16_bf16 v[80:95], v[52:55], v[164:167], v[80:95]
  v_and_b32 v31, s27, v171
  v_add_f32 v24, v7, v24
  v_add_f32 v25, v7, v25
  v_add_f32 v26, v7, v26
  v_add_f32 v27, v7, v27
  v_add_f32 v28, v7, v28
  v_add_f32 v29, v7, v29
  v_mfma_f32_32x32x16_bf16 v[96:111], v[56:59], v[164:167], v[96:111]
  v_add_f32 v30, v7, v30
  v_add_f32 v31, v7, v31
  v_cvt_pk_bf16_f32 v168, v24, v25
  v_cvt_pk_bf16_f32 v169, v26, v27
  v_cvt_pk_bf16_f32 v170, v28, v29
  v_cvt_pk_bf16_f32 v171, v30, v31
  s_add_u32 m0, s53, 17408
  s_nop 0
  buffer_load_dwordx4 v4, s[44:47], s56 offen lds
  buffer_load_dwordx4 v[148:151], v9, s[32:35], s73 offen offset:1024
  ds_read_b32 v0, v3
  ds_read_b64_tr_b16 v[48:49], v20 offset:20480
  ds_read_b64_tr_b16 v[50:51], v20 offset:21504
  ds_read_b64_tr_b16 v[52:53], v21 offset:20480
  ds_read_b64_tr_b16 v[54:55], v21 offset:21504
  ds_read_b64_tr_b16 v[56:57], v22 offset:20480
  ds_read_b64_tr_b16 v[58:59], v22 offset:21504
  s_waitcnt lgkmcnt(6)
  s_waitcnt vmcnt(7)
  v_mov_b32 v10, 6
  ds_write_b32 v11, v10
  v_mfma_f32_32x32x16_bf16 v[64:79], v[32:35], v[168:171], v[64:79]
  v_lshlrev_b32 v24, 16, v172
  v_and_b32 v25, s27, v172
  v_lshlrev_b32 v26, 16, v173
  v_and_b32 v27, s27, v173
  v_lshlrev_b32 v28, 16, v174
  v_and_b32 v29, s27, v174
  v_lshlrev_b32 v30, 16, v175
  s_xor_b32 s56, s58, 10
  s_add_u32 m0, s53, 32768
  s_mul_i32 s56, s56, s55
  buffer_load_dwordx4 v1, s[44:47], s56 offen lds
  v_mfma_f32_32x32x16_bf16 v[80:95], v[36:39], v[168:171], v[80:95]
  v_and_b32 v31, s27, v175
  v_add_f32 v24, v7, v24
  v_add_f32 v25, v7, v25
  v_add_f32 v26, v7, v26
  v_add_f32 v27, v7, v27
  v_add_f32 v28, v7, v28
  v_add_f32 v29, v7, v29
  v_mfma_f32_32x32x16_bf16 v[96:111], v[40:43], v[168:171], v[96:111]
  v_add_f32 v30, v7, v30
  v_add_f32 v31, v7, v31
  v_cvt_pk_bf16_f32 v172, v24, v25
  v_cvt_pk_bf16_f32 v173, v26, v27
  v_cvt_pk_bf16_f32 v174, v28, v29
  v_cvt_pk_bf16_f32 v175, v30, v31
  s_add_u32 m0, s53, 33792
  s_nop 0
  buffer_load_dwordx4 v4, s[44:47], s56 offen lds
  buffer_load_dwordx4 v[152:155], v9, s[32:35], s16 offen offset:0
k1_spin0_5:
  v_cmp_gt_u32 vcc, 5, v0
  s_cbranch_vccz k1_ok0_5
  ds_read_b32 v0, v3
  s_waitcnt lgkmcnt(0)
  s_branch k1_spin0_5
k1_ok0_5:

  ds_read_b64_tr_b16 v[32:33], v20 offset:32768
  ds_read_b64_tr_b16 v[34:35], v20 offset:33792
  ds_read_b64_tr_b16 v[36:37], v21 offset:32768
  ds_read_b64_tr_b16 v[38:39], v21 offset:33792
  ds_read_b64_tr_b16 v[40:41], v22 offset:32768
  ds_read_b64_tr_b16 v[42:43], v22 offset:33792
  s_waitcnt lgkmcnt(6)
  v_mfma_f32_32x32x16_bf16 v[64:79], v[48:51], v[172:175], v[64:79]
  v_lshlrev_b32 v24, 16, v176
  v_and_b32 v25, s27, v176
  v_lshlrev_b32 v26, 16, v177
  v_and_b32 v27, s27, v177
  v_lshlrev_b32 v28, 16, v178
  v_and_b32 v29, s27, v178
  v_lshlrev_b32 v30, 16, v179
  s_xor_b32 s56, s58, 11
  s_add_u32 m0, s53, 49152
  s_mul_i32 s56, s56, s55
  buffer_load_dwordx4 v1, s[44:47], s56 offen lds
  v_mfma_f32_32x32x16_bf16 v[80:95], v[52:55], v[172:175], v[80:95]
  v_and_b32 v31, s27, v179
  v_add_f32 v24, v7, v24
  v_add_f32 v25, v7, v25
  v_add_f32 v26, v7, v26
  v_add_f32 v27, v7, v27
  v_add_f32 v28, v7, v28
  v_add_f32 v29, v7, v29
  v_mfma_f32_32x32x16_bf16 v[96:111], v[56:59], v[172:175], v[96:111]
  v_add_f32 v30, v7, v30
  v_add_f32 v31, v7, v31
  v_cvt_pk_bf16_f32 v176, v24, v25
  v_cvt_pk_bf16_f32 v177, v26, v27
  v_cvt_pk_bf16_f32 v178, v28, v29
  v_cvt_pk_bf16_f32 v179, v30, v31
  s_add_u32 m0, s53, 50176
  s_nop 0
  buffer_load_dwordx4 v4, s[44:47], s56 offen lds
  buffer_load_dwordx4 v[156:159], v9, s[32:35], s16 offen offset:1024
  ds_read_b32 v0, v3
  ds_read_b64_tr_b16 v[48:49], v20 offset:36864
  ds_read_b64_tr_b16 v[50:51], v20 offset:37888
  ds_read_b64_tr_b16 v[52:53], v21 offset:36864
  ds_read_b64_tr_b16 v[54:55], v21 offset:37888
  ds_read_b64_tr_b16 v[56:57], v22 offset:36864
  ds_read_b64_tr_b16 v[58:59], v22 offset:37888
  s_waitcnt lgkmcnt(6)
  s_waitcnt vmcnt(10)
  v_mov_b32 v10, 7
  ds_write_b32 v11, v10
  v_mfma_f32_32x32x16_bf16 v[64:79], v[32:35], v[176:179], v[64:79]
  v_lshlrev_b32 v24, 16, v180
  v_and_b32 v25, s27, v180
  v_lshlrev_b32 v26, 16, v181
  v_and_b32 v27, s27, v181
  v_lshlrev_b32 v28, 16, v182
  v_and_b32 v29, s27, v182
  v_lshlrev_b32 v30, 16, v183
  v_mfma_f32_32x32x16_bf16 v[80:95], v[36:39], v[176:179], v[80:95]
  v_and_b32 v31, s27, v183
  v_add_f32 v24, v7, v24
  v_add_f32 v25, v7, v25
  v_add_f32 v26, v7, v26
  v_add_f32 v27, v7, v27
  v_add_f32 v28, v7, v28
  v_add_f32 v29, v7, v29
  v_mfma_f32_32x32x16_bf16 v[96:111], v[40:43], v[176:179], v[96:111]
  v_add_f32 v30, v7, v30
  v_add_f32 v31, v7, v31
  v_cvt_pk_bf16_f32 v180, v24, v25
  v_cvt_pk_bf16_f32 v181, v26, v27
  v_cvt_pk_bf16_f32 v182, v28, v29
  v_cvt_pk_bf16_f32 v183, v30, v31
  buffer_load_dwordx4 v[160:163], v9, s[32:35], s16 offen offset:2048
k1_spin0_6:
  v_cmp_gt_u32 vcc, 6, v0
  s_cbranch_vccz k1_ok0_6
  ds_read_b32 v0, v3
  s_waitcnt lgkmcnt(0)
  s_branch k1_spin0_6
k1_ok0_6:

  s_mov_b32 s57, 0
k1_nn0:
  v_readfirstlane_b32 s6, v5
  s_cmp_lg_u32 s6, 0
  s_cbranch_scc1 k1_nh0
  s_add_u32 s57, s57, 1
  s_cmp_ge_u32 s57, 0x8000
  s_cbranch_scc1 k1_nh0
  v_mov_b32 v5, 0
  global_load_dword v5, v5, s[68:69] sc1
  s_waitcnt vmcnt(0)
  s_branch k1_nn0
k1_nh0:

  s_cmp_eq_u32 s3, 0
  s_cbranch_scc0 k1_nofy
  s_lshl_b32 s57, s2, 4
  s_add_u32 s57, s57, 15745024
  v_mov_b32 v6, 0
  s_mov_b64 exec, 1
  buffer_store_dword v5, v6, s[40:43], s57 offen sc1
  s_mov_b64 exec, -1
k1_nofy:

  ds_read_b64_tr_b16 v[32:33], v20 offset:49152
  ds_read_b64_tr_b16 v[34:35], v20 offset:50176
  ds_read_b64_tr_b16 v[36:37], v21 offset:49152
  ds_read_b64_tr_b16 v[38:39], v21 offset:50176
  ds_read_b64_tr_b16 v[40:41], v22 offset:49152
  ds_read_b64_tr_b16 v[42:43], v22 offset:50176
  s_waitcnt lgkmcnt(6)
  v_mfma_f32_32x32x16_bf16 v[64:79], v[48:51], v[180:183], v[64:79]
  v_lshlrev_b32 v24, 16, v184
  v_and_b32 v25, s27, v184
  v_lshlrev_b32 v26, 16, v185
  v_and_b32 v27, s27, v185
  v_lshlrev_b32 v28, 16, v186
  v_and_b32 v29, s27, v186
  v_lshlrev_b32 v30, 16, v187
  s_xor_b32 s56, s58, 12
  s_add_u32 m0, s53, 98304
  s_mul_i32 s56, s56, s55
  buffer_load_dwordx4 v1, s[44:47], s56 offen lds
  v_mfma_f32_32x32x16_bf16 v[80:95], v[52:55], v[180:183], v[80:95]
  v_and_b32 v31, s27, v187
  v_add_f32 v24, v7, v24
  v_add_f32 v25, v7, v25
  v_add_f32 v26, v7, v26
  v_add_f32 v27, v7, v27
  v_add_f32 v28, v7, v28
  v_add_f32 v29, v7, v29
  v_mfma_f32_32x32x16_bf16 v[96:111], v[56:59], v[180:183], v[96:111]
  v_add_f32 v30, v7, v30
  v_add_f32 v31, v7, v31
  v_cvt_pk_bf16_f32 v184, v24, v25
  v_cvt_pk_bf16_f32 v185, v26, v27
  v_cvt_pk_bf16_f32 v186, v28, v29
  v_cvt_pk_bf16_f32 v187, v30, v31
  s_add_u32 m0, s53, 99328
  s_nop 0
  buffer_load_dwordx4 v4, s[44:47], s56 offen lds
  buffer_load_dwordx4 v[164:167], v9, s[32:35], s16 offen offset:3072
  ds_read_b32 v0, v3
  ds_read_b64_tr_b16 v[48:49], v20 offset:53248
  ds_read_b64_tr_b16 v[50:51], v20 offset:54272
  ds_read_b64_tr_b16 v[52:53], v21 offset:53248
  ds_read_b64_tr_b16 v[54:55], v21 offset:54272
  ds_read_b64_tr_b16 v[56:57], v22 offset:53248
  ds_read_b64_tr_b16 v[58:59], v22 offset:54272
  s_waitcnt lgkmcnt(6)
  s_waitcnt vmcnt(11)
  v_mov_b32 v10, 8
  ds_write_b32 v11, v10
  v_mfma_f32_32x32x16_bf16 v[64:79], v[32:35], v[184:187], v[64:79]
  v_lshlrev_b32 v24, 16, v188
  v_and_b32 v25, s27, v188
  v_lshlrev_b32 v26, 16, v189
  v_and_b32 v27, s27, v189
  v_lshlrev_b32 v28, 16, v190
  v_and_b32 v29, s27, v190
  v_lshlrev_b32 v30, 16, v191
  v_mfma_f32_32x32x16_bf16 v[80:95], v[36:39], v[184:187], v[80:95]
  v_and_b32 v31, s27, v191
  v_add_f32 v24, v7, v24
  v_add_f32 v25, v7, v25
  v_add_f32 v26, v7, v26
  v_add_f32 v27, v7, v27
  v_add_f32 v28, v7, v28
  v_add_f32 v29, v7, v29
  v_mfma_f32_32x32x16_bf16 v[96:111], v[40:43], v[184:187], v[96:111]
  v_add_f32 v30, v7, v30
  v_add_f32 v31, v7, v31
  v_cvt_pk_bf16_f32 v188, v24, v25
  v_cvt_pk_bf16_f32 v189, v26, v27
  v_cvt_pk_bf16_f32 v190, v28, v29
  v_cvt_pk_bf16_f32 v191, v30, v31
  buffer_load_dwordx4 v[168:171], v9, s[32:35], s17 offen offset:0
k1_spin0_7:
  v_cmp_gt_u32 vcc, 7, v0
  s_cbranch_vccz k1_ok0_7
  ds_read_b32 v0, v3
  s_waitcnt lgkmcnt(0)
  s_branch k1_spin0_7
k1_ok0_7:

  ds_read_b64_tr_b16 v[32:33], v16 offset:0
  ds_read_b64_tr_b16 v[34:35], v16 offset:1024
  ds_read_b64_tr_b16 v[36:37], v17 offset:0
  ds_read_b64_tr_b16 v[38:39], v17 offset:1024
  ds_read_b64_tr_b16 v[40:41], v18 offset:0
  ds_read_b64_tr_b16 v[42:43], v18 offset:1024
  s_waitcnt lgkmcnt(6)
  v_mfma_f32_32x32x16_bf16 v[64:79], v[48:51], v[188:191], v[64:79]
  v_lshlrev_b32 v24, 16, v192
  v_and_b32 v25, s27, v192
  v_lshlrev_b32 v26, 16, v193
  v_and_b32 v27, s27, v193
  v_lshlrev_b32 v28, 16, v194
  v_and_b32 v29, s27, v194
  v_lshlrev_b32 v30, 16, v195
  s_xor_b32 s56, s58, 13
  s_add_u32 m0, s53, 114688
  s_mul_i32 s56, s56, s55
  buffer_load_dwordx4 v1, s[44:47], s56 offen lds
  v_mfma_f32_32x32x16_bf16 v[80:95], v[52:55], v[188:191], v[80:95]
  v_and_b32 v31, s27, v195
  v_add_f32 v24, v7, v24
  v_add_f32 v25, v7, v25
  v_add_f32 v26, v7, v26
  v_add_f32 v27, v7, v27
  v_add_f32 v28, v7, v28
  v_add_f32 v29, v7, v29
  v_mfma_f32_32x32x16_bf16 v[96:111], v[56:59], v[188:191], v[96:111]
  v_add_f32 v30, v7, v30
  v_add_f32 v31, v7, v31
  v_cvt_pk_bf16_f32 v192, v24, v25
  v_cvt_pk_bf16_f32 v193, v26, v27
  v_cvt_pk_bf16_f32 v194, v28, v29
  v_cvt_pk_bf16_f32 v195, v30, v31
  s_add_u32 m0, s53, 115712
  s_nop 0
  buffer_load_dwordx4 v4, s[44:47], s56 offen lds
  buffer_load_dwordx4 v[172:175], v9, s[32:35], s17 offen offset:1024
  ds_read_b32 v0, v3
  ds_read_b64_tr_b16 v[48:49], v16 offset:4096
  ds_read_b64_tr_b16 v[50:51], v16 offset:5120
  ds_read_b64_tr_b16 v[52:53], v17 offset:4096
  ds_read_b64_tr_b16 v[54:55], v17 offset:5120
  ds_read_b64_tr_b16 v[56:57], v18 offset:4096
  ds_read_b64_tr_b16 v[58:59], v18 offset:5120
  s_waitcnt lgkmcnt(6)
  s_waitcnt vmcnt(12)
  v_mov_b32 v10, 9
  ds_write_b32 v11, v10
  v_mfma_f32_32x32x16_bf16 v[64:79], v[32:35], v[192:195], v[64:79]
  v_lshlrev_b32 v24, 16, v196
  v_and_b32 v25, s27, v196
  v_lshlrev_b32 v26, 16, v197
  v_and_b32 v27, s27, v197
  v_lshlrev_b32 v28, 16, v198
  v_and_b32 v29, s27, v198
  v_lshlrev_b32 v30, 16, v199
  v_mfma_f32_32x32x16_bf16 v[80:95], v[36:39], v[192:195], v[80:95]
  v_and_b32 v31, s27, v199
  v_add_f32 v24, v7, v24
  v_add_f32 v25, v7, v25
  v_add_f32 v26, v7, v26
  v_add_f32 v27, v7, v27
  v_add_f32 v28, v7, v28
  v_add_f32 v29, v7, v29
  buffer_load_dwordx4 v[12:15], v9, s[28:31], s62 offen offset:0
  v_mfma_f32_32x32x16_bf16 v[96:111], v[40:43], v[192:195], v[96:111]
  v_add_f32 v30, v7, v30
  v_add_f32 v31, v7, v31
  v_cvt_pk_bf16_f32 v196, v24, v25
  v_cvt_pk_bf16_f32 v197, v26, v27
  v_cvt_pk_bf16_f32 v198, v28, v29
  v_cvt_pk_bf16_f32 v199, v30, v31
  buffer_load_dwordx4 v[176:179], v9, s[32:35], s17 offen offset:2048
k1_spin0_8:
  v_cmp_gt_u32 vcc, 8, v0
  s_cbranch_vccz k1_ok0_8
  ds_read_b32 v0, v3
  s_waitcnt lgkmcnt(0)
  s_branch k1_spin0_8
k1_ok0_8:

  ds_read_b64_tr_b16 v[32:33], v16 offset:16384
  ds_read_b64_tr_b16 v[34:35], v16 offset:17408
  ds_read_b64_tr_b16 v[36:37], v17 offset:16384
  ds_read_b64_tr_b16 v[38:39], v17 offset:17408
  ds_read_b64_tr_b16 v[40:41], v18 offset:16384
  ds_read_b64_tr_b16 v[42:43], v18 offset:17408
  s_waitcnt lgkmcnt(6)
  v_mfma_f32_32x32x16_bf16 v[64:79], v[48:51], v[196:199], v[64:79]
  v_lshlrev_b32 v24, 16, v200
  v_and_b32 v25, s27, v200
  v_lshlrev_b32 v26, 16, v201
  v_and_b32 v27, s27, v201
  v_lshlrev_b32 v28, 16, v202
  v_and_b32 v29, s27, v202
  v_lshlrev_b32 v30, 16, v203
  s_xor_b32 s56, s58, 14
  s_add_u32 m0, s53, 131072
  s_mul_i32 s56, s56, s55
  buffer_load_dwordx4 v1, s[44:47], s56 offen lds
  v_mfma_f32_32x32x16_bf16 v[80:95], v[52:55], v[196:199], v[80:95]
  v_and_b32 v31, s27, v203
  v_add_f32 v24, v7, v24
  v_add_f32 v25, v7, v25
  v_add_f32 v26, v7, v26
  v_add_f32 v27, v7, v27
  v_add_f32 v28, v7, v28
  v_add_f32 v29, v7, v29
  buffer_load_dwordx4 v[12:15], v9, s[28:31], s62 offen offset:1024
  v_mfma_f32_32x32x16_bf16 v[96:111], v[56:59], v[196:199], v[96:111]
  v_add_f32 v30, v7, v30
  v_add_f32 v31, v7, v31
  v_cvt_pk_bf16_f32 v200, v24, v25
  v_cvt_pk_bf16_f32 v201, v26, v27
  v_cvt_pk_bf16_f32 v202, v28, v29
  v_cvt_pk_bf16_f32 v203, v30, v31
  s_add_u32 m0, s53, 132096
  s_nop 0
  buffer_load_dwordx4 v4, s[44:47], s56 offen lds
  buffer_load_dwordx4 v[180:183], v9, s[32:35], s17 offen offset:3072
  ds_read_b32 v0, v3
  ds_read_b64_tr_b16 v[48:49], v16 offset:20480
  ds_read_b64_tr_b16 v[50:51], v16 offset:21504
  ds_read_b64_tr_b16 v[52:53], v17 offset:20480
  ds_read_b64_tr_b16 v[54:55], v17 offset:21504
  ds_read_b64_tr_b16 v[56:57], v18 offset:20480
  ds_read_b64_tr_b16 v[58:59], v18 offset:21504
  s_waitcnt lgkmcnt(6)
  s_waitcnt vmcnt(15)
  v_mov_b32 v10, 10
  ds_write_b32 v11, v10
  v_mfma_f32_32x32x16_bf16 v[64:79], v[32:35], v[200:203], v[64:79]
  v_lshlrev_b32 v24, 16, v204
  v_and_b32 v25, s27, v204
  v_lshlrev_b32 v26, 16, v205
  v_and_b32 v27, s27, v205
  v_lshlrev_b32 v28, 16, v206
  v_and_b32 v29, s27, v206
  v_lshlrev_b32 v30, 16, v207
  v_mfma_f32_32x32x16_bf16 v[80:95], v[36:39], v[200:203], v[80:95]
  v_and_b32 v31, s27, v207
  v_add_f32 v24, v7, v24
  v_add_f32 v25, v7, v25
  v_add_f32 v26, v7, v26
  v_add_f32 v27, v7, v27
  v_add_f32 v28, v7, v28
  v_add_f32 v29, v7, v29
  buffer_load_dwordx4 v[12:15], v9, s[28:31], s62 offen offset:2048
  v_mfma_f32_32x32x16_bf16 v[96:111], v[40:43], v[200:203], v[96:111]
  v_add_f32 v30, v7, v30
  v_add_f32 v31, v7, v31
  v_cvt_pk_bf16_f32 v204, v24, v25
  v_cvt_pk_bf16_f32 v205, v26, v27
  v_cvt_pk_bf16_f32 v206, v28, v29
  v_cvt_pk_bf16_f32 v207, v30, v31
  buffer_load_dwordx4 v[184:187], v9, s[32:35], s24 offen offset:0
k1_spin0_9:
  v_cmp_gt_u32 vcc, 9, v0
  s_cbranch_vccz k1_ok0_9
  ds_read_b32 v0, v3
  s_waitcnt lgkmcnt(0)
  s_branch k1_spin0_9
k1_ok0_9:

  ds_read_b64_tr_b16 v[32:33], v16 offset:32768
  ds_read_b64_tr_b16 v[34:35], v16 offset:33792
  ds_read_b64_tr_b16 v[36:37], v17 offset:32768
  ds_read_b64_tr_b16 v[38:39], v17 offset:33792
  ds_read_b64_tr_b16 v[40:41], v18 offset:32768
  ds_read_b64_tr_b16 v[42:43], v18 offset:33792
  s_waitcnt lgkmcnt(6)
  v_mfma_f32_32x32x16_bf16 v[64:79], v[48:51], v[204:207], v[64:79]
  v_lshlrev_b32 v24, 16, v208
  v_and_b32 v25, s27, v208
  v_lshlrev_b32 v26, 16, v209
  v_and_b32 v27, s27, v209
  v_lshlrev_b32 v28, 16, v210
  v_and_b32 v29, s27, v210
  v_lshlrev_b32 v30, 16, v211
  s_xor_b32 s56, s58, 15
  s_add_u32 m0, s53, 147456
  s_mul_i32 s56, s56, s55
  buffer_load_dwordx4 v1, s[44:47], s56 offen lds
  v_mfma_f32_32x32x16_bf16 v[80:95], v[52:55], v[204:207], v[80:95]
  v_and_b32 v31, s27, v211
  v_add_f32 v24, v7, v24
  v_add_f32 v25, v7, v25
  v_add_f32 v26, v7, v26
  v_add_f32 v27, v7, v27
  v_add_f32 v28, v7, v28
  v_add_f32 v29, v7, v29
  buffer_load_dwordx4 v[12:15], v9, s[28:31], s62 offen offset:3072
  s_add_u32 s62, s62, 4096
  v_mfma_f32_32x32x16_bf16 v[96:111], v[56:59], v[204:207], v[96:111]
  v_add_f32 v30, v7, v30
  v_add_f32 v31, v7, v31
  v_cvt_pk_bf16_f32 v208, v24, v25
  v_cvt_pk_bf16_f32 v209, v26, v27
  v_cvt_pk_bf16_f32 v210, v28, v29
  v_cvt_pk_bf16_f32 v211, v30, v31
  s_add_u32 m0, s53, 148480
  s_nop 0
  buffer_load_dwordx4 v4, s[44:47], s56 offen lds
  buffer_load_dwordx4 v[188:191], v9, s[32:35], s24 offen offset:1024
  ds_read_b32 v0, v3
  ds_read_b64_tr_b16 v[48:49], v16 offset:36864
  ds_read_b64_tr_b16 v[50:51], v16 offset:37888
  ds_read_b64_tr_b16 v[52:53], v17 offset:36864
  ds_read_b64_tr_b16 v[54:55], v17 offset:37888
  ds_read_b64_tr_b16 v[56:57], v18 offset:36864
  ds_read_b64_tr_b16 v[58:59], v18 offset:37888
  s_waitcnt lgkmcnt(6)
  s_waitcnt vmcnt(17)
  v_mov_b32 v10, 11
  ds_write_b32 v11, v10
  v_mfma_f32_32x32x16_bf16 v[64:79], v[32:35], v[208:211], v[64:79]
  v_lshlrev_b32 v24, 16, v212
  v_and_b32 v25, s27, v212
  v_lshlrev_b32 v26, 16, v213
  v_and_b32 v27, s27, v213
  v_lshlrev_b32 v28, 16, v214
  v_and_b32 v29, s27, v214
  v_lshlrev_b32 v30, 16, v215
  v_mfma_f32_32x32x16_bf16 v[80:95], v[36:39], v[208:211], v[80:95]
  v_and_b32 v31, s27, v215
  v_add_f32 v24, v7, v24
  v_add_f32 v25, v7, v25
  v_add_f32 v26, v7, v26
  v_add_f32 v27, v7, v27
  v_add_f32 v28, v7, v28
  v_add_f32 v29, v7, v29
  buffer_load_dwordx4 v[12:15], v9, s[28:31], s62 offen offset:0
  v_mfma_f32_32x32x16_bf16 v[96:111], v[40:43], v[208:211], v[96:111]
  v_add_f32 v30, v7, v30
  v_add_f32 v31, v7, v31
  v_cvt_pk_bf16_f32 v212, v24, v25
  v_cvt_pk_bf16_f32 v213, v26, v27
  v_cvt_pk_bf16_f32 v214, v28, v29
  v_cvt_pk_bf16_f32 v215, v30, v31
  buffer_load_dwordx4 v[192:195], v9, s[32:35], s25 offen offset:0
k1_spin0_10:
  v_cmp_gt_u32 vcc, 10, v0
  s_cbranch_vccz k1_ok0_10
  ds_read_b32 v0, v3
  s_waitcnt lgkmcnt(0)
  s_branch k1_spin0_10
k1_ok0_10:

  ds_read_b64_tr_b16 v[32:33], v16 offset:49152
  ds_read_b64_tr_b16 v[34:35], v16 offset:50176
  ds_read_b64_tr_b16 v[36:37], v17 offset:49152
  ds_read_b64_tr_b16 v[38:39], v17 offset:50176
  ds_read_b64_tr_b16 v[40:41], v18 offset:49152
  ds_read_b64_tr_b16 v[42:43], v18 offset:50176
  s_waitcnt lgkmcnt(6)
  v_mfma_f32_32x32x16_bf16 v[64:79], v[48:51], v[212:215], v[64:79]
  v_lshlrev_b32 v24, 16, v216
  v_and_b32 v25, s27, v216
  v_lshlrev_b32 v26, 16, v217
  v_and_b32 v27, s27, v217
  v_lshlrev_b32 v28, 16, v218
  v_and_b32 v29, s27, v218
  v_lshlrev_b32 v30, 16, v219
  v_mfma_f32_32x32x16_bf16 v[80:95], v[52:55], v[212:215], v[80:95]
  v_and_b32 v31, s27, v219
  v_add_f32 v24, v7, v24
  v_add_f32 v25, v7, v25
  v_add_f32 v26, v7, v26
  v_add_f32 v27, v7, v27
  v_add_f32 v28, v7, v28
  v_add_f32 v29, v7, v29
  buffer_load_dwordx4 v[12:15], v9, s[28:31], s62 offen offset:1024
  v_mfma_f32_32x32x16_bf16 v[96:111], v[56:59], v[212:215], v[96:111]
  v_add_f32 v30, v7, v30
  v_add_f32 v31, v7, v31
  v_cvt_pk_bf16_f32 v216, v24, v25
  v_cvt_pk_bf16_f32 v217, v26, v27
  v_cvt_pk_bf16_f32 v218, v28, v29
  v_cvt_pk_bf16_f32 v219, v30, v31
  buffer_load_dwordx4 v[196:199], v9, s[32:35], s25 offen offset:1024
  s_mov_b32 s57, 15745024
  buffer_load_dword v112, v9, s[40:43], s57 offen offset:0 sc1
  buffer_load_dword v113, v9, s[40:43], s57 offen offset:1024 sc1
  buffer_load_dword v114, v9, s[40:43], s57 offen offset:2048 sc1
  buffer_load_dword v115, v9, s[40:43], s57 offen offset:3072 sc1
  v_and_b32 v116, 15, v2
  v_lshlrev_b32 v116, 6, v116
  v_lshrrev_b32 v117, 4, v2
  v_lshl_add_u32 v116, v117, 4, v116
  v_lshlrev_b32 v117, 5, v2
  s_lshl_b32 s72, s2, 13
  s_lshl_b32 s73, s3, 10
  s_add_u32 s16, s72, s73
  s_add_u32 s16, s16, 8388608
  s_add_u32 s17, s16, 4096
  s_lshl_b32 s73, s3, 11
  s_add_u32 s72, s72, s73
  s_add_u32 s72, s72, 12582912
  s_add_u32 s73, s73, 14680064

  ds_read_b32 v0, v3
  ds_read_b64_tr_b16 v[48:49], v16 offset:53248
  ds_read_b64_tr_b16 v[50:51], v16 offset:54272
  ds_read_b64_tr_b16 v[52:53], v17 offset:53248
  ds_read_b64_tr_b16 v[54:55], v17 offset:54272
  ds_read_b64_tr_b16 v[56:57], v18 offset:53248
  ds_read_b64_tr_b16 v[58:59], v18 offset:54272
  s_waitcnt lgkmcnt(6)
  s_waitcnt vmcnt(21)
  v_mov_b32 v10, 12
  ds_write_b32 v11, v10
  v_mfma_f32_32x32x16_bf16 v[64:79], v[32:35], v[216:219], v[64:79]
  v_lshlrev_b32 v24, 16, v220
  v_and_b32 v25, s27, v220
  v_lshlrev_b32 v26, 16, v221
  v_and_b32 v27, s27, v221
  v_lshlrev_b32 v28, 16, v222
  v_and_b32 v29, s27, v222
  v_lshlrev_b32 v30, 16, v223
  v_mfma_f32_32x32x16_bf16 v[80:95], v[36:39], v[216:219], v[80:95]
  v_and_b32 v31, s27, v223
  v_add_f32 v24, v7, v24
  v_add_f32 v25, v7, v25
  v_add_f32 v26, v7, v26
  v_add_f32 v27, v7, v27
  v_add_f32 v28, v7, v28
  v_add_f32 v29, v7, v29
  buffer_load_dwordx4 v[12:15], v9, s[28:31], s62 offen offset:2048
  v_mfma_f32_32x32x16_bf16 v[96:111], v[40:43], v[216:219], v[96:111]
  v_add_f32 v30, v7, v30
  v_add_f32 v31, v7, v31
  v_cvt_pk_bf16_f32 v220, v24, v25
  v_cvt_pk_bf16_f32 v221, v26, v27
  v_cvt_pk_bf16_f32 v222, v28, v29
  v_cvt_pk_bf16_f32 v223, v30, v31
  buffer_load_dwordx4 v[200:203], v9, s[32:35], s25 offen offset:2048
k1_spin0_11:
  v_cmp_gt_u32 vcc, 11, v0
  s_cbranch_vccz k1_ok0_11
  ds_read_b32 v0, v3
  s_waitcnt lgkmcnt(0)
  s_branch k1_spin0_11
k1_ok0_11:

  ds_read_b64_tr_b16 v[32:33], v20 offset:0
  ds_read_b64_tr_b16 v[34:35], v20 offset:1024
  ds_read_b64_tr_b16 v[36:37], v21 offset:0
  ds_read_b64_tr_b16 v[38:39], v21 offset:1024
  ds_read_b64_tr_b16 v[40:41], v22 offset:0
  ds_read_b64_tr_b16 v[42:43], v22 offset:1024
  s_waitcnt lgkmcnt(6)
  v_mfma_f32_32x32x16_bf16 v[64:79], v[48:51], v[220:223], v[64:79]
  v_lshlrev_b32 v24, 16, v224
  v_and_b32 v25, s27, v224
  v_lshlrev_b32 v26, 16, v225
  v_and_b32 v27, s27, v225
  v_lshlrev_b32 v28, 16, v226
  v_and_b32 v29, s27, v226
  v_lshlrev_b32 v30, 16, v227
  v_mfma_f32_32x32x16_bf16 v[80:95], v[52:55], v[220:223], v[80:95]
  v_and_b32 v31, s27, v227
  v_add_f32 v24, v7, v24
  v_add_f32 v25, v7, v25
  v_add_f32 v26, v7, v26
  v_add_f32 v27, v7, v27
  v_add_f32 v28, v7, v28
  v_add_f32 v29, v7, v29
  buffer_load_dwordx4 v[12:15], v9, s[32:35], s63 offen offset:0
  v_mfma_f32_32x32x16_bf16 v[96:111], v[56:59], v[220:223], v[96:111]
  v_add_f32 v30, v7, v30
  v_add_f32 v31, v7, v31
  v_cvt_pk_bf16_f32 v224, v24, v25
  v_cvt_pk_bf16_f32 v225, v26, v27
  v_cvt_pk_bf16_f32 v226, v28, v29
  v_cvt_pk_bf16_f32 v227, v30, v31
  buffer_load_dwordx4 v[204:207], v9, s[32:35], s25 offen offset:3072
  ds_read_b32 v0, v3
  ds_read_b64_tr_b16 v[48:49], v20 offset:4096
  ds_read_b64_tr_b16 v[50:51], v20 offset:5120
  ds_read_b64_tr_b16 v[52:53], v21 offset:4096
  ds_read_b64_tr_b16 v[54:55], v21 offset:5120
  ds_read_b64_tr_b16 v[56:57], v22 offset:4096
  ds_read_b64_tr_b16 v[58:59], v22 offset:5120
  s_waitcnt lgkmcnt(6)
  s_waitcnt vmcnt(19)
  v_mov_b32 v10, 13
  ds_write_b32 v11, v10
  v_mfma_f32_32x32x16_bf16 v[64:79], v[32:35], v[224:227], v[64:79]
  v_lshlrev_b32 v24, 16, v228
  v_and_b32 v25, s27, v228
  v_lshlrev_b32 v26, 16, v229
  v_and_b32 v27, s27, v229
  v_lshlrev_b32 v28, 16, v230
  v_and_b32 v29, s27, v230
  v_lshlrev_b32 v30, 16, v231
  v_mfma_f32_32x32x16_bf16 v[80:95], v[36:39], v[224:227], v[80:95]
  v_and_b32 v31, s27, v231
  v_add_f32 v24, v7, v24
  v_add_f32 v25, v7, v25
  v_add_f32 v26, v7, v26
  v_add_f32 v27, v7, v27
  v_add_f32 v28, v7, v28
  v_add_f32 v29, v7, v29
  buffer_load_dwordx4 v[12:15], v9, s[32:35], s63 offen offset:1024
  v_mfma_f32_32x32x16_bf16 v[96:111], v[40:43], v[224:227], v[96:111]
  v_add_f32 v30, v7, v30
  v_add_f32 v31, v7, v31
  v_cvt_pk_bf16_f32 v228, v24, v25
  v_cvt_pk_bf16_f32 v229, v26, v27
  v_cvt_pk_bf16_f32 v230, v28, v29
  v_cvt_pk_bf16_f32 v231, v30, v31
k1_spin0_12:
  v_cmp_gt_u32 vcc, 12, v0
  s_cbranch_vccz k1_ok0_12
  ds_read_b32 v0, v3
  s_waitcnt lgkmcnt(0)
  s_branch k1_spin0_12
k1_ok0_12:

  ds_read_b64_tr_b16 v[32:33], v20 offset:16384
  ds_read_b64_tr_b16 v[34:35], v20 offset:17408
  ds_read_b64_tr_b16 v[36:37], v21 offset:16384
  ds_read_b64_tr_b16 v[38:39], v21 offset:17408
  ds_read_b64_tr_b16 v[40:41], v22 offset:16384
  ds_read_b64_tr_b16 v[42:43], v22 offset:17408
  s_waitcnt lgkmcnt(6)
  v_mfma_f32_32x32x16_bf16 v[64:79], v[48:51], v[228:231], v[64:79]
  v_lshlrev_b32 v24, 16, v232
  v_and_b32 v25, s27, v232
  v_lshlrev_b32 v26, 16, v233
  v_and_b32 v27, s27, v233
  v_lshlrev_b32 v28, 16, v234
  v_and_b32 v29, s27, v234
  v_lshlrev_b32 v30, 16, v235
  v_mfma_f32_32x32x16_bf16 v[80:95], v[52:55], v[228:231], v[80:95]
  v_and_b32 v31, s27, v235
  v_add_f32 v24, v7, v24
  v_add_f32 v25, v7, v25
  v_add_f32 v26, v7, v26
  v_add_f32 v27, v7, v27
  v_add_f32 v28, v7, v28
  v_add_f32 v29, v7, v29
  buffer_load_dwordx4 v[12:15], v9, s[32:35], s63 offen offset:2048
  v_mfma_f32_32x32x16_bf16 v[96:111], v[56:59], v[228:231], v[96:111]
  v_add_f32 v30, v7, v30
  v_add_f32 v31, v7, v31
  v_cvt_pk_bf16_f32 v232, v24, v25
  v_cvt_pk_bf16_f32 v233, v26, v27
  v_cvt_pk_bf16_f32 v234, v28, v29
  v_cvt_pk_bf16_f32 v235, v30, v31
  s_waitcnt vmcnt(6)
  s_mov_b32 s56, 0
  s_mov_b32 s57, 15745024
k1_fys:
  v_xor_b32 v112, s6, v112
  v_xor_b32 v113, s6, v113
  v_xor_b32 v114, s6, v114
  v_xor_b32 v115, s6, v115
  v_or3_b32 v112, v112, v113, v114
  v_or_b32 v112, v112, v115
  v_cmp_ne_u32 vcc, 0, v112
  s_cbranch_vccz k1_fyok
  s_add_u32 s56, s56, 1
  s_cmp_ge_u32 s56, 0x4000
  s_cbranch_scc1 k1_fyok
  s_sleep 16
  buffer_load_dword v112, v9, s[40:43], s57 offen sc1
  buffer_load_dword v113, v9, s[40:43], s57 offen offset:1024 sc1
  buffer_load_dword v114, v9, s[40:43], s57 offen offset:2048 sc1
  buffer_load_dword v115, v9, s[40:43], s57 offen offset:3072 sc1
  s_waitcnt vmcnt(0)
  s_branch k1_fys
k1_fyok:

  buffer_load_dwordx4 v[208:211], v116, s[40:43], s16 offen sc1
  buffer_load_dwordx4 v[212:215], v116, s[40:43], s17 offen sc1
  ds_read_b32 v0, v3
  ds_read_b64_tr_b16 v[48:49], v20 offset:20480
  ds_read_b64_tr_b16 v[50:51], v20 offset:21504
  ds_read_b64_tr_b16 v[52:53], v21 offset:20480
  ds_read_b64_tr_b16 v[54:55], v21 offset:21504
  ds_read_b64_tr_b16 v[56:57], v22 offset:20480
  ds_read_b64_tr_b16 v[58:59], v22 offset:21504
  s_waitcnt lgkmcnt(6)
  v_mov_b32 v10, 14
  ds_write_b32 v11, v10
  v_mfma_f32_32x32x16_bf16 v[64:79], v[32:35], v[232:235], v[64:79]
  v_lshlrev_b32 v24, 16, v236
  v_and_b32 v25, s27, v236
  v_lshlrev_b32 v26, 16, v237
  v_and_b32 v27, s27, v237
  v_lshlrev_b32 v28, 16, v238
  v_and_b32 v29, s27, v238
  v_lshlrev_b32 v30, 16, v239
  v_mfma_f32_32x32x16_bf16 v[80:95], v[36:39], v[232:235], v[80:95]
  v_and_b32 v31, s27, v239
  v_add_f32 v24, v7, v24
  v_add_f32 v25, v7, v25
  v_add_f32 v26, v7, v26
  v_add_f32 v27, v7, v27
  v_add_f32 v28, v7, v28
  v_add_f32 v29, v7, v29
  v_mfma_f32_32x32x16_bf16 v[96:111], v[40:43], v[232:235], v[96:111]
  v_add_f32 v30, v7, v30
  v_add_f32 v31, v7, v31
  v_cvt_pk_bf16_f32 v236, v24, v25
  v_cvt_pk_bf16_f32 v237, v26, v27
  v_cvt_pk_bf16_f32 v238, v28, v29
  v_cvt_pk_bf16_f32 v239, v30, v31
  buffer_load_dwordx4 v[216:219], v117, s[40:43], s72 offen sc1
  buffer_load_dwordx4 v[220:223], v117, s[40:43], s72 offen offset:16 sc1
k1_spin0_13:
  v_cmp_gt_u32 vcc, 13, v0
  s_cbranch_vccz k1_ok0_13
  ds_read_b32 v0, v3
  s_waitcnt lgkmcnt(0)
  s_branch k1_spin0_13
k1_ok0_13:

  ds_read_b64_tr_b16 v[32:33], v20 offset:32768
  ds_read_b64_tr_b16 v[34:35], v20 offset:33792
  ds_read_b64_tr_b16 v[36:37], v21 offset:32768
  ds_read_b64_tr_b16 v[38:39], v21 offset:33792
  ds_read_b64_tr_b16 v[40:41], v22 offset:32768
  ds_read_b64_tr_b16 v[42:43], v22 offset:33792
  s_waitcnt lgkmcnt(6)
  v_mfma_f32_32x32x16_bf16 v[64:79], v[48:51], v[236:239], v[64:79]
  v_lshlrev_b32 v24, 16, v240
  v_and_b32 v25, s27, v240
  v_lshlrev_b32 v26, 16, v241
  v_and_b32 v27, s27, v241
  v_lshlrev_b32 v28, 16, v242
  v_and_b32 v29, s27, v242
  v_lshlrev_b32 v30, 16, v243
  v_mfma_f32_32x32x16_bf16 v[80:95], v[52:55], v[236:239], v[80:95]
  v_and_b32 v31, s27, v243
  v_add_f32 v24, v7, v24
  v_add_f32 v25, v7, v25
  v_add_f32 v26, v7, v26
  v_add_f32 v27, v7, v27
  v_add_f32 v28, v7, v28
  v_add_f32 v29, v7, v29
  v_mfma_f32_32x32x16_bf16 v[96:111], v[56:59], v[236:239], v[96:111]
  v_add_f32 v30, v7, v30
  v_add_f32 v31, v7, v31
  v_cvt_pk_bf16_f32 v240, v24, v25
  v_cvt_pk_bf16_f32 v241, v26, v27
  v_cvt_pk_bf16_f32 v242, v28, v29
  v_cvt_pk_bf16_f32 v243, v30, v31
  ds_read_b32 v0, v3
  ds_read_b64_tr_b16 v[48:49], v20 offset:36864
  ds_read_b64_tr_b16 v[50:51], v20 offset:37888
  ds_read_b64_tr_b16 v[52:53], v21 offset:36864
  ds_read_b64_tr_b16 v[54:55], v21 offset:37888
  ds_read_b64_tr_b16 v[56:57], v22 offset:36864
  ds_read_b64_tr_b16 v[58:59], v22 offset:37888
  s_waitcnt lgkmcnt(6)
  v_mfma_f32_32x32x16_bf16 v[64:79], v[32:35], v[240:243], v[64:79]
  v_lshlrev_b32 v24, 16, v244
  v_and_b32 v25, s27, v244
  v_lshlrev_b32 v26, 16, v245
  v_and_b32 v27, s27, v245
  v_lshlrev_b32 v28, 16, v246
  v_and_b32 v29, s27, v246
  v_lshlrev_b32 v30, 16, v247
  v_mfma_f32_32x32x16_bf16 v[80:95], v[36:39], v[240:243], v[80:95]
  v_and_b32 v31, s27, v247
  v_add_f32 v24, v7, v24
  v_add_f32 v25, v7, v25
  v_add_f32 v26, v7, v26
  v_add_f32 v27, v7, v27
  v_add_f32 v28, v7, v28
  v_add_f32 v29, v7, v29
  v_mfma_f32_32x32x16_bf16 v[96:111], v[40:43], v[240:243], v[96:111]
  v_add_f32 v30, v7, v30
  v_add_f32 v31, v7, v31
  v_cvt_pk_bf16_f32 v244, v24, v25
  v_cvt_pk_bf16_f32 v245, v26, v27
  v_cvt_pk_bf16_f32 v246, v28, v29
  v_cvt_pk_bf16_f32 v247, v30, v31
k1_spin0_14:
  v_cmp_gt_u32 vcc, 14, v0
  s_cbranch_vccz k1_ok0_14
  ds_read_b32 v0, v3
  s_waitcnt lgkmcnt(0)
  s_branch k1_spin0_14
k1_ok0_14:

  ds_read_b64_tr_b16 v[32:33], v20 offset:49152
  ds_read_b64_tr_b16 v[34:35], v20 offset:50176
  ds_read_b64_tr_b16 v[36:37], v21 offset:49152
  ds_read_b64_tr_b16 v[38:39], v21 offset:50176
  ds_read_b64_tr_b16 v[40:41], v22 offset:49152
  ds_read_b64_tr_b16 v[42:43], v22 offset:50176
  s_waitcnt lgkmcnt(6)
  v_mfma_f32_32x32x16_bf16 v[64:79], v[48:51], v[244:247], v[64:79]
  v_lshlrev_b32 v24, 16, v248
  v_and_b32 v25, s27, v248
  v_lshlrev_b32 v26, 16, v249
  v_and_b32 v27, s27, v249
  v_lshlrev_b32 v28, 16, v250
  v_and_b32 v29, s27, v250
  v_lshlrev_b32 v30, 16, v251
  v_mfma_f32_32x32x16_bf16 v[80:95], v[52:55], v[244:247], v[80:95]
  v_and_b32 v31, s27, v251
  v_add_f32 v24, v7, v24
  v_add_f32 v25, v7, v25
  v_add_f32 v26, v7, v26
  v_add_f32 v27, v7, v27
  v_add_f32 v28, v7, v28
  v_add_f32 v29, v7, v29
  v_mfma_f32_32x32x16_bf16 v[96:111], v[56:59], v[244:247], v[96:111]
  v_add_f32 v30, v7, v30
  v_add_f32 v31, v7, v31
  v_cvt_pk_bf16_f32 v248, v24, v25
  v_cvt_pk_bf16_f32 v249, v26, v27
  v_cvt_pk_bf16_f32 v250, v28, v29
  v_cvt_pk_bf16_f32 v251, v30, v31
  ds_read_b64_tr_b16 v[48:49], v20 offset:53248
  ds_read_b64_tr_b16 v[50:51], v20 offset:54272
  ds_read_b64_tr_b16 v[52:53], v21 offset:53248
  ds_read_b64_tr_b16 v[54:55], v21 offset:54272
  ds_read_b64_tr_b16 v[56:57], v22 offset:53248
  ds_read_b64_tr_b16 v[58:59], v22 offset:54272
  s_waitcnt lgkmcnt(6)
  v_mfma_f32_32x32x16_bf16 v[64:79], v[32:35], v[248:251], v[64:79]
  v_lshlrev_b32 v24, 16, v252
  v_and_b32 v25, s27, v252
  v_lshlrev_b32 v26, 16, v253
  v_and_b32 v27, s27, v253
  v_lshlrev_b32 v28, 16, v254
  v_and_b32 v29, s27, v254
  v_lshlrev_b32 v30, 16, v255
  v_mfma_f32_32x32x16_bf16 v[80:95], v[36:39], v[248:251], v[80:95]
  v_and_b32 v31, s27, v255
  v_add_f32 v24, v7, v24
  v_add_f32 v25, v7, v25
  v_add_f32 v26, v7, v26
  v_add_f32 v27, v7, v27
  v_add_f32 v28, v7, v28
  v_add_f32 v29, v7, v29
  v_mfma_f32_32x32x16_bf16 v[96:111], v[40:43], v[248:251], v[96:111]
  v_add_f32 v30, v7, v30
  v_add_f32 v31, v7, v31
  v_cvt_pk_bf16_f32 v252, v24, v25
  v_cvt_pk_bf16_f32 v253, v26, v27
  v_cvt_pk_bf16_f32 v254, v28, v29
  v_cvt_pk_bf16_f32 v255, v30, v31
  s_cmp_eq_u32 s2, 0
  s_cbranch_scc0 k1_nosp3
  buffer_load_dwordx4 v[224:227], v117, s[40:43], s73 offen sc1
  buffer_load_dwordx4 v[228:231], v117, s[40:43], s73 offen offset:16 sc1
  s_add_u32 s73, s73, 8192
  buffer_load_dwordx4 v[232:235], v117, s[40:43], s73 offen sc1
  buffer_load_dwordx4 v[236:239], v117, s[40:43], s73 offen offset:16 sc1
  s_add_u32 s73, s73, 8192
  buffer_load_dwordx4 v[240:243], v117, s[40:43], s73 offen sc1
  buffer_load_dwordx4 v[244:247], v117, s[40:43], s73 offen offset:16 sc1
k1_nosp3:

  s_waitcnt lgkmcnt(0)
  v_mfma_f32_32x32x16_bf16 v[64:79], v[48:51], v[252:255], v[64:79]
  v_mfma_f32_32x32x16_bf16 v[80:95], v[52:55], v[252:255], v[80:95]
  v_mfma_f32_32x32x16_bf16 v[96:111], v[56:59], v[252:255], v[96:111]
  s_mul_i32 s50, s22, 112
  s_mul_i32 s51, s19, 7
  s_add_u32 s50, s50, s51
  s_add_u32 s50, s50, 0
  s_lshl_b32 s50, s50, 10
  s_add_u32 s50, s50, 0
  v_mov_b32 v10, v8
  v_mov_b32 v11, v8
  s_nop 7

  v_pk_mul_f32 v[64:65], v[64:65], v[10:11]
  v_pk_mul_f32 v[66:67], v[66:67], v[10:11]
  v_pk_mul_f32 v[68:69], v[68:69], v[10:11]
  v_pk_mul_f32 v[70:71], v[70:71], v[10:11]
  v_pk_mul_f32 v[72:73], v[72:73], v[10:11]
  v_pk_mul_f32 v[74:75], v[74:75], v[10:11]
  v_pk_mul_f32 v[76:77], v[76:77], v[10:11]
  v_pk_mul_f32 v[78:79], v[78:79], v[10:11]
  v_max_f32 v64, 0, v64
  v_max_f32 v65, 0, v65
  v_max_f32 v66, 0, v66
  v_max_f32 v67, 0, v67
  v_max_f32 v68, 0, v68
  v_max_f32 v69, 0, v69
  v_max_f32 v70, 0, v70
  v_max_f32 v71, 0, v71
  v_cvt_pk_bf16_f32 v120, v64, v65
  v_cvt_pk_bf16_f32 v121, v66, v67
  v_cvt_pk_bf16_f32 v122, v68, v69
  v_cvt_pk_bf16_f32 v123, v70, v71
  v_cvt_pk_bf16_f32 v124, v72, v73
  v_cvt_pk_bf16_f32 v125, v74, v75
  v_cvt_pk_bf16_f32 v126, v76, v77
  v_cvt_pk_bf16_f32 v127, v78, v79
  v_lshlrev_b32 v64, 16, v120
  v_and_b32 v65, s27, v120
  v_lshlrev_b32 v66, 16, v121
  v_and_b32 v67, s27, v121
  v_lshlrev_b32 v68, 16, v122
  v_and_b32 v69, s27, v122
  v_lshlrev_b32 v70, 16, v123
  v_and_b32 v71, s27, v123
  v_lshlrev_b32 v72, 16, v124
  v_and_b32 v73, s27, v124
  v_lshlrev_b32 v74, 16, v125
  v_and_b32 v75, s27, v125
  v_lshlrev_b32 v76, 16, v126
  v_and_b32 v77, s27, v126
  v_lshlrev_b32 v78, 16, v127
  v_and_b32 v79, s27, v127
  v_pk_mul_f32 v[64:65], v[64:65], v[72:73]
  v_pk_mul_f32 v[66:67], v[66:67], v[74:75]
  v_pk_mul_f32 v[68:69], v[68:69], v[76:77]
  v_pk_mul_f32 v[70:71], v[70:71], v[78:79]
  v_cvt_pk_bf16_f32 v32, v64, v65
  v_cvt_pk_bf16_f32 v33, v66, v67
  v_cvt_pk_bf16_f32 v34, v68, v69
  v_cvt_pk_bf16_f32 v35, v70, v71
  buffer_store_dwordx4 v[32:35], v9, s[40:43], s50 offen offset:0 sc1
  v_pk_mul_f32 v[80:81], v[80:81], v[10:11]
  v_pk_mul_f32 v[82:83], v[82:83], v[10:11]
  v_pk_mul_f32 v[84:85], v[84:85], v[10:11]
  v_pk_mul_f32 v[86:87], v[86:87], v[10:11]
  v_pk_mul_f32 v[88:89], v[88:89], v[10:11]
  v_pk_mul_f32 v[90:91], v[90:91], v[10:11]
  v_pk_mul_f32 v[92:93], v[92:93], v[10:11]
  v_pk_mul_f32 v[94:95], v[94:95], v[10:11]
  v_max_f32 v80, 0, v80
  v_max_f32 v81, 0, v81
  v_max_f32 v82, 0, v82
  v_max_f32 v83, 0, v83
  v_max_f32 v84, 0, v84
  v_max_f32 v85, 0, v85
  v_max_f32 v86, 0, v86
  v_max_f32 v87, 0, v87
  v_cvt_pk_bf16_f32 v120, v80, v81
  v_cvt_pk_bf16_f32 v121, v82, v83
  v_cvt_pk_bf16_f32 v122, v84, v85
  v_cvt_pk_bf16_f32 v123, v86, v87
  v_cvt_pk_bf16_f32 v124, v88, v89
  v_cvt_pk_bf16_f32 v125, v90, v91
  v_cvt_pk_bf16_f32 v126, v92, v93
  v_cvt_pk_bf16_f32 v127, v94, v95
  v_lshlrev_b32 v80, 16, v120
  v_and_b32 v81, s27, v120
  v_lshlrev_b32 v82, 16, v121
  v_and_b32 v83, s27, v121
  v_lshlrev_b32 v84, 16, v122
  v_and_b32 v85, s27, v122
  v_lshlrev_b32 v86, 16, v123
  v_and_b32 v87, s27, v123
  v_lshlrev_b32 v88, 16, v124
  v_and_b32 v89, s27, v124
  v_lshlrev_b32 v90, 16, v125
  v_and_b32 v91, s27, v125
  v_lshlrev_b32 v92, 16, v126
  v_and_b32 v93, s27, v126
  v_lshlrev_b32 v94, 16, v127
  v_and_b32 v95, s27, v127
  v_pk_mul_f32 v[80:81], v[80:81], v[88:89]
  v_pk_mul_f32 v[82:83], v[82:83], v[90:91]
  v_pk_mul_f32 v[84:85], v[84:85], v[92:93]
  v_pk_mul_f32 v[86:87], v[86:87], v[94:95]
  v_cvt_pk_bf16_f32 v36, v80, v81
  v_cvt_pk_bf16_f32 v37, v82, v83
  v_cvt_pk_bf16_f32 v38, v84, v85
  v_cvt_pk_bf16_f32 v39, v86, v87
  buffer_store_dwordx4 v[36:39], v9, s[40:43], s50 offen offset:1024 sc1
  v_pk_mul_f32 v[96:97], v[96:97], v[10:11]
  v_pk_mul_f32 v[98:99], v[98:99], v[10:11]
  v_pk_mul_f32 v[100:101], v[100:101], v[10:11]
  v_pk_mul_f32 v[102:103], v[102:103], v[10:11]
  v_pk_mul_f32 v[104:105], v[104:105], v[10:11]
  v_pk_mul_f32 v[106:107], v[106:107], v[10:11]
  v_pk_mul_f32 v[108:109], v[108:109], v[10:11]
  v_pk_mul_f32 v[110:111], v[110:111], v[10:11]
  v_max_f32 v96, 0, v96
  v_max_f32 v97, 0, v97
  v_max_f32 v98, 0, v98
  v_max_f32 v99, 0, v99
  v_max_f32 v100, 0, v100
  v_max_f32 v101, 0, v101
  v_max_f32 v102, 0, v102
  v_max_f32 v103, 0, v103
  v_cvt_pk_bf16_f32 v120, v96, v97
  v_cvt_pk_bf16_f32 v121, v98, v99
  v_cvt_pk_bf16_f32 v122, v100, v101
  v_cvt_pk_bf16_f32 v123, v102, v103
  v_cvt_pk_bf16_f32 v124, v104, v105
  v_cvt_pk_bf16_f32 v125, v106, v107
  v_cvt_pk_bf16_f32 v126, v108, v109
  v_cvt_pk_bf16_f32 v127, v110, v111
  v_lshlrev_b32 v96, 16, v120
  v_and_b32 v97, s27, v120
  v_lshlrev_b32 v98, 16, v121
  v_and_b32 v99, s27, v121
  v_lshlrev_b32 v100, 16, v122
  v_and_b32 v101, s27, v122
  v_lshlrev_b32 v102, 16, v123
  v_and_b32 v103, s27, v123
  v_lshlrev_b32 v104, 16, v124
  v_and_b32 v105, s27, v124
  v_lshlrev_b32 v106, 16, v125
  v_and_b32 v107, s27, v125
  v_lshlrev_b32 v108, 16, v126
  v_and_b32 v109, s27, v126
  v_lshlrev_b32 v110, 16, v127
  v_and_b32 v111, s27, v127
  v_pk_mul_f32 v[96:97], v[96:97], v[104:105]
  v_pk_mul_f32 v[98:99], v[98:99], v[106:107]
  v_pk_mul_f32 v[100:101], v[100:101], v[108:109]
  v_pk_mul_f32 v[102:103], v[102:103], v[110:111]
  v_cvt_pk_bf16_f32 v40, v96, v97
  v_cvt_pk_bf16_f32 v41, v98, v99
  v_cvt_pk_bf16_f32 v42, v100, v101
  v_cvt_pk_bf16_f32 v43, v102, v103
  buffer_store_dwordx4 v[40:43], v9, s[40:43], s50 offen offset:2048 sc1
  s_branch ph2
k1_ch1:
  ds_read_b64_tr_b16 v[32:33], v16 offset:0
  ds_read_b64_tr_b16 v[34:35], v16 offset:1024
  ds_read_b64_tr_b16 v[36:37], v17 offset:0
  ds_read_b64_tr_b16 v[38:39], v17 offset:1024
  ds_read_b64_tr_b16 v[40:41], v18 offset:0
  ds_read_b64_tr_b16 v[42:43], v18 offset:1024
  ds_read_b64_tr_b16 v[44:45], v19 offset:0
  ds_read_b64_tr_b16 v[46:47], v19 offset:1024
  v_lshlrev_b32 v24, 16, v128
  v_and_b32 v25, s27, v128
  v_lshlrev_b32 v26, 16, v129
  v_and_b32 v27, s27, v129
  v_lshlrev_b32 v28, 16, v130
  v_and_b32 v29, s27, v130
  v_lshlrev_b32 v30, 16, v131
  v_and_b32 v31, s27, v131
  v_add_f32 v24, v7, v24
  v_add_f32 v25, v7, v25
  v_add_f32 v26, v7, v26
  v_add_f32 v27, v7, v27
  v_add_f32 v28, v7, v28
  v_add_f32 v29, v7, v29
  v_add_f32 v30, v7, v30
  v_add_f32 v31, v7, v31
  v_cvt_pk_bf16_f32 v128, v24, v25
  v_cvt_pk_bf16_f32 v129, v26, v27
  v_cvt_pk_bf16_f32 v130, v28, v29
  v_cvt_pk_bf16_f32 v131, v30, v31
  ds_read_b64_tr_b16 v[48:49], v16 offset:4096
  ds_read_b64_tr_b16 v[50:51], v16 offset:5120
  ds_read_b64_tr_b16 v[52:53], v17 offset:4096
  ds_read_b64_tr_b16 v[54:55], v17 offset:5120
  ds_read_b64_tr_b16 v[56:57], v18 offset:4096
  ds_read_b64_tr_b16 v[58:59], v18 offset:5120
  ds_read_b64_tr_b16 v[60:61], v19 offset:4096
  ds_read_b64_tr_b16 v[62:63], v19 offset:5120
  s_waitcnt lgkmcnt(8)
  s_waitcnt vmcnt(3)
  v_mov_b32 v10, 1
  ds_write_b32 v11, v10
  v_mfma_f32_32x32x16_bf16 v[64:79], v[32:35], v[128:131], 0
  v_lshlrev_b32 v24, 16, v132
  v_and_b32 v25, s27, v132
  v_lshlrev_b32 v26, 16, v133
  v_and_b32 v27, s27, v133
  v_lshlrev_b32 v28, 16, v134
  s_xor_b32 s56, s58, 4
  s_add_u32 m0, s53, 98304
  s_mul_i32 s56, s56, s55
  buffer_load_dwordx4 v1, s[44:47], s56 offen lds
  v_mfma_f32_32x32x16_bf16 v[80:95], v[36:39], v[128:131], 0
  v_and_b32 v29, s27, v134
  v_lshlrev_b32 v30, 16, v135
  v_and_b32 v31, s27, v135
  v_add_f32 v24, v7, v24
  v_add_f32 v25, v7, v25
  v_mfma_f32_32x32x16_bf16 v[96:111], v[40:43], v[128:131], 0
  v_add_f32 v26, v7, v26
  v_add_f32 v27, v7, v27
  v_add_f32 v28, v7, v28
  v_add_f32 v29, v7, v29
  v_add_f32 v30, v7, v30
  s_add_u32 m0, s53, 99328
  s_nop 0
  buffer_load_dwordx4 v4, s[44:47], s56 offen lds
  v_mfma_f32_32x32x16_bf16 v[112:127], v[44:47], v[128:131], 0
  v_add_f32 v31, v7, v31
  v_cvt_pk_bf16_f32 v132, v24, v25
  v_cvt_pk_bf16_f32 v133, v26, v27
  v_cvt_pk_bf16_f32 v134, v28, v29
  v_cvt_pk_bf16_f32 v135, v30, v31
  ds_read_b64_tr_b16 v[32:33], v16 offset:16384
  ds_read_b64_tr_b16 v[34:35], v16 offset:17408
  ds_read_b64_tr_b16 v[36:37], v17 offset:16384
  ds_read_b64_tr_b16 v[38:39], v17 offset:17408
  ds_read_b64_tr_b16 v[40:41], v18 offset:16384
  ds_read_b64_tr_b16 v[42:43], v18 offset:17408
  ds_read_b64_tr_b16 v[44:45], v19 offset:16384
  ds_read_b64_tr_b16 v[46:47], v19 offset:17408
  s_waitcnt lgkmcnt(8)
  v_mfma_f32_32x32x16_bf16 v[64:79], v[48:51], v[132:135], v[64:79]
  v_lshlrev_b32 v24, 16, v136
  v_and_b32 v25, s27, v136
  v_lshlrev_b32 v26, 16, v137
  v_and_b32 v27, s27, v137
  v_lshlrev_b32 v28, 16, v138
  s_xor_b32 s56, s58, 5
  s_add_u32 m0, s53, 114688
  s_mul_i32 s56, s56, s55
  buffer_load_dwordx4 v1, s[44:47], s56 offen lds
  v_mfma_f32_32x32x16_bf16 v[80:95], v[52:55], v[132:135], v[80:95]
  v_and_b32 v29, s27, v138
  v_lshlrev_b32 v30, 16, v139
  v_and_b32 v31, s27, v139
  v_add_f32 v24, v7, v24
  v_add_f32 v25, v7, v25
  v_mfma_f32_32x32x16_bf16 v[96:111], v[56:59], v[132:135], v[96:111]
  v_add_f32 v26, v7, v26
  v_add_f32 v27, v7, v27
  v_add_f32 v28, v7, v28
  v_add_f32 v29, v7, v29
  v_add_f32 v30, v7, v30
  s_add_u32 m0, s53, 115712
  s_nop 0
  buffer_load_dwordx4 v4, s[44:47], s56 offen lds
  v_mfma_f32_32x32x16_bf16 v[112:127], v[60:63], v[132:135], v[112:127]
  v_add_f32 v31, v7, v31
  v_cvt_pk_bf16_f32 v136, v24, v25
  v_cvt_pk_bf16_f32 v137, v26, v27
  v_cvt_pk_bf16_f32 v138, v28, v29
  v_cvt_pk_bf16_f32 v139, v30, v31
  ds_read_b32 v0, v3
  ds_read_b64_tr_b16 v[48:49], v16 offset:20480
  ds_read_b64_tr_b16 v[50:51], v16 offset:21504
  ds_read_b64_tr_b16 v[52:53], v17 offset:20480
  ds_read_b64_tr_b16 v[54:55], v17 offset:21504
  ds_read_b64_tr_b16 v[56:57], v18 offset:20480
  ds_read_b64_tr_b16 v[58:59], v18 offset:21504
  ds_read_b64_tr_b16 v[60:61], v19 offset:20480
  ds_read_b64_tr_b16 v[62:63], v19 offset:21504
  s_waitcnt lgkmcnt(8)
  s_waitcnt vmcnt(5)
  v_mov_b32 v10, 2
  ds_write_b32 v11, v10
  v_mfma_f32_32x32x16_bf16 v[64:79], v[32:35], v[136:139], v[64:79]
  v_lshlrev_b32 v24, 16, v140
  v_and_b32 v25, s27, v140
  v_lshlrev_b32 v26, 16, v141
  v_and_b32 v27, s27, v141
  v_lshlrev_b32 v28, 16, v142
  s_xor_b32 s56, s58, 6
  s_add_u32 m0, s53, 131072
  s_mul_i32 s56, s56, s55
  buffer_load_dwordx4 v1, s[44:47], s56 offen lds
  v_mfma_f32_32x32x16_bf16 v[80:95], v[36:39], v[136:139], v[80:95]
  v_and_b32 v29, s27, v142
  v_lshlrev_b32 v30, 16, v143
  v_and_b32 v31, s27, v143
  v_add_f32 v24, v7, v24
  v_add_f32 v25, v7, v25
  v_mfma_f32_32x32x16_bf16 v[96:111], v[40:43], v[136:139], v[96:111]
  v_add_f32 v26, v7, v26
  v_add_f32 v27, v7, v27
  v_add_f32 v28, v7, v28
  v_add_f32 v29, v7, v29
  v_add_f32 v30, v7, v30
  s_add_u32 m0, s53, 132096
  s_nop 0
  buffer_load_dwordx4 v4, s[44:47], s56 offen lds
  v_mfma_f32_32x32x16_bf16 v[112:127], v[44:47], v[136:139], v[112:127]
  v_add_f32 v31, v7, v31
  v_cvt_pk_bf16_f32 v140, v24, v25
  v_cvt_pk_bf16_f32 v141, v26, v27
  v_cvt_pk_bf16_f32 v142, v28, v29
  v_cvt_pk_bf16_f32 v143, v30, v31
k1_spin1_1:
  v_cmp_gt_u32 vcc, 1, v0
  s_cbranch_vccz k1_ok1_1
  ds_read_b32 v0, v3
  s_waitcnt lgkmcnt(0)
  s_branch k1_spin1_1
k1_ok1_1:

  ds_read_b128 v[12:15], v5
  ds_read_b64_tr_b16 v[32:33], v16 offset:32768
  ds_read_b64_tr_b16 v[34:35], v16 offset:33792
  ds_read_b64_tr_b16 v[36:37], v17 offset:32768
  ds_read_b64_tr_b16 v[38:39], v17 offset:33792
  ds_read_b64_tr_b16 v[40:41], v18 offset:32768
  ds_read_b64_tr_b16 v[42:43], v18 offset:33792
  ds_read_b64_tr_b16 v[44:45], v19 offset:32768
  ds_read_b64_tr_b16 v[46:47], v19 offset:33792
  s_waitcnt lgkmcnt(8)
  v_mfma_f32_32x32x16_bf16 v[64:79], v[48:51], v[140:143], v[64:79]
  v_lshlrev_b32 v24, 16, v144
  v_and_b32 v25, s27, v144
  v_lshlrev_b32 v26, 16, v145
  v_and_b32 v27, s27, v145
  v_lshlrev_b32 v28, 16, v146
  v_mfma_f32_32x32x16_bf16 v[80:95], v[52:55], v[140:143], v[80:95]
  v_and_b32 v29, s27, v146
  v_lshlrev_b32 v30, 16, v147
  v_and_b32 v31, s27, v147
  v_add_f32 v24, v7, v24
  v_add_f32 v25, v7, v25
  v_mfma_f32_32x32x16_bf16 v[96:111], v[56:59], v[140:143], v[96:111]
  v_add_f32 v26, v7, v26
  v_add_f32 v27, v7, v27
  v_add_f32 v28, v7, v28
  v_add_f32 v29, v7, v29
  v_add_f32 v30, v7, v30
  v_mfma_f32_32x32x16_bf16 v[112:127], v[60:63], v[140:143], v[112:127]
  v_add_f32 v31, v7, v31
  v_cvt_pk_bf16_f32 v144, v24, v25
  v_cvt_pk_bf16_f32 v145, v26, v27
  v_cvt_pk_bf16_f32 v146, v28, v29
  v_cvt_pk_bf16_f32 v147, v30, v31
  ds_read_b32 v0, v3
  ds_read_b64_tr_b16 v[48:49], v16 offset:36864
  ds_read_b64_tr_b16 v[50:51], v16 offset:37888
  ds_read_b64_tr_b16 v[52:53], v17 offset:36864
  ds_read_b64_tr_b16 v[54:55], v17 offset:37888
  ds_read_b64_tr_b16 v[56:57], v18 offset:36864
  ds_read_b64_tr_b16 v[58:59], v18 offset:37888
  ds_read_b64_tr_b16 v[60:61], v19 offset:36864
  ds_read_b64_tr_b16 v[62:63], v19 offset:37888
  s_waitcnt lgkmcnt(8)
  buffer_store_dwordx4 v[12:15], v6, s[40:43], s51 offen sc1
  v_mov_b32 v5, 0
  global_load_dword v5, v5, s[68:69] sc1
  s_waitcnt vmcnt(6)
  v_mov_b32 v10, 3
  ds_write_b32 v11, v10
  v_mfma_f32_32x32x16_bf16 v[64:79], v[32:35], v[144:147], v[64:79]
  v_lshlrev_b32 v24, 16, v148
  v_and_b32 v25, s27, v148
  v_lshlrev_b32 v26, 16, v149
  v_and_b32 v27, s27, v149
  v_lshlrev_b32 v28, 16, v150
  v_mfma_f32_32x32x16_bf16 v[80:95], v[36:39], v[144:147], v[80:95]
  v_and_b32 v29, s27, v150
  v_lshlrev_b32 v30, 16, v151
  v_and_b32 v31, s27, v151
  v_add_f32 v24, v7, v24
  v_add_f32 v25, v7, v25
  v_mfma_f32_32x32x16_bf16 v[96:111], v[40:43], v[144:147], v[96:111]
  v_add_f32 v26, v7, v26
  v_add_f32 v27, v7, v27
  v_add_f32 v28, v7, v28
  v_add_f32 v29, v7, v29
  v_add_f32 v30, v7, v30
  v_mfma_f32_32x32x16_bf16 v[112:127], v[44:47], v[144:147], v[112:127]
  v_add_f32 v31, v7, v31
  v_cvt_pk_bf16_f32 v148, v24, v25
  v_cvt_pk_bf16_f32 v149, v26, v27
  v_cvt_pk_bf16_f32 v150, v28, v29
  v_cvt_pk_bf16_f32 v151, v30, v31
k1_spin1_2:
  v_cmp_gt_u32 vcc, 2, v0
  s_cbranch_vccz k1_ok1_2
  ds_read_b32 v0, v3
  s_waitcnt lgkmcnt(0)
  s_branch k1_spin1_2
k1_ok1_2:

  ds_read_b64_tr_b16 v[32:33], v16 offset:49152
  ds_read_b64_tr_b16 v[34:35], v16 offset:50176
  ds_read_b64_tr_b16 v[36:37], v17 offset:49152
  ds_read_b64_tr_b16 v[38:39], v17 offset:50176
  ds_read_b64_tr_b16 v[40:41], v18 offset:49152
  ds_read_b64_tr_b16 v[42:43], v18 offset:50176
  ds_read_b64_tr_b16 v[44:45], v19 offset:49152
  ds_read_b64_tr_b16 v[46:47], v19 offset:50176
  s_waitcnt lgkmcnt(8)
  v_mfma_f32_32x32x16_bf16 v[64:79], v[48:51], v[148:151], v[64:79]
  v_lshlrev_b32 v24, 16, v152
  v_and_b32 v25, s27, v152
  v_lshlrev_b32 v26, 16, v153
  v_and_b32 v27, s27, v153
  v_lshlrev_b32 v28, 16, v154
  v_mfma_f32_32x32x16_bf16 v[80:95], v[52:55], v[148:151], v[80:95]
  v_and_b32 v29, s27, v154
  v_lshlrev_b32 v30, 16, v155
  v_and_b32 v31, s27, v155
  v_add_f32 v24, v7, v24
  v_add_f32 v25, v7, v25
  v_mfma_f32_32x32x16_bf16 v[96:111], v[56:59], v[148:151], v[96:111]
  v_add_f32 v26, v7, v26
  v_add_f32 v27, v7, v27
  v_add_f32 v28, v7, v28
  v_add_f32 v29, v7, v29
  v_add_f32 v30, v7, v30
  v_mfma_f32_32x32x16_bf16 v[112:127], v[60:63], v[148:151], v[112:127]
  v_add_f32 v31, v7, v31
  v_cvt_pk_bf16_f32 v152, v24, v25
  v_cvt_pk_bf16_f32 v153, v26, v27
  v_cvt_pk_bf16_f32 v154, v28, v29
  v_cvt_pk_bf16_f32 v155, v30, v31
  ds_read_b32 v0, v3
  ds_read_b64_tr_b16 v[48:49], v16 offset:53248
  ds_read_b64_tr_b16 v[50:51], v16 offset:54272
  ds_read_b64_tr_b16 v[52:53], v17 offset:53248
  ds_read_b64_tr_b16 v[54:55], v17 offset:54272
  ds_read_b64_tr_b16 v[56:57], v18 offset:53248
  ds_read_b64_tr_b16 v[58:59], v18 offset:54272
  ds_read_b64_tr_b16 v[60:61], v19 offset:53248
  ds_read_b64_tr_b16 v[62:63], v19 offset:54272
  s_waitcnt lgkmcnt(8)
  s_waitcnt vmcnt(4)
  v_mov_b32 v10, 4
  ds_write_b32 v11, v10
  v_mfma_f32_32x32x16_bf16 v[64:79], v[32:35], v[152:155], v[64:79]
  v_lshlrev_b32 v24, 16, v156
  v_and_b32 v25, s27, v156
  v_lshlrev_b32 v26, 16, v157
  v_and_b32 v27, s27, v157
  v_lshlrev_b32 v28, 16, v158
  v_mfma_f32_32x32x16_bf16 v[80:95], v[36:39], v[152:155], v[80:95]
  v_and_b32 v29, s27, v158
  v_lshlrev_b32 v30, 16, v159
  v_and_b32 v31, s27, v159
  v_add_f32 v24, v7, v24
  v_add_f32 v25, v7, v25
  v_mfma_f32_32x32x16_bf16 v[96:111], v[40:43], v[152:155], v[96:111]
  v_add_f32 v26, v7, v26
  v_add_f32 v27, v7, v27
  v_add_f32 v28, v7, v28
  v_add_f32 v29, v7, v29
  v_add_f32 v30, v7, v30
  v_mfma_f32_32x32x16_bf16 v[112:127], v[44:47], v[152:155], v[112:127]
  v_add_f32 v31, v7, v31
  v_cvt_pk_bf16_f32 v156, v24, v25
  v_cvt_pk_bf16_f32 v157, v26, v27
  v_cvt_pk_bf16_f32 v158, v28, v29
  v_cvt_pk_bf16_f32 v159, v30, v31
k1_spin1_3:
  v_cmp_gt_u32 vcc, 3, v0
  s_cbranch_vccz k1_ok1_3
  ds_read_b32 v0, v3
  s_waitcnt lgkmcnt(0)
  s_branch k1_spin1_3
k1_ok1_3:

  ds_read_b64_tr_b16 v[32:33], v20 offset:0
  ds_read_b64_tr_b16 v[34:35], v20 offset:1024
  ds_read_b64_tr_b16 v[36:37], v21 offset:0
  ds_read_b64_tr_b16 v[38:39], v21 offset:1024
  ds_read_b64_tr_b16 v[40:41], v22 offset:0
  ds_read_b64_tr_b16 v[42:43], v22 offset:1024
  ds_read_b64_tr_b16 v[44:45], v23 offset:0
  ds_read_b64_tr_b16 v[46:47], v23 offset:1024
  s_waitcnt lgkmcnt(8)
  v_mfma_f32_32x32x16_bf16 v[64:79], v[48:51], v[156:159], v[64:79]
  v_lshlrev_b32 v24, 16, v160
  v_and_b32 v25, s27, v160
  v_lshlrev_b32 v26, 16, v161
  v_and_b32 v27, s27, v161
  v_lshlrev_b32 v28, 16, v162
  s_xor_b32 s56, s58, 7
  s_add_u32 m0, s53, 147456
  s_mul_i32 s56, s56, s55
  buffer_load_dwordx4 v1, s[44:47], s56 offen lds
  v_mfma_f32_32x32x16_bf16 v[80:95], v[52:55], v[156:159], v[80:95]
  v_and_b32 v29, s27, v162
  v_lshlrev_b32 v30, 16, v163
  v_and_b32 v31, s27, v163
  v_add_f32 v24, v7, v24
  v_add_f32 v25, v7, v25
  v_mfma_f32_32x32x16_bf16 v[96:111], v[56:59], v[156:159], v[96:111]
  v_add_f32 v26, v7, v26
  v_add_f32 v27, v7, v27
  v_add_f32 v28, v7, v28
  v_add_f32 v29, v7, v29
  v_add_f32 v30, v7, v30
  s_add_u32 m0, s53, 148480
  s_nop 0
  buffer_load_dwordx4 v4, s[44:47], s56 offen lds
  v_mfma_f32_32x32x16_bf16 v[112:127], v[60:63], v[156:159], v[112:127]
  v_add_f32 v31, v7, v31
  v_cvt_pk_bf16_f32 v160, v24, v25
  v_cvt_pk_bf16_f32 v161, v26, v27
  v_cvt_pk_bf16_f32 v162, v28, v29
  v_cvt_pk_bf16_f32 v163, v30, v31
  ds_read_b32 v0, v3
  ds_read_b64_tr_b16 v[48:49], v20 offset:4096
  ds_read_b64_tr_b16 v[50:51], v20 offset:5120
  ds_read_b64_tr_b16 v[52:53], v21 offset:4096
  ds_read_b64_tr_b16 v[54:55], v21 offset:5120
  ds_read_b64_tr_b16 v[56:57], v22 offset:4096
  ds_read_b64_tr_b16 v[58:59], v22 offset:5120
  ds_read_b64_tr_b16 v[60:61], v23 offset:4096
  ds_read_b64_tr_b16 v[62:63], v23 offset:5120
  s_waitcnt lgkmcnt(8)
  s_waitcnt vmcnt(4)
  v_mov_b32 v10, 5
  ds_write_b32 v11, v10
  v_mfma_f32_32x32x16_bf16 v[64:79], v[32:35], v[160:163], v[64:79]
  v_lshlrev_b32 v24, 16, v164
  v_and_b32 v25, s27, v164
  v_lshlrev_b32 v26, 16, v165
  v_and_b32 v27, s27, v165
  v_lshlrev_b32 v28, 16, v166
  s_xor_b32 s56, s58, 8
  s_add_u32 m0, s53, 0
  s_mul_i32 s56, s56, s55
  buffer_load_dwordx4 v1, s[44:47], s56 offen lds
  v_mfma_f32_32x32x16_bf16 v[80:95], v[36:39], v[160:163], v[80:95]
  v_and_b32 v29, s27, v166
  v_lshlrev_b32 v30, 16, v167
  v_and_b32 v31, s27, v167
  v_add_f32 v24, v7, v24
  v_add_f32 v25, v7, v25
  v_mfma_f32_32x32x16_bf16 v[96:111], v[40:43], v[160:163], v[96:111]
  v_add_f32 v26, v7, v26
  v_add_f32 v27, v7, v27
  v_add_f32 v28, v7, v28
  v_add_f32 v29, v7, v29
  v_add_f32 v30, v7, v30
  s_add_u32 m0, s53, 1024
  s_nop 0
  buffer_load_dwordx4 v4, s[44:47], s56 offen lds
  v_mfma_f32_32x32x16_bf16 v[112:127], v[44:47], v[160:163], v[112:127]
  v_add_f32 v31, v7, v31
  v_cvt_pk_bf16_f32 v164, v24, v25
  v_cvt_pk_bf16_f32 v165, v26, v27
  v_cvt_pk_bf16_f32 v166, v28, v29
  v_cvt_pk_bf16_f32 v167, v30, v31
k1_spin1_4:
  v_cmp_gt_u32 vcc, 4, v0
  s_cbranch_vccz k1_ok1_4
  ds_read_b32 v0, v3
  s_waitcnt lgkmcnt(0)
  s_branch k1_spin1_4
k1_ok1_4:

  ds_read_b64_tr_b16 v[32:33], v20 offset:16384
  ds_read_b64_tr_b16 v[34:35], v20 offset:17408
  ds_read_b64_tr_b16 v[36:37], v21 offset:16384
  ds_read_b64_tr_b16 v[38:39], v21 offset:17408
  ds_read_b64_tr_b16 v[40:41], v22 offset:16384
  ds_read_b64_tr_b16 v[42:43], v22 offset:17408
  ds_read_b64_tr_b16 v[44:45], v23 offset:16384
  ds_read_b64_tr_b16 v[46:47], v23 offset:17408
  s_waitcnt lgkmcnt(8)
  v_mfma_f32_32x32x16_bf16 v[64:79], v[48:51], v[164:167], v[64:79]
  v_lshlrev_b32 v24, 16, v168
  v_and_b32 v25, s27, v168
  v_lshlrev_b32 v26, 16, v169
  v_and_b32 v27, s27, v169
  v_lshlrev_b32 v28, 16, v170
  s_xor_b32 s56, s58, 9
  s_add_u32 m0, s53, 16384
  s_mul_i32 s56, s56, s55
  buffer_load_dwordx4 v1, s[44:47], s56 offen lds
  v_mfma_f32_32x32x16_bf16 v[80:95], v[52:55], v[164:167], v[80:95]
  v_and_b32 v29, s27, v170
  v_lshlrev_b32 v30, 16, v171
  v_and_b32 v31, s27, v171
  v_add_f32 v24, v7, v24
  v_add_f32 v25, v7, v25
  v_mfma_f32_32x32x16_bf16 v[96:111], v[56:59], v[164:167], v[96:111]
  v_add_f32 v26, v7, v26
  v_add_f32 v27, v7, v27
  v_add_f32 v28, v7, v28
  v_add_f32 v29, v7, v29
  v_add_f32 v30, v7, v30
  s_add_u32 m0, s53, 17408
  s_nop 0
  buffer_load_dwordx4 v4, s[44:47], s56 offen lds
  v_mfma_f32_32x32x16_bf16 v[112:127], v[60:63], v[164:167], v[112:127]
  v_add_f32 v31, v7, v31
  v_cvt_pk_bf16_f32 v168, v24, v25
  v_cvt_pk_bf16_f32 v169, v26, v27
  v_cvt_pk_bf16_f32 v170, v28, v29
  v_cvt_pk_bf16_f32 v171, v30, v31
  ds_read_b32 v0, v3
  ds_read_b64_tr_b16 v[48:49], v20 offset:20480
  ds_read_b64_tr_b16 v[50:51], v20 offset:21504
  ds_read_b64_tr_b16 v[52:53], v21 offset:20480
  ds_read_b64_tr_b16 v[54:55], v21 offset:21504
  ds_read_b64_tr_b16 v[56:57], v22 offset:20480
  ds_read_b64_tr_b16 v[58:59], v22 offset:21504
  ds_read_b64_tr_b16 v[60:61], v23 offset:20480
  ds_read_b64_tr_b16 v[62:63], v23 offset:21504
  s_waitcnt lgkmcnt(8)
  s_waitcnt vmcnt(4)
  v_mov_b32 v10, 6
  ds_write_b32 v11, v10
  v_mfma_f32_32x32x16_bf16 v[64:79], v[32:35], v[168:171], v[64:79]
  v_lshlrev_b32 v24, 16, v172
  v_and_b32 v25, s27, v172
  v_lshlrev_b32 v26, 16, v173
  v_and_b32 v27, s27, v173
  v_lshlrev_b32 v28, 16, v174
  s_xor_b32 s56, s58, 10
  s_add_u32 m0, s53, 32768
  s_mul_i32 s56, s56, s55
  buffer_load_dwordx4 v1, s[44:47], s56 offen lds
  v_mfma_f32_32x32x16_bf16 v[80:95], v[36:39], v[168:171], v[80:95]
  v_and_b32 v29, s27, v174
  v_lshlrev_b32 v30, 16, v175
  v_and_b32 v31, s27, v175
  v_add_f32 v24, v7, v24
  v_add_f32 v25, v7, v25
  v_mfma_f32_32x32x16_bf16 v[96:111], v[40:43], v[168:171], v[96:111]
  v_add_f32 v26, v7, v26
  v_add_f32 v27, v7, v27
  v_add_f32 v28, v7, v28
  v_add_f32 v29, v7, v29
  v_add_f32 v30, v7, v30
  s_add_u32 m0, s53, 33792
  s_nop 0
  buffer_load_dwordx4 v4, s[44:47], s56 offen lds
  v_mfma_f32_32x32x16_bf16 v[112:127], v[44:47], v[168:171], v[112:127]
  v_add_f32 v31, v7, v31
  v_cvt_pk_bf16_f32 v172, v24, v25
  v_cvt_pk_bf16_f32 v173, v26, v27
  v_cvt_pk_bf16_f32 v174, v28, v29
  v_cvt_pk_bf16_f32 v175, v30, v31
k1_spin1_5:
  v_cmp_gt_u32 vcc, 5, v0
  s_cbranch_vccz k1_ok1_5
  ds_read_b32 v0, v3
  s_waitcnt lgkmcnt(0)
  s_branch k1_spin1_5
k1_ok1_5:

  ds_read_b64_tr_b16 v[32:33], v20 offset:32768
  ds_read_b64_tr_b16 v[34:35], v20 offset:33792
  ds_read_b64_tr_b16 v[36:37], v21 offset:32768
  ds_read_b64_tr_b16 v[38:39], v21 offset:33792
  ds_read_b64_tr_b16 v[40:41], v22 offset:32768
  ds_read_b64_tr_b16 v[42:43], v22 offset:33792
  ds_read_b64_tr_b16 v[44:45], v23 offset:32768
  ds_read_b64_tr_b16 v[46:47], v23 offset:33792
  s_waitcnt lgkmcnt(8)
  v_mfma_f32_32x32x16_bf16 v[64:79], v[48:51], v[172:175], v[64:79]
  v_lshlrev_b32 v24, 16, v176
  v_and_b32 v25, s27, v176
  v_lshlrev_b32 v26, 16, v177
  v_and_b32 v27, s27, v177
  v_lshlrev_b32 v28, 16, v178
  s_xor_b32 s56, s58, 11
  s_add_u32 m0, s53, 49152
  s_mul_i32 s56, s56, s55
  buffer_load_dwordx4 v1, s[44:47], s56 offen lds
  v_mfma_f32_32x32x16_bf16 v[80:95], v[52:55], v[172:175], v[80:95]
  v_and_b32 v29, s27, v178
  v_lshlrev_b32 v30, 16, v179
  v_and_b32 v31, s27, v179
  v_add_f32 v24, v7, v24
  v_add_f32 v25, v7, v25
  v_mfma_f32_32x32x16_bf16 v[96:111], v[56:59], v[172:175], v[96:111]
  v_add_f32 v26, v7, v26
  v_add_f32 v27, v7, v27
  v_add_f32 v28, v7, v28
  v_add_f32 v29, v7, v29
  v_add_f32 v30, v7, v30
  s_add_u32 m0, s53, 50176
  s_nop 0
  buffer_load_dwordx4 v4, s[44:47], s56 offen lds
  v_mfma_f32_32x32x16_bf16 v[112:127], v[60:63], v[172:175], v[112:127]
  v_add_f32 v31, v7, v31
  v_cvt_pk_bf16_f32 v176, v24, v25
  v_cvt_pk_bf16_f32 v177, v26, v27
  v_cvt_pk_bf16_f32 v178, v28, v29
  v_cvt_pk_bf16_f32 v179, v30, v31
  ds_read_b32 v0, v3
  ds_read_b64_tr_b16 v[48:49], v20 offset:36864
  ds_read_b64_tr_b16 v[50:51], v20 offset:37888
  ds_read_b64_tr_b16 v[52:53], v21 offset:36864
  ds_read_b64_tr_b16 v[54:55], v21 offset:37888
  ds_read_b64_tr_b16 v[56:57], v22 offset:36864
  ds_read_b64_tr_b16 v[58:59], v22 offset:37888
  ds_read_b64_tr_b16 v[60:61], v23 offset:36864
  ds_read_b64_tr_b16 v[62:63], v23 offset:37888
  s_waitcnt lgkmcnt(8)
  s_waitcnt vmcnt(6)
  v_mov_b32 v10, 7
  ds_write_b32 v11, v10
  v_mfma_f32_32x32x16_bf16 v[64:79], v[32:35], v[176:179], v[64:79]
  v_lshlrev_b32 v24, 16, v180
  v_and_b32 v25, s27, v180
  v_lshlrev_b32 v26, 16, v181
  v_and_b32 v27, s27, v181
  v_lshlrev_b32 v28, 16, v182
  v_mfma_f32_32x32x16_bf16 v[80:95], v[36:39], v[176:179], v[80:95]
  v_and_b32 v29, s27, v182
  v_lshlrev_b32 v30, 16, v183
  v_and_b32 v31, s27, v183
  v_add_f32 v24, v7, v24
  v_add_f32 v25, v7, v25
  v_mfma_f32_32x32x16_bf16 v[96:111], v[40:43], v[176:179], v[96:111]
  v_add_f32 v26, v7, v26
  v_add_f32 v27, v7, v27
  v_add_f32 v28, v7, v28
  v_add_f32 v29, v7, v29
  v_add_f32 v30, v7, v30
  v_mfma_f32_32x32x16_bf16 v[112:127], v[44:47], v[176:179], v[112:127]
  v_add_f32 v31, v7, v31
  v_cvt_pk_bf16_f32 v180, v24, v25
  v_cvt_pk_bf16_f32 v181, v26, v27
  v_cvt_pk_bf16_f32 v182, v28, v29
  v_cvt_pk_bf16_f32 v183, v30, v31
k1_spin1_6:
  v_cmp_gt_u32 vcc, 6, v0
  s_cbranch_vccz k1_ok1_6
  ds_read_b32 v0, v3
  s_waitcnt lgkmcnt(0)
  s_branch k1_spin1_6
k1_ok1_6:

  s_mov_b32 s57, 0
k1_nn1:
  v_readfirstlane_b32 s6, v5
  s_cmp_lg_u32 s6, 0
  s_cbranch_scc1 k1_nh1
  s_add_u32 s57, s57, 1
  s_cmp_ge_u32 s57, 0x8000
  s_cbranch_scc1 k1_nh1
  v_mov_b32 v5, 0
  global_load_dword v5, v5, s[68:69] sc1
  s_waitcnt vmcnt(0)
  s_branch k1_nn1
k1_nh1:

  ds_read_b64_tr_b16 v[32:33], v20 offset:49152
  ds_read_b64_tr_b16 v[34:35], v20 offset:50176
  ds_read_b64_tr_b16 v[36:37], v21 offset:49152
  ds_read_b64_tr_b16 v[38:39], v21 offset:50176
  ds_read_b64_tr_b16 v[40:41], v22 offset:49152
  ds_read_b64_tr_b16 v[42:43], v22 offset:50176
  ds_read_b64_tr_b16 v[44:45], v23 offset:49152
  ds_read_b64_tr_b16 v[46:47], v23 offset:50176
  s_waitcnt lgkmcnt(8)
  v_mfma_f32_32x32x16_bf16 v[64:79], v[48:51], v[180:183], v[64:79]
  v_lshlrev_b32 v24, 16, v184
  v_and_b32 v25, s27, v184
  v_lshlrev_b32 v26, 16, v185
  v_and_b32 v27, s27, v185
  v_lshlrev_b32 v28, 16, v186
  s_xor_b32 s56, s58, 12
  s_add_u32 m0, s53, 98304
  s_mul_i32 s56, s56, s55
  buffer_load_dwordx4 v1, s[44:47], s56 offen lds
  v_mfma_f32_32x32x16_bf16 v[80:95], v[52:55], v[180:183], v[80:95]
  v_and_b32 v29, s27, v186
  v_lshlrev_b32 v30, 16, v187
  v_and_b32 v31, s27, v187
  v_add_f32 v24, v7, v24
  v_add_f32 v25, v7, v25
  v_mfma_f32_32x32x16_bf16 v[96:111], v[56:59], v[180:183], v[96:111]
  v_add_f32 v26, v7, v26
  v_add_f32 v27, v7, v27
  v_add_f32 v28, v7, v28
  v_add_f32 v29, v7, v29
  v_add_f32 v30, v7, v30
  s_add_u32 m0, s53, 99328
  s_nop 0
  buffer_load_dwordx4 v4, s[44:47], s56 offen lds
  v_mfma_f32_32x32x16_bf16 v[112:127], v[60:63], v[180:183], v[112:127]
  v_add_f32 v31, v7, v31
  v_cvt_pk_bf16_f32 v184, v24, v25
  v_cvt_pk_bf16_f32 v185, v26, v27
  v_cvt_pk_bf16_f32 v186, v28, v29
  v_cvt_pk_bf16_f32 v187, v30, v31
  ds_read_b32 v0, v3
  ds_read_b64_tr_b16 v[48:49], v20 offset:53248
  ds_read_b64_tr_b16 v[50:51], v20 offset:54272
  ds_read_b64_tr_b16 v[52:53], v21 offset:53248
  ds_read_b64_tr_b16 v[54:55], v21 offset:54272
  ds_read_b64_tr_b16 v[56:57], v22 offset:53248
  ds_read_b64_tr_b16 v[58:59], v22 offset:54272
  ds_read_b64_tr_b16 v[60:61], v23 offset:53248
  ds_read_b64_tr_b16 v[62:63], v23 offset:54272
  s_waitcnt lgkmcnt(8)
  s_waitcnt vmcnt(6)
  v_mov_b32 v10, 8
  ds_write_b32 v11, v10
  v_mfma_f32_32x32x16_bf16 v[64:79], v[32:35], v[184:187], v[64:79]
  v_lshlrev_b32 v24, 16, v188
  v_and_b32 v25, s27, v188
  v_lshlrev_b32 v26, 16, v189
  v_and_b32 v27, s27, v189
  v_lshlrev_b32 v28, 16, v190
  v_mfma_f32_32x32x16_bf16 v[80:95], v[36:39], v[184:187], v[80:95]
  v_and_b32 v29, s27, v190
  v_lshlrev_b32 v30, 16, v191
  v_and_b32 v31, s27, v191
  v_add_f32 v24, v7, v24
  v_add_f32 v25, v7, v25
  v_mfma_f32_32x32x16_bf16 v[96:111], v[40:43], v[184:187], v[96:111]
  v_add_f32 v26, v7, v26
  v_add_f32 v27, v7, v27
  v_add_f32 v28, v7, v28
  v_add_f32 v29, v7, v29
  v_add_f32 v30, v7, v30
  v_mfma_f32_32x32x16_bf16 v[112:127], v[44:47], v[184:187], v[112:127]
  v_add_f32 v31, v7, v31
  v_cvt_pk_bf16_f32 v188, v24, v25
  v_cvt_pk_bf16_f32 v189, v26, v27
  v_cvt_pk_bf16_f32 v190, v28, v29
  v_cvt_pk_bf16_f32 v191, v30, v31
k1_spin1_7:
  v_cmp_gt_u32 vcc, 7, v0
  s_cbranch_vccz k1_ok1_7
  ds_read_b32 v0, v3
  s_waitcnt lgkmcnt(0)
  s_branch k1_spin1_7
k1_ok1_7:

  ds_read_b64_tr_b16 v[32:33], v16 offset:0
  ds_read_b64_tr_b16 v[34:35], v16 offset:1024
  ds_read_b64_tr_b16 v[36:37], v17 offset:0
  ds_read_b64_tr_b16 v[38:39], v17 offset:1024
  ds_read_b64_tr_b16 v[40:41], v18 offset:0
  ds_read_b64_tr_b16 v[42:43], v18 offset:1024
  ds_read_b64_tr_b16 v[44:45], v19 offset:0
  ds_read_b64_tr_b16 v[46:47], v19 offset:1024
  s_waitcnt lgkmcnt(8)
  v_mfma_f32_32x32x16_bf16 v[64:79], v[48:51], v[188:191], v[64:79]
  v_lshlrev_b32 v24, 16, v192
  v_and_b32 v25, s27, v192
  v_lshlrev_b32 v26, 16, v193
  v_and_b32 v27, s27, v193
  v_lshlrev_b32 v28, 16, v194
  s_xor_b32 s56, s58, 13
  s_add_u32 m0, s53, 114688
  s_mul_i32 s56, s56, s55
  buffer_load_dwordx4 v1, s[44:47], s56 offen lds
  v_mfma_f32_32x32x16_bf16 v[80:95], v[52:55], v[188:191], v[80:95]
  v_and_b32 v29, s27, v194
  v_lshlrev_b32 v30, 16, v195
  v_and_b32 v31, s27, v195
  v_add_f32 v24, v7, v24
  v_add_f32 v25, v7, v25
  v_mfma_f32_32x32x16_bf16 v[96:111], v[56:59], v[188:191], v[96:111]
  v_add_f32 v26, v7, v26
  v_add_f32 v27, v7, v27
  v_add_f32 v28, v7, v28
  v_add_f32 v29, v7, v29
  v_add_f32 v30, v7, v30
  s_add_u32 m0, s53, 115712
  s_nop 0
  buffer_load_dwordx4 v4, s[44:47], s56 offen lds
  v_mfma_f32_32x32x16_bf16 v[112:127], v[60:63], v[188:191], v[112:127]
  v_add_f32 v31, v7, v31
  v_cvt_pk_bf16_f32 v192, v24, v25
  v_cvt_pk_bf16_f32 v193, v26, v27
  v_cvt_pk_bf16_f32 v194, v28, v29
  v_cvt_pk_bf16_f32 v195, v30, v31
  ds_read_b32 v0, v3
  ds_read_b64_tr_b16 v[48:49], v16 offset:4096
  ds_read_b64_tr_b16 v[50:51], v16 offset:5120
  ds_read_b64_tr_b16 v[52:53], v17 offset:4096
  ds_read_b64_tr_b16 v[54:55], v17 offset:5120
  ds_read_b64_tr_b16 v[56:57], v18 offset:4096
  ds_read_b64_tr_b16 v[58:59], v18 offset:5120
  ds_read_b64_tr_b16 v[60:61], v19 offset:4096
  ds_read_b64_tr_b16 v[62:63], v19 offset:5120
  s_waitcnt lgkmcnt(8)
  s_waitcnt vmcnt(6)
  v_mov_b32 v10, 9
  ds_write_b32 v11, v10
  v_mfma_f32_32x32x16_bf16 v[64:79], v[32:35], v[192:195], v[64:79]
  v_lshlrev_b32 v24, 16, v196
  v_and_b32 v25, s27, v196
  v_lshlrev_b32 v26, 16, v197
  v_and_b32 v27, s27, v197
  v_lshlrev_b32 v28, 16, v198
  v_mfma_f32_32x32x16_bf16 v[80:95], v[36:39], v[192:195], v[80:95]
  v_and_b32 v29, s27, v198
  v_lshlrev_b32 v30, 16, v199
  v_and_b32 v31, s27, v199
  v_add_f32 v24, v7, v24
  v_add_f32 v25, v7, v25
  buffer_load_dwordx4 v[12:15], v9, s[28:31], s62 offen offset:0
  v_mfma_f32_32x32x16_bf16 v[96:111], v[40:43], v[192:195], v[96:111]
  v_add_f32 v26, v7, v26
  v_add_f32 v27, v7, v27
  v_add_f32 v28, v7, v28
  v_add_f32 v29, v7, v29
  v_add_f32 v30, v7, v30
  v_mfma_f32_32x32x16_bf16 v[112:127], v[44:47], v[192:195], v[112:127]
  v_add_f32 v31, v7, v31
  v_cvt_pk_bf16_f32 v196, v24, v25
  v_cvt_pk_bf16_f32 v197, v26, v27
  v_cvt_pk_bf16_f32 v198, v28, v29
  v_cvt_pk_bf16_f32 v199, v30, v31
k1_spin1_8:
  v_cmp_gt_u32 vcc, 8, v0
  s_cbranch_vccz k1_ok1_8
  ds_read_b32 v0, v3
  s_waitcnt lgkmcnt(0)
  s_branch k1_spin1_8
k1_ok1_8:

  ds_read_b64_tr_b16 v[32:33], v16 offset:16384
  ds_read_b64_tr_b16 v[34:35], v16 offset:17408
  ds_read_b64_tr_b16 v[36:37], v17 offset:16384
  ds_read_b64_tr_b16 v[38:39], v17 offset:17408
  ds_read_b64_tr_b16 v[40:41], v18 offset:16384
  ds_read_b64_tr_b16 v[42:43], v18 offset:17408
  ds_read_b64_tr_b16 v[44:45], v19 offset:16384
  ds_read_b64_tr_b16 v[46:47], v19 offset:17408
  s_waitcnt lgkmcnt(8)
  v_mfma_f32_32x32x16_bf16 v[64:79], v[48:51], v[196:199], v[64:79]
  v_lshlrev_b32 v24, 16, v200
  v_and_b32 v25, s27, v200
  v_lshlrev_b32 v26, 16, v201
  v_and_b32 v27, s27, v201
  v_lshlrev_b32 v28, 16, v202
  s_xor_b32 s56, s58, 14
  s_add_u32 m0, s53, 131072
  s_mul_i32 s56, s56, s55
  buffer_load_dwordx4 v1, s[44:47], s56 offen lds
  v_mfma_f32_32x32x16_bf16 v[80:95], v[52:55], v[196:199], v[80:95]
  v_and_b32 v29, s27, v202
  v_lshlrev_b32 v30, 16, v203
  v_and_b32 v31, s27, v203
  v_add_f32 v24, v7, v24
  v_add_f32 v25, v7, v25
  buffer_load_dwordx4 v[12:15], v9, s[28:31], s62 offen offset:1024
  v_mfma_f32_32x32x16_bf16 v[96:111], v[56:59], v[196:199], v[96:111]
  v_add_f32 v26, v7, v26
  v_add_f32 v27, v7, v27
  v_add_f32 v28, v7, v28
  v_add_f32 v29, v7, v29
  v_add_f32 v30, v7, v30
  s_add_u32 m0, s53, 132096
  s_nop 0
  buffer_load_dwordx4 v4, s[44:47], s56 offen lds
  v_mfma_f32_32x32x16_bf16 v[112:127], v[60:63], v[196:199], v[112:127]
  v_add_f32 v31, v7, v31
  v_cvt_pk_bf16_f32 v200, v24, v25
  v_cvt_pk_bf16_f32 v201, v26, v27
  v_cvt_pk_bf16_f32 v202, v28, v29
  v_cvt_pk_bf16_f32 v203, v30, v31
  ds_read_b32 v0, v3
  ds_read_b64_tr_b16 v[48:49], v16 offset:20480
  ds_read_b64_tr_b16 v[50:51], v16 offset:21504
  ds_read_b64_tr_b16 v[52:53], v17 offset:20480
  ds_read_b64_tr_b16 v[54:55], v17 offset:21504
  ds_read_b64_tr_b16 v[56:57], v18 offset:20480
  ds_read_b64_tr_b16 v[58:59], v18 offset:21504
  ds_read_b64_tr_b16 v[60:61], v19 offset:20480
  ds_read_b64_tr_b16 v[62:63], v19 offset:21504
  s_waitcnt lgkmcnt(8)
  s_waitcnt vmcnt(8)
  v_mov_b32 v10, 10
  ds_write_b32 v11, v10
  v_mfma_f32_32x32x16_bf16 v[64:79], v[32:35], v[200:203], v[64:79]
  v_lshlrev_b32 v24, 16, v204
  v_and_b32 v25, s27, v204
  v_lshlrev_b32 v26, 16, v205
  v_and_b32 v27, s27, v205
  v_lshlrev_b32 v28, 16, v206
  v_mfma_f32_32x32x16_bf16 v[80:95], v[36:39], v[200:203], v[80:95]
  v_and_b32 v29, s27, v206
  v_lshlrev_b32 v30, 16, v207
  v_and_b32 v31, s27, v207
  v_add_f32 v24, v7, v24
  v_add_f32 v25, v7, v25
  buffer_load_dwordx4 v[12:15], v9, s[28:31], s62 offen offset:2048
  v_mfma_f32_32x32x16_bf16 v[96:111], v[40:43], v[200:203], v[96:111]
  v_add_f32 v26, v7, v26
  v_add_f32 v27, v7, v27
  v_add_f32 v28, v7, v28
  v_add_f32 v29, v7, v29
  v_add_f32 v30, v7, v30
  v_mfma_f32_32x32x16_bf16 v[112:127], v[44:47], v[200:203], v[112:127]
  v_add_f32 v31, v7, v31
  v_cvt_pk_bf16_f32 v204, v24, v25
  v_cvt_pk_bf16_f32 v205, v26, v27
  v_cvt_pk_bf16_f32 v206, v28, v29
  v_cvt_pk_bf16_f32 v207, v30, v31
k1_spin1_9:
  v_cmp_gt_u32 vcc, 9, v0
  s_cbranch_vccz k1_ok1_9
  ds_read_b32 v0, v3
  s_waitcnt lgkmcnt(0)
  s_branch k1_spin1_9
k1_ok1_9:

  ds_read_b64_tr_b16 v[32:33], v16 offset:32768
  ds_read_b64_tr_b16 v[34:35], v16 offset:33792
  ds_read_b64_tr_b16 v[36:37], v17 offset:32768
  ds_read_b64_tr_b16 v[38:39], v17 offset:33792
  ds_read_b64_tr_b16 v[40:41], v18 offset:32768
  ds_read_b64_tr_b16 v[42:43], v18 offset:33792
  ds_read_b64_tr_b16 v[44:45], v19 offset:32768
  ds_read_b64_tr_b16 v[46:47], v19 offset:33792
  s_waitcnt lgkmcnt(8)
  v_mfma_f32_32x32x16_bf16 v[64:79], v[48:51], v[204:207], v[64:79]
  v_lshlrev_b32 v24, 16, v208
  v_and_b32 v25, s27, v208
  v_lshlrev_b32 v26, 16, v209
  v_and_b32 v27, s27, v209
  v_lshlrev_b32 v28, 16, v210
  s_xor_b32 s56, s58, 15
  s_add_u32 m0, s53, 147456
  s_mul_i32 s56, s56, s55
  buffer_load_dwordx4 v1, s[44:47], s56 offen lds
  v_mfma_f32_32x32x16_bf16 v[80:95], v[52:55], v[204:207], v[80:95]
  v_and_b32 v29, s27, v210
  v_lshlrev_b32 v30, 16, v211
  v_and_b32 v31, s27, v211
  v_add_f32 v24, v7, v24
  v_add_f32 v25, v7, v25
  buffer_load_dwordx4 v[12:15], v9, s[28:31], s62 offen offset:3072
  s_add_u32 s62, s62, 4096
  v_mfma_f32_32x32x16_bf16 v[96:111], v[56:59], v[204:207], v[96:111]
  v_add_f32 v26, v7, v26
  v_add_f32 v27, v7, v27
  v_add_f32 v28, v7, v28
  v_add_f32 v29, v7, v29
  v_add_f32 v30, v7, v30
  s_add_u32 m0, s53, 148480
  s_nop 0
  buffer_load_dwordx4 v4, s[44:47], s56 offen lds
  v_mfma_f32_32x32x16_bf16 v[112:127], v[60:63], v[204:207], v[112:127]
  v_add_f32 v31, v7, v31
  v_cvt_pk_bf16_f32 v208, v24, v25
  v_cvt_pk_bf16_f32 v209, v26, v27
  v_cvt_pk_bf16_f32 v210, v28, v29
  v_cvt_pk_bf16_f32 v211, v30, v31
  ds_read_b32 v0, v3
  ds_read_b64_tr_b16 v[48:49], v16 offset:36864
  ds_read_b64_tr_b16 v[50:51], v16 offset:37888
  ds_read_b64_tr_b16 v[52:53], v17 offset:36864
  ds_read_b64_tr_b16 v[54:55], v17 offset:37888
  ds_read_b64_tr_b16 v[56:57], v18 offset:36864
  ds_read_b64_tr_b16 v[58:59], v18 offset:37888
  ds_read_b64_tr_b16 v[60:61], v19 offset:36864
  ds_read_b64_tr_b16 v[62:63], v19 offset:37888
  s_waitcnt lgkmcnt(8)
  s_waitcnt vmcnt(10)
  v_mov_b32 v10, 11
  ds_write_b32 v11, v10
  v_mfma_f32_32x32x16_bf16 v[64:79], v[32:35], v[208:211], v[64:79]
  v_lshlrev_b32 v24, 16, v212
  v_and_b32 v25, s27, v212
  v_lshlrev_b32 v26, 16, v213
  v_and_b32 v27, s27, v213
  v_lshlrev_b32 v28, 16, v214
  v_mfma_f32_32x32x16_bf16 v[80:95], v[36:39], v[208:211], v[80:95]
  v_and_b32 v29, s27, v214
  v_lshlrev_b32 v30, 16, v215
  v_and_b32 v31, s27, v215
  v_add_f32 v24, v7, v24
  v_add_f32 v25, v7, v25
  buffer_load_dwordx4 v[12:15], v9, s[28:31], s62 offen offset:0
  v_mfma_f32_32x32x16_bf16 v[96:111], v[40:43], v[208:211], v[96:111]
  v_add_f32 v26, v7, v26
  v_add_f32 v27, v7, v27
  v_add_f32 v28, v7, v28
  v_add_f32 v29, v7, v29
  v_add_f32 v30, v7, v30
  v_mfma_f32_32x32x16_bf16 v[112:127], v[44:47], v[208:211], v[112:127]
  v_add_f32 v31, v7, v31
  v_cvt_pk_bf16_f32 v212, v24, v25
  v_cvt_pk_bf16_f32 v213, v26, v27
  v_cvt_pk_bf16_f32 v214, v28, v29
  v_cvt_pk_bf16_f32 v215, v30, v31
k1_spin1_10:
  v_cmp_gt_u32 vcc, 10, v0
  s_cbranch_vccz k1_ok1_10
  ds_read_b32 v0, v3
  s_waitcnt lgkmcnt(0)
  s_branch k1_spin1_10
k1_ok1_10:

  ds_read_b64_tr_b16 v[32:33], v16 offset:49152
  ds_read_b64_tr_b16 v[34:35], v16 offset:50176
  ds_read_b64_tr_b16 v[36:37], v17 offset:49152
  ds_read_b64_tr_b16 v[38:39], v17 offset:50176
  ds_read_b64_tr_b16 v[40:41], v18 offset:49152
  ds_read_b64_tr_b16 v[42:43], v18 offset:50176
  ds_read_b64_tr_b16 v[44:45], v19 offset:49152
  ds_read_b64_tr_b16 v[46:47], v19 offset:50176
  s_waitcnt lgkmcnt(8)
  v_mfma_f32_32x32x16_bf16 v[64:79], v[48:51], v[212:215], v[64:79]
  v_lshlrev_b32 v24, 16, v216
  v_and_b32 v25, s27, v216
  v_lshlrev_b32 v26, 16, v217
  v_and_b32 v27, s27, v217
  v_lshlrev_b32 v28, 16, v218
  v_mfma_f32_32x32x16_bf16 v[80:95], v[52:55], v[212:215], v[80:95]
  v_and_b32 v29, s27, v218
  v_lshlrev_b32 v30, 16, v219
  v_and_b32 v31, s27, v219
  v_add_f32 v24, v7, v24
  v_add_f32 v25, v7, v25
  buffer_load_dwordx4 v[12:15], v9, s[28:31], s62 offen offset:1024
  v_mfma_f32_32x32x16_bf16 v[96:111], v[56:59], v[212:215], v[96:111]
  v_add_f32 v26, v7, v26
  v_add_f32 v27, v7, v27
  v_add_f32 v28, v7, v28
  v_add_f32 v29, v7, v29
  v_add_f32 v30, v7, v30
  v_mfma_f32_32x32x16_bf16 v[112:127], v[60:63], v[212:215], v[112:127]
  v_add_f32 v31, v7, v31
  v_cvt_pk_bf16_f32 v216, v24, v25
  v_cvt_pk_bf16_f32 v217, v26, v27
  v_cvt_pk_bf16_f32 v218, v28, v29
  v_cvt_pk_bf16_f32 v219, v30, v31
  ds_read_b32 v0, v3
  ds_read_b64_tr_b16 v[48:49], v16 offset:53248
  ds_read_b64_tr_b16 v[50:51], v16 offset:54272
  ds_read_b64_tr_b16 v[52:53], v17 offset:53248
  ds_read_b64_tr_b16 v[54:55], v17 offset:54272
  ds_read_b64_tr_b16 v[56:57], v18 offset:53248
  ds_read_b64_tr_b16 v[58:59], v18 offset:54272
  ds_read_b64_tr_b16 v[60:61], v19 offset:53248
  ds_read_b64_tr_b16 v[62:63], v19 offset:54272
  s_waitcnt lgkmcnt(8)
  s_waitcnt vmcnt(10)
  v_mov_b32 v10, 12
  ds_write_b32 v11, v10
  v_mfma_f32_32x32x16_bf16 v[64:79], v[32:35], v[216:219], v[64:79]
  v_lshlrev_b32 v24, 16, v220
  v_and_b32 v25, s27, v220
  v_lshlrev_b32 v26, 16, v221
  v_and_b32 v27, s27, v221
  v_lshlrev_b32 v28, 16, v222
  v_mfma_f32_32x32x16_bf16 v[80:95], v[36:39], v[216:219], v[80:95]
  v_and_b32 v29, s27, v222
  v_lshlrev_b32 v30, 16, v223
  v_and_b32 v31, s27, v223
  v_add_f32 v24, v7, v24
  v_add_f32 v25, v7, v25
  buffer_load_dwordx4 v[12:15], v9, s[28:31], s62 offen offset:2048
  v_mfma_f32_32x32x16_bf16 v[96:111], v[40:43], v[216:219], v[96:111]
  v_add_f32 v26, v7, v26
  v_add_f32 v27, v7, v27
  v_add_f32 v28, v7, v28
  v_add_f32 v29, v7, v29
  v_add_f32 v30, v7, v30
  v_mfma_f32_32x32x16_bf16 v[112:127], v[44:47], v[216:219], v[112:127]
  v_add_f32 v31, v7, v31
  v_cvt_pk_bf16_f32 v220, v24, v25
  v_cvt_pk_bf16_f32 v221, v26, v27
  v_cvt_pk_bf16_f32 v222, v28, v29
  v_cvt_pk_bf16_f32 v223, v30, v31
k1_spin1_11:
  v_cmp_gt_u32 vcc, 11, v0
  s_cbranch_vccz k1_ok1_11
  ds_read_b32 v0, v3
  s_waitcnt lgkmcnt(0)
  s_branch k1_spin1_11
k1_ok1_11:

  ds_read_b64_tr_b16 v[32:33], v20 offset:0
  ds_read_b64_tr_b16 v[34:35], v20 offset:1024
  ds_read_b64_tr_b16 v[36:37], v21 offset:0
  ds_read_b64_tr_b16 v[38:39], v21 offset:1024
  ds_read_b64_tr_b16 v[40:41], v22 offset:0
  ds_read_b64_tr_b16 v[42:43], v22 offset:1024
  ds_read_b64_tr_b16 v[44:45], v23 offset:0
  ds_read_b64_tr_b16 v[46:47], v23 offset:1024
  s_waitcnt lgkmcnt(8)
  v_mfma_f32_32x32x16_bf16 v[64:79], v[48:51], v[220:223], v[64:79]
  v_lshlrev_b32 v24, 16, v224
  v_and_b32 v25, s27, v224
  v_lshlrev_b32 v26, 16, v225
  v_and_b32 v27, s27, v225
  v_lshlrev_b32 v28, 16, v226
  v_mfma_f32_32x32x16_bf16 v[80:95], v[52:55], v[220:223], v[80:95]
  v_and_b32 v29, s27, v226
  v_lshlrev_b32 v30, 16, v227
  v_and_b32 v31, s27, v227
  v_add_f32 v24, v7, v24
  v_add_f32 v25, v7, v25
  buffer_load_dwordx4 v[12:15], v9, s[32:35], s63 offen offset:0
  v_mfma_f32_32x32x16_bf16 v[96:111], v[56:59], v[220:223], v[96:111]
  v_add_f32 v26, v7, v26
  v_add_f32 v27, v7, v27
  v_add_f32 v28, v7, v28
  v_add_f32 v29, v7, v29
  v_add_f32 v30, v7, v30
  v_mfma_f32_32x32x16_bf16 v[112:127], v[60:63], v[220:223], v[112:127]
  v_add_f32 v31, v7, v31
  v_cvt_pk_bf16_f32 v224, v24, v25
  v_cvt_pk_bf16_f32 v225, v26, v27
  v_cvt_pk_bf16_f32 v226, v28, v29
  v_cvt_pk_bf16_f32 v227, v30, v31
  ds_read_b32 v0, v3
  ds_read_b64_tr_b16 v[48:49], v20 offset:4096
  ds_read_b64_tr_b16 v[50:51], v20 offset:5120
  ds_read_b64_tr_b16 v[52:53], v21 offset:4096
  ds_read_b64_tr_b16 v[54:55], v21 offset:5120
  ds_read_b64_tr_b16 v[56:57], v22 offset:4096
  ds_read_b64_tr_b16 v[58:59], v22 offset:5120
  ds_read_b64_tr_b16 v[60:61], v23 offset:4096
  ds_read_b64_tr_b16 v[62:63], v23 offset:5120
  s_waitcnt lgkmcnt(8)
  s_waitcnt vmcnt(8)
  v_mov_b32 v10, 13
  ds_write_b32 v11, v10
  v_mfma_f32_32x32x16_bf16 v[64:79], v[32:35], v[224:227], v[64:79]
  v_lshlrev_b32 v24, 16, v228
  v_and_b32 v25, s27, v228
  v_lshlrev_b32 v26, 16, v229
  v_and_b32 v27, s27, v229
  v_lshlrev_b32 v28, 16, v230
  v_mfma_f32_32x32x16_bf16 v[80:95], v[36:39], v[224:227], v[80:95]
  v_and_b32 v29, s27, v230
  v_lshlrev_b32 v30, 16, v231
  v_and_b32 v31, s27, v231
  v_add_f32 v24, v7, v24
  v_add_f32 v25, v7, v25
  buffer_load_dwordx4 v[12:15], v9, s[32:35], s63 offen offset:1024
  v_mfma_f32_32x32x16_bf16 v[96:111], v[40:43], v[224:227], v[96:111]
  v_add_f32 v26, v7, v26
  v_add_f32 v27, v7, v27
  v_add_f32 v28, v7, v28
  v_add_f32 v29, v7, v29
  v_add_f32 v30, v7, v30
  v_mfma_f32_32x32x16_bf16 v[112:127], v[44:47], v[224:227], v[112:127]
  v_add_f32 v31, v7, v31
  v_cvt_pk_bf16_f32 v228, v24, v25
  v_cvt_pk_bf16_f32 v229, v26, v27
  v_cvt_pk_bf16_f32 v230, v28, v29
  v_cvt_pk_bf16_f32 v231, v30, v31
k1_spin1_12:
  v_cmp_gt_u32 vcc, 12, v0
  s_cbranch_vccz k1_ok1_12
  ds_read_b32 v0, v3
  s_waitcnt lgkmcnt(0)
  s_branch k1_spin1_12
k1_ok1_12:

  ds_read_b64_tr_b16 v[32:33], v20 offset:16384
  ds_read_b64_tr_b16 v[34:35], v20 offset:17408
  ds_read_b64_tr_b16 v[36:37], v21 offset:16384
  ds_read_b64_tr_b16 v[38:39], v21 offset:17408
  ds_read_b64_tr_b16 v[40:41], v22 offset:16384
  ds_read_b64_tr_b16 v[42:43], v22 offset:17408
  ds_read_b64_tr_b16 v[44:45], v23 offset:16384
  ds_read_b64_tr_b16 v[46:47], v23 offset:17408
  s_waitcnt lgkmcnt(8)
  v_mfma_f32_32x32x16_bf16 v[64:79], v[48:51], v[228:231], v[64:79]
  v_lshlrev_b32 v24, 16, v232
  v_and_b32 v25, s27, v232
  v_lshlrev_b32 v26, 16, v233
  v_and_b32 v27, s27, v233
  v_lshlrev_b32 v28, 16, v234
  v_mfma_f32_32x32x16_bf16 v[80:95], v[52:55], v[228:231], v[80:95]
  v_and_b32 v29, s27, v234
  v_lshlrev_b32 v30, 16, v235
  v_and_b32 v31, s27, v235
  v_add_f32 v24, v7, v24
  v_add_f32 v25, v7, v25
  buffer_load_dwordx4 v[12:15], v9, s[32:35], s63 offen offset:2048
  v_mfma_f32_32x32x16_bf16 v[96:111], v[56:59], v[228:231], v[96:111]
  v_add_f32 v26, v7, v26
  v_add_f32 v27, v7, v27
  v_add_f32 v28, v7, v28
  v_add_f32 v29, v7, v29
  v_add_f32 v30, v7, v30
  v_mfma_f32_32x32x16_bf16 v[112:127], v[60:63], v[228:231], v[112:127]
  v_add_f32 v31, v7, v31
  v_cvt_pk_bf16_f32 v232, v24, v25
  v_cvt_pk_bf16_f32 v233, v26, v27
  v_cvt_pk_bf16_f32 v234, v28, v29
  v_cvt_pk_bf16_f32 v235, v30, v31
  ds_read_b32 v0, v3
  ds_read_b64_tr_b16 v[48:49], v20 offset:20480
  ds_read_b64_tr_b16 v[50:51], v20 offset:21504
  ds_read_b64_tr_b16 v[52:53], v21 offset:20480
  ds_read_b64_tr_b16 v[54:55], v21 offset:21504
  ds_read_b64_tr_b16 v[56:57], v22 offset:20480
  ds_read_b64_tr_b16 v[58:59], v22 offset:21504
  ds_read_b64_tr_b16 v[60:61], v23 offset:20480
  ds_read_b64_tr_b16 v[62:63], v23 offset:21504
  s_waitcnt lgkmcnt(8)
  s_waitcnt vmcnt(6)
  v_mov_b32 v10, 14
  ds_write_b32 v11, v10
  v_mfma_f32_32x32x16_bf16 v[64:79], v[32:35], v[232:235], v[64:79]
  v_lshlrev_b32 v24, 16, v236
  v_and_b32 v25, s27, v236
  v_lshlrev_b32 v26, 16, v237
  v_and_b32 v27, s27, v237
  v_lshlrev_b32 v28, 16, v238
  v_mfma_f32_32x32x16_bf16 v[80:95], v[36:39], v[232:235], v[80:95]
  v_and_b32 v29, s27, v238
  v_lshlrev_b32 v30, 16, v239
  v_and_b32 v31, s27, v239
  v_add_f32 v24, v7, v24
  v_add_f32 v25, v7, v25
  v_mfma_f32_32x32x16_bf16 v[96:111], v[40:43], v[232:235], v[96:111]
  v_add_f32 v26, v7, v26
  v_add_f32 v27, v7, v27
  v_add_f32 v28, v7, v28
  v_add_f32 v29, v7, v29
  v_add_f32 v30, v7, v30
  v_mfma_f32_32x32x16_bf16 v[112:127], v[44:47], v[232:235], v[112:127]
  v_add_f32 v31, v7, v31
  v_cvt_pk_bf16_f32 v236, v24, v25
  v_cvt_pk_bf16_f32 v237, v26, v27
  v_cvt_pk_bf16_f32 v238, v28, v29
  v_cvt_pk_bf16_f32 v239, v30, v31
k1_spin1_13:
  v_cmp_gt_u32 vcc, 13, v0
  s_cbranch_vccz k1_ok1_13
  ds_read_b32 v0, v3
  s_waitcnt lgkmcnt(0)
  s_branch k1_spin1_13
k1_ok1_13:

  ds_read_b64_tr_b16 v[32:33], v20 offset:32768
  ds_read_b64_tr_b16 v[34:35], v20 offset:33792
  ds_read_b64_tr_b16 v[36:37], v21 offset:32768
  ds_read_b64_tr_b16 v[38:39], v21 offset:33792
  ds_read_b64_tr_b16 v[40:41], v22 offset:32768
  ds_read_b64_tr_b16 v[42:43], v22 offset:33792
  ds_read_b64_tr_b16 v[44:45], v23 offset:32768
  ds_read_b64_tr_b16 v[46:47], v23 offset:33792
  s_waitcnt lgkmcnt(8)
  v_mfma_f32_32x32x16_bf16 v[64:79], v[48:51], v[236:239], v[64:79]
  v_lshlrev_b32 v24, 16, v240
  v_and_b32 v25, s27, v240
  v_lshlrev_b32 v26, 16, v241
  v_and_b32 v27, s27, v241
  v_lshlrev_b32 v28, 16, v242
  v_mfma_f32_32x32x16_bf16 v[80:95], v[52:55], v[236:239], v[80:95]
  v_and_b32 v29, s27, v242
  v_lshlrev_b32 v30, 16, v243
  v_and_b32 v31, s27, v243
  v_add_f32 v24, v7, v24
  v_add_f32 v25, v7, v25
  v_mfma_f32_32x32x16_bf16 v[96:111], v[56:59], v[236:239], v[96:111]
  v_add_f32 v26, v7, v26
  v_add_f32 v27, v7, v27
  v_add_f32 v28, v7, v28
  v_add_f32 v29, v7, v29
  v_add_f32 v30, v7, v30
  v_mfma_f32_32x32x16_bf16 v[112:127], v[60:63], v[236:239], v[112:127]
  v_add_f32 v31, v7, v31
  v_cvt_pk_bf16_f32 v240, v24, v25
  v_cvt_pk_bf16_f32 v241, v26, v27
  v_cvt_pk_bf16_f32 v242, v28, v29
  v_cvt_pk_bf16_f32 v243, v30, v31
  ds_read_b32 v0, v3
  ds_read_b64_tr_b16 v[48:49], v20 offset:36864
  ds_read_b64_tr_b16 v[50:51], v20 offset:37888
  ds_read_b64_tr_b16 v[52:53], v21 offset:36864
  ds_read_b64_tr_b16 v[54:55], v21 offset:37888
  ds_read_b64_tr_b16 v[56:57], v22 offset:36864
  ds_read_b64_tr_b16 v[58:59], v22 offset:37888
  ds_read_b64_tr_b16 v[60:61], v23 offset:36864
  ds_read_b64_tr_b16 v[62:63], v23 offset:37888
  s_waitcnt lgkmcnt(8)
  v_mfma_f32_32x32x16_bf16 v[64:79], v[32:35], v[240:243], v[64:79]
  v_lshlrev_b32 v24, 16, v244
  v_and_b32 v25, s27, v244
  v_lshlrev_b32 v26, 16, v245
  v_and_b32 v27, s27, v245
  v_lshlrev_b32 v28, 16, v246
  v_mfma_f32_32x32x16_bf16 v[80:95], v[36:39], v[240:243], v[80:95]
  v_and_b32 v29, s27, v246
  v_lshlrev_b32 v30, 16, v247
  v_and_b32 v31, s27, v247
  v_add_f32 v24, v7, v24
  v_add_f32 v25, v7, v25
  v_mfma_f32_32x32x16_bf16 v[96:111], v[40:43], v[240:243], v[96:111]
  v_add_f32 v26, v7, v26
  v_add_f32 v27, v7, v27
  v_add_f32 v28, v7, v28
  v_add_f32 v29, v7, v29
  v_add_f32 v30, v7, v30
  v_mfma_f32_32x32x16_bf16 v[112:127], v[44:47], v[240:243], v[112:127]
  v_add_f32 v31, v7, v31
  v_cvt_pk_bf16_f32 v244, v24, v25
  v_cvt_pk_bf16_f32 v245, v26, v27
  v_cvt_pk_bf16_f32 v246, v28, v29
  v_cvt_pk_bf16_f32 v247, v30, v31
k1_spin1_14:
  v_cmp_gt_u32 vcc, 14, v0
  s_cbranch_vccz k1_ok1_14
  ds_read_b32 v0, v3
  s_waitcnt lgkmcnt(0)
  s_branch k1_spin1_14
k1_ok1_14:

  ds_read_b64_tr_b16 v[32:33], v20 offset:49152
  ds_read_b64_tr_b16 v[34:35], v20 offset:50176
  ds_read_b64_tr_b16 v[36:37], v21 offset:49152
  ds_read_b64_tr_b16 v[38:39], v21 offset:50176
  ds_read_b64_tr_b16 v[40:41], v22 offset:49152
  ds_read_b64_tr_b16 v[42:43], v22 offset:50176
  ds_read_b64_tr_b16 v[44:45], v23 offset:49152
  ds_read_b64_tr_b16 v[46:47], v23 offset:50176
  s_waitcnt lgkmcnt(8)
  v_mfma_f32_32x32x16_bf16 v[64:79], v[48:51], v[244:247], v[64:79]
  v_lshlrev_b32 v24, 16, v248
  v_and_b32 v25, s27, v248
  v_lshlrev_b32 v26, 16, v249
  v_and_b32 v27, s27, v249
  v_lshlrev_b32 v28, 16, v250
  v_mfma_f32_32x32x16_bf16 v[80:95], v[52:55], v[244:247], v[80:95]
  v_and_b32 v29, s27, v250
  v_lshlrev_b32 v30, 16, v251
  v_and_b32 v31, s27, v251
  v_add_f32 v24, v7, v24
  v_add_f32 v25, v7, v25
  v_mfma_f32_32x32x16_bf16 v[96:111], v[56:59], v[244:247], v[96:111]
  v_add_f32 v26, v7, v26
  v_add_f32 v27, v7, v27
  v_add_f32 v28, v7, v28
  v_add_f32 v29, v7, v29
  v_add_f32 v30, v7, v30
  v_mfma_f32_32x32x16_bf16 v[112:127], v[60:63], v[244:247], v[112:127]
  v_add_f32 v31, v7, v31
  v_cvt_pk_bf16_f32 v248, v24, v25
  v_cvt_pk_bf16_f32 v249, v26, v27
  v_cvt_pk_bf16_f32 v250, v28, v29
  v_cvt_pk_bf16_f32 v251, v30, v31
  ds_read_b64_tr_b16 v[48:49], v20 offset:53248
  ds_read_b64_tr_b16 v[50:51], v20 offset:54272
  ds_read_b64_tr_b16 v[52:53], v21 offset:53248
  ds_read_b64_tr_b16 v[54:55], v21 offset:54272
  ds_read_b64_tr_b16 v[56:57], v22 offset:53248
  ds_read_b64_tr_b16 v[58:59], v22 offset:54272
  ds_read_b64_tr_b16 v[60:61], v23 offset:53248
  ds_read_b64_tr_b16 v[62:63], v23 offset:54272
  s_waitcnt lgkmcnt(8)
  v_mfma_f32_32x32x16_bf16 v[64:79], v[32:35], v[248:251], v[64:79]
  v_lshlrev_b32 v24, 16, v252
  v_and_b32 v25, s27, v252
  v_lshlrev_b32 v26, 16, v253
  v_and_b32 v27, s27, v253
  v_lshlrev_b32 v28, 16, v254
  v_mfma_f32_32x32x16_bf16 v[80:95], v[36:39], v[248:251], v[80:95]
  v_and_b32 v29, s27, v254
  v_lshlrev_b32 v30, 16, v255
  v_and_b32 v31, s27, v255
  v_add_f32 v24, v7, v24
  v_add_f32 v25, v7, v25
  v_mfma_f32_32x32x16_bf16 v[96:111], v[40:43], v[248:251], v[96:111]
  v_add_f32 v26, v7, v26
  v_add_f32 v27, v7, v27
  v_add_f32 v28, v7, v28
  v_add_f32 v29, v7, v29
  v_add_f32 v30, v7, v30
  v_mfma_f32_32x32x16_bf16 v[112:127], v[44:47], v[248:251], v[112:127]
  v_add_f32 v31, v7, v31
  v_cvt_pk_bf16_f32 v252, v24, v25
  v_cvt_pk_bf16_f32 v253, v26, v27
  v_cvt_pk_bf16_f32 v254, v28, v29
  v_cvt_pk_bf16_f32 v255, v30, v31
  s_waitcnt lgkmcnt(0)
  v_mfma_f32_32x32x16_bf16 v[64:79], v[48:51], v[252:255], v[64:79]
  v_mfma_f32_32x32x16_bf16 v[80:95], v[52:55], v[252:255], v[80:95]
  v_mfma_f32_32x32x16_bf16 v[96:111], v[56:59], v[252:255], v[96:111]
  v_mfma_f32_32x32x16_bf16 v[112:127], v[60:63], v[252:255], v[112:127]
  s_mul_i32 s50, s22, 112
  s_mul_i32 s51, s19, 7
  s_add_u32 s50, s50, s51
  s_add_u32 s50, s50, 3
  s_lshl_b32 s50, s50, 10
  s_add_u32 s50, s50, 0
  v_mov_b32 v10, v8
  v_mov_b32 v11, v8
  s_nop 7

  v_pk_mul_f32 v[64:65], v[64:65], v[10:11]
  v_pk_mul_f32 v[66:67], v[66:67], v[10:11]
  v_pk_mul_f32 v[68:69], v[68:69], v[10:11]
  v_pk_mul_f32 v[70:71], v[70:71], v[10:11]
  v_pk_mul_f32 v[72:73], v[72:73], v[10:11]
  v_pk_mul_f32 v[74:75], v[74:75], v[10:11]
  v_pk_mul_f32 v[76:77], v[76:77], v[10:11]
  v_pk_mul_f32 v[78:79], v[78:79], v[10:11]
  v_max_f32 v64, 0, v64
  v_max_f32 v65, 0, v65
  v_max_f32 v66, 0, v66
  v_max_f32 v67, 0, v67
  v_max_f32 v68, 0, v68
  v_max_f32 v69, 0, v69
  v_max_f32 v70, 0, v70
  v_max_f32 v71, 0, v71
  v_cvt_pk_bf16_f32 v128, v64, v65
  v_cvt_pk_bf16_f32 v129, v66, v67
  v_cvt_pk_bf16_f32 v130, v68, v69
  v_cvt_pk_bf16_f32 v131, v70, v71
  v_cvt_pk_bf16_f32 v132, v72, v73
  v_cvt_pk_bf16_f32 v133, v74, v75
  v_cvt_pk_bf16_f32 v134, v76, v77
  v_cvt_pk_bf16_f32 v135, v78, v79
  v_lshlrev_b32 v64, 16, v128
  v_and_b32 v65, s27, v128
  v_lshlrev_b32 v66, 16, v129
  v_and_b32 v67, s27, v129
  v_lshlrev_b32 v68, 16, v130
  v_and_b32 v69, s27, v130
  v_lshlrev_b32 v70, 16, v131
  v_and_b32 v71, s27, v131
  v_lshlrev_b32 v72, 16, v132
  v_and_b32 v73, s27, v132
  v_lshlrev_b32 v74, 16, v133
  v_and_b32 v75, s27, v133
  v_lshlrev_b32 v76, 16, v134
  v_and_b32 v77, s27, v134
  v_lshlrev_b32 v78, 16, v135
  v_and_b32 v79, s27, v135
  v_pk_mul_f32 v[64:65], v[64:65], v[72:73]
  v_pk_mul_f32 v[66:67], v[66:67], v[74:75]
  v_pk_mul_f32 v[68:69], v[68:69], v[76:77]
  v_pk_mul_f32 v[70:71], v[70:71], v[78:79]
  v_cvt_pk_bf16_f32 v32, v64, v65
  v_cvt_pk_bf16_f32 v33, v66, v67
  v_cvt_pk_bf16_f32 v34, v68, v69
  v_cvt_pk_bf16_f32 v35, v70, v71
  buffer_store_dwordx4 v[32:35], v9, s[40:43], s50 offen offset:0 sc1
  v_pk_mul_f32 v[80:81], v[80:81], v[10:11]
  v_pk_mul_f32 v[82:83], v[82:83], v[10:11]
  v_pk_mul_f32 v[84:85], v[84:85], v[10:11]
  v_pk_mul_f32 v[86:87], v[86:87], v[10:11]
  v_pk_mul_f32 v[88:89], v[88:89], v[10:11]
  v_pk_mul_f32 v[90:91], v[90:91], v[10:11]
  v_pk_mul_f32 v[92:93], v[92:93], v[10:11]
  v_pk_mul_f32 v[94:95], v[94:95], v[10:11]
  v_max_f32 v80, 0, v80
  v_max_f32 v81, 0, v81
  v_max_f32 v82, 0, v82
  v_max_f32 v83, 0, v83
  v_max_f32 v84, 0, v84
  v_max_f32 v85, 0, v85
  v_max_f32 v86, 0, v86
  v_max_f32 v87, 0, v87
  v_cvt_pk_bf16_f32 v136, v80, v81
  v_cvt_pk_bf16_f32 v137, v82, v83
  v_cvt_pk_bf16_f32 v138, v84, v85
  v_cvt_pk_bf16_f32 v139, v86, v87
  v_cvt_pk_bf16_f32 v140, v88, v89
  v_cvt_pk_bf16_f32 v141, v90, v91
  v_cvt_pk_bf16_f32 v142, v92, v93
  v_cvt_pk_bf16_f32 v143, v94, v95
  v_lshlrev_b32 v80, 16, v136
  v_and_b32 v81, s27, v136
  v_lshlrev_b32 v82, 16, v137
  v_and_b32 v83, s27, v137
  v_lshlrev_b32 v84, 16, v138
  v_and_b32 v85, s27, v138
  v_lshlrev_b32 v86, 16, v139
  v_and_b32 v87, s27, v139
  v_lshlrev_b32 v88, 16, v140
  v_and_b32 v89, s27, v140
  v_lshlrev_b32 v90, 16, v141
  v_and_b32 v91, s27, v141
  v_lshlrev_b32 v92, 16, v142
  v_and_b32 v93, s27, v142
  v_lshlrev_b32 v94, 16, v143
  v_and_b32 v95, s27, v143
  v_pk_mul_f32 v[80:81], v[80:81], v[88:89]
  v_pk_mul_f32 v[82:83], v[82:83], v[90:91]
  v_pk_mul_f32 v[84:85], v[84:85], v[92:93]
  v_pk_mul_f32 v[86:87], v[86:87], v[94:95]
  v_cvt_pk_bf16_f32 v36, v80, v81
  v_cvt_pk_bf16_f32 v37, v82, v83
  v_cvt_pk_bf16_f32 v38, v84, v85
  v_cvt_pk_bf16_f32 v39, v86, v87
  buffer_store_dwordx4 v[36:39], v9, s[40:43], s50 offen offset:1024 sc1
  v_pk_mul_f32 v[96:97], v[96:97], v[10:11]
  v_pk_mul_f32 v[98:99], v[98:99], v[10:11]
  v_pk_mul_f32 v[100:101], v[100:101], v[10:11]
  v_pk_mul_f32 v[102:103], v[102:103], v[10:11]
  v_pk_mul_f32 v[104:105], v[104:105], v[10:11]
  v_pk_mul_f32 v[106:107], v[106:107], v[10:11]
  v_pk_mul_f32 v[108:109], v[108:109], v[10:11]
  v_pk_mul_f32 v[110:111], v[110:111], v[10:11]
  v_max_f32 v96, 0, v96
  v_max_f32 v97, 0, v97
  v_max_f32 v98, 0, v98
  v_max_f32 v99, 0, v99
  v_max_f32 v100, 0, v100
  v_max_f32 v101, 0, v101
  v_max_f32 v102, 0, v102
  v_max_f32 v103, 0, v103
  v_cvt_pk_bf16_f32 v144, v96, v97
  v_cvt_pk_bf16_f32 v145, v98, v99
  v_cvt_pk_bf16_f32 v146, v100, v101
  v_cvt_pk_bf16_f32 v147, v102, v103
  v_cvt_pk_bf16_f32 v148, v104, v105
  v_cvt_pk_bf16_f32 v149, v106, v107
  v_cvt_pk_bf16_f32 v150, v108, v109
  v_cvt_pk_bf16_f32 v151, v110, v111
  v_lshlrev_b32 v96, 16, v144
  v_and_b32 v97, s27, v144
  v_lshlrev_b32 v98, 16, v145
  v_and_b32 v99, s27, v145
  v_lshlrev_b32 v100, 16, v146
  v_and_b32 v101, s27, v146
  v_lshlrev_b32 v102, 16, v147
  v_and_b32 v103, s27, v147
  v_lshlrev_b32 v104, 16, v148
  v_and_b32 v105, s27, v148
  v_lshlrev_b32 v106, 16, v149
  v_and_b32 v107, s27, v149
  v_lshlrev_b32 v108, 16, v150
  v_and_b32 v109, s27, v150
  v_lshlrev_b32 v110, 16, v151
  v_and_b32 v111, s27, v151
  v_pk_mul_f32 v[96:97], v[96:97], v[104:105]
  v_pk_mul_f32 v[98:99], v[98:99], v[106:107]
  v_pk_mul_f32 v[100:101], v[100:101], v[108:109]
  v_pk_mul_f32 v[102:103], v[102:103], v[110:111]
  v_cvt_pk_bf16_f32 v40, v96, v97
  v_cvt_pk_bf16_f32 v41, v98, v99
  v_cvt_pk_bf16_f32 v42, v100, v101
  v_cvt_pk_bf16_f32 v43, v102, v103
  buffer_store_dwordx4 v[40:43], v9, s[40:43], s50 offen offset:2048 sc1
  v_pk_mul_f32 v[112:113], v[112:113], v[10:11]
  v_pk_mul_f32 v[114:115], v[114:115], v[10:11]
  v_pk_mul_f32 v[116:117], v[116:117], v[10:11]
  v_pk_mul_f32 v[118:119], v[118:119], v[10:11]
  v_pk_mul_f32 v[120:121], v[120:121], v[10:11]
  v_pk_mul_f32 v[122:123], v[122:123], v[10:11]
  v_pk_mul_f32 v[124:125], v[124:125], v[10:11]
  v_pk_mul_f32 v[126:127], v[126:127], v[10:11]
  v_max_f32 v112, 0, v112
  v_max_f32 v113, 0, v113
  v_max_f32 v114, 0, v114
  v_max_f32 v115, 0, v115
  v_max_f32 v116, 0, v116
  v_max_f32 v117, 0, v117
  v_max_f32 v118, 0, v118
  v_max_f32 v119, 0, v119
  v_cvt_pk_bf16_f32 v152, v112, v113
  v_cvt_pk_bf16_f32 v153, v114, v115
  v_cvt_pk_bf16_f32 v154, v116, v117
  v_cvt_pk_bf16_f32 v155, v118, v119
  v_cvt_pk_bf16_f32 v156, v120, v121
  v_cvt_pk_bf16_f32 v157, v122, v123
  v_cvt_pk_bf16_f32 v158, v124, v125
  v_cvt_pk_bf16_f32 v159, v126, v127
  v_lshlrev_b32 v112, 16, v152
  v_and_b32 v113, s27, v152
  v_lshlrev_b32 v114, 16, v153
  v_and_b32 v115, s27, v153
  v_lshlrev_b32 v116, 16, v154
  v_and_b32 v117, s27, v154
  v_lshlrev_b32 v118, 16, v155
  v_and_b32 v119, s27, v155
  v_lshlrev_b32 v120, 16, v156
  v_and_b32 v121, s27, v156
  v_lshlrev_b32 v122, 16, v157
  v_and_b32 v123, s27, v157
  v_lshlrev_b32 v124, 16, v158
  v_and_b32 v125, s27, v158
  v_lshlrev_b32 v126, 16, v159
  v_and_b32 v127, s27, v159
  v_pk_mul_f32 v[112:113], v[112:113], v[120:121]
  v_pk_mul_f32 v[114:115], v[114:115], v[122:123]
  v_pk_mul_f32 v[116:117], v[116:117], v[124:125]
  v_pk_mul_f32 v[118:119], v[118:119], v[126:127]
  v_cvt_pk_bf16_f32 v44, v112, v113
  v_cvt_pk_bf16_f32 v45, v114, v115
  v_cvt_pk_bf16_f32 v46, v116, v117
  v_cvt_pk_bf16_f32 v47, v118, v119
  buffer_store_dwordx4 v[44:47], v9, s[40:43], s50 offen offset:3072 sc1
  s_branch ph2
k1_end:
  s_endpgm
ph2:
  s_load_dwordx4 s[8:11], s[0:1], 48
  s_load_dwordx2 s[14:15], s[0:1], 72
  s_waitcnt vmcnt(0) lgkmcnt(0)
  s_barrier
  s_cmp_eq_u32 s3, 4
  s_cbranch_scc0 ph2_nopub
  s_lshl_b32 s26, s2, 4
  s_add_u32 s26, s26, 15736832
  v_mov_b32 v7, 0
  v_mov_b32 v23, s6
  s_mov_b64 exec, 1
  buffer_store_dword v23, v7, s[40:43], s26 offen sc1
  s_mov_b64 exec, -1
ph2_nopub:
  s_nop 0
  s_nop 0
  s_lshl_b32 s26, s3, 6
  v_add_u32 v0, s26, v2

  v_and_b32 v3, 15, v2
  v_lshrrev_b32 v4, 4, v2
  s_mov_b32 s48, 0x80008000
  s_mov_b32 s49, 0xffff0000
  s_cmp_lt_u32 s3, 4
  s_cbranch_scc1 k23_conv

  s_and_b32 s7, s3, 3
  s_getpc_b64 s[24:25]
  s_add_u32 s24, s24, tab_G@rel32@lo+4
  s_addc_u32 s25, s25, tab_G@rel32@hi+12
  s_mov_b32 s44, s24
  s_mov_b32 s45, s25
  s_mov_b32 s46, 524288
  s_mov_b32 s47, 0x20000
  s_and_b32 s16, s2, 7
  s_lshr_b32 s17, s2, 3
  s_lshl_b32 s18, s16, 2
  s_and_b32 s19, s17, 3
  s_add_u32 s18, s18, s19
  s_lshl_b32 s58, s19, 2
  s_lshr_b32 s19, s17, 2
  s_lshl_b32 s20, s19, 1
  s_add_u32 s58, s58, s20

  s_cmp_ge_u32 s58, 14
  s_cselect_b32 s20, 14, 0
  s_sub_u32 s58, s58, s20
  s_lshl_b32 s58, s58, 1
  s_add_u32 s12, s18, s19
  s_and_b32 s12, s12, 7
  s_and_b32 s20, s7, 1
  s_lshr_b32 s21, s7, 1
  s_lshl_b32 s22, s18, 1
  s_add_u32 s22, s22, s21
  v_lshlrev_b32 v21, 4, v2
  v_lshrrev_b32 v6, 3, v2
  v_and_b32 v5, 7, v2
  v_lshrrev_b32 v5, 1, v5
  v_lshrrev_b32 v1, 1, v6
  v_xor_b32 v5, v5, v1
  v_lshlrev_b32 v5, 5, v5
  v_and_b32 v1, 1, v2
  v_lshl_add_u32 v5, v1, 4, v5
  v_lshl_add_u32 v22, v6, 10, v5
  v_lshl_add_u32 v23, v6, 12, v5
  s_lshl_b32 s27, s19, 7
  v_add_u32 v22, s27, v22
  s_lshl_b32 s27, s18, 7
  s_add_u32 s27, s27, 10485760
  v_add_u32 v23, s27, v23
  v_add_u32 v41, 8192, v22
  v_add_u32 v42, 32768, v23
  v_lshlrev_b32 v24, 9, v4
  v_lshl_add_u32 v24, v3, 4, v24
  s_mul_i32 s50, s22, 112
  s_lshl_b32 s50, s50, 10
  s_lshl_b32 s27, s20, 8
  s_add_u32 s50, s50, s27
  s_add_u32 s50, s50, 0
  s_lshl_b32 s51, s19, 1
  s_add_u32 s51, s51, s21
  s_lshl_b32 s51, s51, 5
  s_lshl_b32 s27, s20, 1
  s_add_u32 s51, s51, s27
  s_lshl_b32 s51, s51, 10
  s_lshl_b32 s52, s7, 11
  s_lshl_b32 s54, s7, 14
  s_lshl_b32 s55, s7, 16
  s_mov_b32 s59, 15728640
  s_lshl_b32 s27, s7, 2
  s_add_u32 s27, s27, 159744
  v_mov_b32 v26, s27
  v_mov_b32 v25, 0
  v_and_b32 v27, 3, v2
  v_lshlrev_b32 v27, 2, v27
  v_add_u32 v27, 159744, v27
  v_lshlrev_b32 v5, 2, v3
  v_add_u32 v5, 159744, v5
  ds_write_b32 v5, v25
  s_waitcnt lgkmcnt(0)

  s_mov_b32 s40, s14
  s_mov_b32 s41, s15
  s_mov_b32 s42, 268435456
  s_mov_b32 s43, 0x20000
  s_mov_b32 s32, s8
  s_mov_b32 s33, s9
  s_mov_b32 s34, 1835008
  s_mov_b32 s35, 0x20000
  v_add_u32 v22, s54, v22
  v_add_u32 v41, s54, v41
  v_add_u32 v43, s50, v24
  s_lshl_b32 s64, s58, 12

  s_add_u32 s65, s64, 4096
  s_cmp_eq_u32 s65, 114688
  s_cselect_b32 s65, 0, s65
  s_barrier
  s_add_u32 s66, s65, 4096
  s_cmp_eq_u32 s66, 114688
  s_cselect_b32 s66, 0, s66
  s_add_u32 s67, s66, 4096
  s_cmp_eq_u32 s67, 114688
  s_cselect_b32 s67, 0, s67
  s_add_u32 s68, s67, 4096
  s_cmp_eq_u32 s68, 114688
  s_cselect_b32 s68, 0, s68
  s_add_u32 s69, s68, 4096
  s_cmp_eq_u32 s69, 114688
  s_cselect_b32 s69, 0, s69
  s_add_u32 s70, s69, 4096
  s_cmp_eq_u32 s70, 114688
  s_cselect_b32 s70, 0, s70
  s_add_u32 s71, s70, 4096
  s_cmp_eq_u32 s71, 114688
  s_cselect_b32 s71, 0, s71
  s_add_u32 s72, s71, 4096
  s_cmp_eq_u32 s72, 114688
  s_cselect_b32 s72, 0, s72
  s_add_u32 s73, s72, 4096
  s_cmp_eq_u32 s73, 114688
  s_cselect_b32 s73, 0, s73
  s_add_u32 s74, s73, 4096
  s_cmp_eq_u32 s74, 114688
  s_cselect_b32 s74, 0, s74
  s_add_u32 s75, s74, 4096
  s_cmp_eq_u32 s75, 114688
  s_cselect_b32 s75, 0, s75
  s_add_u32 s76, s75, 4096
  s_cmp_eq_u32 s76, 114688
  s_cselect_b32 s76, 0, s76
  s_add_u32 s77, s76, 4096
  s_cmp_eq_u32 s77, 114688
  s_cselect_b32 s77, 0, s77
  s_add_u32 s78, s77, 4096
  s_cmp_eq_u32 s78, 114688
  s_cselect_b32 s78, 0, s78
  s_add_u32 s79, s78, 4096
  s_cmp_eq_u32 s79, 114688
  s_cselect_b32 s79, 0, s79
  s_add_u32 s80, s79, 4096
  s_cmp_eq_u32 s80, 114688
  s_cselect_b32 s80, 0, s80
  s_add_u32 s81, s80, 4096
  s_cmp_eq_u32 s81, 114688
  s_cselect_b32 s81, 0, s81
  s_add_u32 s82, s81, 4096
  s_cmp_eq_u32 s82, 114688
  s_cselect_b32 s82, 0, s82
  s_add_u32 s83, s82, 4096
  s_cmp_eq_u32 s83, 114688
  s_cselect_b32 s83, 0, s83
  s_add_u32 s84, s83, 4096
  s_cmp_eq_u32 s84, 114688
  s_cselect_b32 s84, 0, s84
  s_add_u32 s85, s84, 4096
  s_cmp_eq_u32 s85, 114688
  s_cselect_b32 s85, 0, s85
  s_add_u32 s86, s85, 4096
  s_cmp_eq_u32 s86, 114688
  s_cselect_b32 s86, 0, s86
  s_add_u32 s87, s86, 4096
  s_cmp_eq_u32 s87, 114688
  s_cselect_b32 s87, 0, s87
  s_add_u32 s88, s87, 4096
  s_cmp_eq_u32 s88, 114688
  s_cselect_b32 s88, 0, s88
  s_add_u32 s89, s88, 4096
  s_cmp_eq_u32 s89, 114688
  s_cselect_b32 s89, 0, s89
  s_add_u32 s90, s89, 4096
  s_cmp_eq_u32 s90, 114688
  s_cselect_b32 s90, 0, s90
  s_add_u32 s91, s90, 4096
  s_cmp_eq_u32 s91, 114688
  s_cselect_b32 s91, 0, s91
  s_add_u32 m0, s52, 0
  s_lshl_b32 s63, s64, 4
  buffer_load_dwordx4 v22, s[32:35], s63 offen lds
  s_add_u32 m0, s52, 1024
  s_nop 0
  buffer_load_dwordx4 v41, s[32:35], s63 offen lds
  s_add_u32 m0, s52, 8192
  s_lshl_b32 s63, s65, 4
  buffer_load_dwordx4 v22, s[32:35], s63 offen lds
  s_add_u32 m0, s52, 9216
  s_nop 0
  buffer_load_dwordx4 v41, s[32:35], s63 offen lds
  s_add_u32 m0, s52, 16384
  s_lshl_b32 s63, s66, 4
  buffer_load_dwordx4 v22, s[32:35], s63 offen lds
  s_add_u32 m0, s52, 17408
  s_nop 0
  buffer_load_dwordx4 v41, s[32:35], s63 offen lds
  s_add_u32 m0, s52, 24576
  s_lshl_b32 s63, s67, 4
  buffer_load_dwordx4 v22, s[32:35], s63 offen lds
  s_add_u32 m0, s52, 25600
  s_nop 0
  buffer_load_dwordx4 v41, s[32:35], s63 offen lds
  s_add_u32 m0, s52, 32768
  s_lshl_b32 s63, s68, 4
  buffer_load_dwordx4 v22, s[32:35], s63 offen lds
  s_add_u32 m0, s52, 33792
  s_nop 0
  buffer_load_dwordx4 v41, s[32:35], s63 offen lds
  s_add_u32 m0, s52, 40960
  s_lshl_b32 s63, s69, 4
  buffer_load_dwordx4 v22, s[32:35], s63 offen lds
  s_add_u32 m0, s52, 41984
  s_nop 0
  buffer_load_dwordx4 v41, s[32:35], s63 offen lds
  s_add_u32 m0, s52, 49152
  s_lshl_b32 s63, s70, 4
  buffer_load_dwordx4 v22, s[32:35], s63 offen lds
  s_add_u32 m0, s52, 50176
  s_nop 0
  buffer_load_dwordx4 v41, s[32:35], s63 offen lds
  s_add_u32 m0, s52, 57344
  s_lshl_b32 s63, s71, 4
  buffer_load_dwordx4 v22, s[32:35], s63 offen lds
  s_add_u32 m0, s52, 58368
  s_nop 0
  buffer_load_dwordx4 v41, s[32:35], s63 offen lds
  s_add_u32 m0, s52, 65536
  s_lshl_b32 s63, s72, 4
  buffer_load_dwordx4 v22, s[32:35], s63 offen lds
  s_add_u32 m0, s52, 66560
  s_nop 0
  buffer_load_dwordx4 v41, s[32:35], s63 offen lds
  s_add_u32 m0, s52, 73728
  s_lshl_b32 s63, s73, 4
  buffer_load_dwordx4 v22, s[32:35], s63 offen lds
  s_add_u32 m0, s52, 74752
  s_nop 0
  buffer_load_dwordx4 v41, s[32:35], s63 offen lds
  s_add_u32 m0, s52, 81920
  s_lshl_b32 s63, s74, 4
  buffer_load_dwordx4 v22, s[32:35], s63 offen lds
  s_add_u32 m0, s52, 82944
  s_nop 0
  buffer_load_dwordx4 v41, s[32:35], s63 offen lds
  s_add_u32 m0, s52, 90112
  s_lshl_b32 s63, s75, 4
  buffer_load_dwordx4 v22, s[32:35], s63 offen lds
  s_add_u32 m0, s52, 91136
  s_nop 0
  buffer_load_dwordx4 v41, s[32:35], s63 offen lds
  s_add_u32 m0, s52, 98304
  s_lshl_b32 s63, s76, 4
  buffer_load_dwordx4 v22, s[32:35], s63 offen lds
  s_add_u32 m0, s52, 99328
  s_nop 0
  buffer_load_dwordx4 v41, s[32:35], s63 offen lds
  s_add_u32 m0, s52, 106496
  s_lshl_b32 s63, s77, 4
  buffer_load_dwordx4 v22, s[32:35], s63 offen lds
  s_add_u32 m0, s52, 107520
  s_nop 0
  buffer_load_dwordx4 v41, s[32:35], s63 offen lds
  s_add_u32 m0, s52, 114688
  s_lshl_b32 s63, s78, 4
  buffer_load_dwordx4 v22, s[32:35], s63 offen lds
  s_add_u32 m0, s52, 115712
  s_nop 0
  buffer_load_dwordx4 v41, s[32:35], s63 offen lds
  s_add_u32 m0, s52, 122880
  s_lshl_b32 s63, s79, 4
  buffer_load_dwordx4 v22, s[32:35], s63 offen lds
  s_add_u32 m0, s52, 123904
  s_nop 0
  buffer_load_dwordx4 v41, s[32:35], s63 offen lds
  s_mov_b32 s36, s10
  s_mov_b32 s37, s11
  s_mov_b32 s38, 2097152
  s_mov_b32 s39, 0x20000
  s_mov_b32 s28, s4
  s_mov_b32 s29, s5
  s_mov_b32 s30, 2097152
  s_mov_b32 s31, 0x20000
  v_lshrrev_b32 v16, 2, v3
  v_and_b32 v17, 3, v3
  v_lshrrev_b32 v18, 1, v4
  v_lshlrev_b32 v18, 4, v18
  v_and_b32 v19, 1, v4
  v_lshl_add_u32 v18, v19, 2, v18
  v_add_u32 v18, v18, v16
  v_lshlrev_b32 v18, 7, v18
  v_lshl_add_u32 v18, v17, 3, v18
  v_lshrrev_b32 v16, 1, v16
  v_lshl_add_u32 v16, v19, 1, v16

  v_xor_b32 v17, 0, v16
  v_lshl_add_u32 v29, v17, 5, v18
  v_add_u32 v33, 0x10000, v29
  v_xor_b32 v17, 1, v16
  v_lshl_add_u32 v30, v17, 5, v18
  v_add_u32 v34, 0x10000, v30
  v_xor_b32 v17, 2, v16
  v_lshl_add_u32 v31, v17, 5, v18
  v_add_u32 v35, 0x10000, v31
  v_xor_b32 v17, 3, v16
  v_lshl_add_u32 v32, v17, 5, v18
  v_add_u32 v36, 0x10000, v32
  v_xor_b32 v17, s7, v16
  v_lshl_add_u32 v37, v17, 5, v18
  v_add_u32 v38, 0x10000, v37
  v_mov_b32 v39, v24
  v_add_u32 v40, 0x10000, v24
  v_lshrrev_b32 v1, 3, v2
  v_and_b32 v20, 7, v2
  v_lshlrev_b32 v20, 4, v20
  v_lshl_add_u32 v20, v1, 16, v20
  s_lshl_b32 s23, s22, 10
  s_lshl_b32 s26, s19, 7
  s_add_u32 s23, s23, s26
  s_lshl_b32 s26, s20, 20
  s_add_u32 s23, s23, s26
  s_add_u32 s13, s23, 0x80000

  s_cmp_eq_u32 s7, 0
  s_cbranch_scc0 ph2_ggo
  s_lshr_b32 s26, s18, 1
  s_lshr_b32 s27, s26, 3
  s_and_b32 s26, s26, 7
  s_lshl_b32 s26, s26, 3
  s_add_u32 s26, s26, s27
  s_lshl_b32 s26, s26, 4
  s_add_u32 s26, s26, 15736832
  v_lshrrev_b32 v16, 2, v3
  v_and_b32 v17, 3, v3
  v_lshlrev_b32 v16, 5, v16
  v_lshl_add_u32 v16, v17, 10, v16
  s_mov_b32 s27, 0
ph2_gpoll:
  buffer_load_dword v17, v16, s[40:43], s26 offen sc1
  s_waitcnt vmcnt(0)
  v_cmp_ne_u32 vcc, s6, v17
  s_cbranch_vccz ph2_ggo
  s_add_u32 s27, s27, 1
  s_cmp_ge_u32 s27, 0x8000
  s_cbranch_scc1 ph2_ggo
  s_sleep 8
  s_branch ph2_gpoll
ph2_ggo:
  s_nop 0
  s_waitcnt vmcnt(0) lgkmcnt(0)

  v_mov_b32 v25, 1
  ds_write_b32 v26, v25
  ds_read_b32 v28, v27
  s_waitcnt lgkmcnt(0)
k23_gs0:
  v_cmp_gt_u32 vcc, 1, v28
  s_cbranch_vccz k23_go0
  s_sleep 1
  ds_read_b32 v28, v27
  s_waitcnt lgkmcnt(0)
  s_branch k23_gs0
k23_go0:

  buffer_load_dwordx4 v[136:139], v43, s[40:43], s64 offen offset:0 sc1
  buffer_load_dwordx4 v[140:143], v43, s[40:43], s64 offen offset:2048 sc1
  buffer_load_dwordx4 v[144:147], v43, s[40:43], s65 offen offset:0 sc1
  buffer_load_dwordx4 v[148:151], v43, s[40:43], s65 offen offset:2048 sc1
  buffer_load_dwordx4 v[152:155], v43, s[40:43], s66 offen offset:0 sc1
  buffer_load_dwordx4 v[156:159], v43, s[40:43], s66 offen offset:2048 sc1
  buffer_load_dwordx4 v[160:163], v43, s[40:43], s67 offen offset:0 sc1
  buffer_load_dwordx4 v[164:167], v43, s[40:43], s67 offen offset:2048 sc1
  buffer_load_dwordx4 v[168:171], v43, s[40:43], s68 offen offset:0 sc1
  buffer_load_dwordx4 v[172:175], v43, s[40:43], s68 offen offset:2048 sc1
  buffer_load_dwordx4 v[176:179], v43, s[40:43], s69 offen offset:0 sc1
  buffer_load_dwordx4 v[180:183], v43, s[40:43], s69 offen offset:2048 sc1
  ds_read_b64_tr_b16 v[76:77], v29 offset:0
  ds_read_b64_tr_b16 v[78:79], v29 offset:1024
  ds_read_b64_tr_b16 v[80:81], v30 offset:0
  ds_read_b64_tr_b16 v[82:83], v30 offset:1024
  ds_read_b64_tr_b16 v[84:85], v31 offset:0
  ds_read_b64_tr_b16 v[86:87], v31 offset:1024
  ds_read_b64_tr_b16 v[88:89], v32 offset:0
  ds_read_b64_tr_b16 v[90:91], v32 offset:1024
  ds_read_b64_tr_b16 v[96:97], v29 offset:4096
  ds_read_b64_tr_b16 v[98:99], v29 offset:5120
  ds_read_b64_tr_b16 v[100:101], v30 offset:4096
  ds_read_b64_tr_b16 v[102:103], v30 offset:5120
  ds_read_b64_tr_b16 v[104:105], v31 offset:4096
  ds_read_b64_tr_b16 v[106:107], v31 offset:5120
  ds_read_b64_tr_b16 v[108:109], v32 offset:4096
  ds_read_b64_tr_b16 v[110:111], v32 offset:5120
  ds_read_b64_tr_b16 v[116:117], v29 offset:8192
  ds_read_b64_tr_b16 v[118:119], v29 offset:9216
  ds_read_b64_tr_b16 v[120:121], v30 offset:8192
  ds_read_b64_tr_b16 v[122:123], v30 offset:9216
  ds_read_b64_tr_b16 v[124:125], v31 offset:8192
  ds_read_b64_tr_b16 v[126:127], v31 offset:9216
  ds_read_b64_tr_b16 v[128:129], v32 offset:8192
  ds_read_b64_tr_b16 v[130:131], v32 offset:9216
  s_waitcnt lgkmcnt(15)
  s_waitcnt vmcnt(11)
  v_mfma_f32_16x16x32_bf16 v[44:47], v[76:79], v[136:139], 0
  v_mfma_f32_16x16x32_bf16 v[48:51], v[80:83], v[136:139], 0
  buffer_load_dwordx4 v[184:187], v43, s[40:43], s70 offen offset:0 sc1
  v_mfma_f32_16x16x32_bf16 v[52:55], v[84:87], v[136:139], 0
  v_mfma_f32_16x16x32_bf16 v[56:59], v[88:91], v[136:139], 0
  ds_read_b64_tr_b16 v[76:77], v29 offset:12288
  ds_read_b64_tr_b16 v[78:79], v29 offset:13312
  ds_read_b64_tr_b16 v[80:81], v30 offset:12288
  ds_read_b64_tr_b16 v[82:83], v30 offset:13312
  ds_read_b64_tr_b16 v[84:85], v31 offset:12288
  ds_read_b64_tr_b16 v[86:87], v31 offset:13312
  ds_read_b64_tr_b16 v[88:89], v32 offset:12288
  ds_read_b64_tr_b16 v[90:91], v32 offset:13312
  s_waitcnt lgkmcnt(15)
  s_waitcnt vmcnt(11)
  v_mov_b32 v25, 2
  ds_write_b32 v26, v25
  v_mfma_f32_16x16x32_bf16 v[44:47], v[96:99], v[140:143], v[44:47]
  v_mfma_f32_16x16x32_bf16 v[48:51], v[100:103], v[140:143], v[48:51]
  buffer_load_dwordx4 v[188:191], v43, s[40:43], s70 offen offset:2048 sc1
  v_mfma_f32_16x16x32_bf16 v[52:55], v[104:107], v[140:143], v[52:55]
  v_mfma_f32_16x16x32_bf16 v[56:59], v[108:111], v[140:143], v[56:59]
  ds_read_b64_tr_b16 v[96:97], v29 offset:16384
  ds_read_b64_tr_b16 v[98:99], v29 offset:17408
  ds_read_b64_tr_b16 v[100:101], v30 offset:16384
  ds_read_b64_tr_b16 v[102:103], v30 offset:17408
  ds_read_b64_tr_b16 v[104:105], v31 offset:16384
  ds_read_b64_tr_b16 v[106:107], v31 offset:17408
  ds_read_b64_tr_b16 v[108:109], v32 offset:16384
  ds_read_b64_tr_b16 v[110:111], v32 offset:17408
  s_waitcnt lgkmcnt(15)
  s_waitcnt vmcnt(11)
  v_mfma_f32_16x16x32_bf16 v[44:47], v[116:119], v[144:147], v[44:47]
  v_mfma_f32_16x16x32_bf16 v[48:51], v[120:123], v[144:147], v[48:51]
  buffer_load_dwordx4 v[192:195], v43, s[40:43], s71 offen offset:0 sc1
  v_mfma_f32_16x16x32_bf16 v[52:55], v[124:127], v[144:147], v[52:55]
  v_mfma_f32_16x16x32_bf16 v[56:59], v[128:131], v[144:147], v[56:59]
  ds_read_b64_tr_b16 v[116:117], v29 offset:20480
  ds_read_b64_tr_b16 v[118:119], v29 offset:21504
  ds_read_b64_tr_b16 v[120:121], v30 offset:20480
  ds_read_b64_tr_b16 v[122:123], v30 offset:21504
  ds_read_b64_tr_b16 v[124:125], v31 offset:20480
  ds_read_b64_tr_b16 v[126:127], v31 offset:21504
  ds_read_b64_tr_b16 v[128:129], v32 offset:20480
  ds_read_b64_tr_b16 v[130:131], v32 offset:21504
  s_waitcnt lgkmcnt(15)
  s_waitcnt vmcnt(11)
  v_mfma_f32_16x16x32_bf16 v[44:47], v[76:79], v[148:151], v[44:47]
  v_mfma_f32_16x16x32_bf16 v[48:51], v[80:83], v[148:151], v[48:51]
  buffer_load_dwordx4 v[196:199], v43, s[40:43], s71 offen offset:2048 sc1
  v_mfma_f32_16x16x32_bf16 v[52:55], v[84:87], v[148:151], v[52:55]
  v_mfma_f32_16x16x32_bf16 v[56:59], v[88:91], v[148:151], v[56:59]
  ds_read_b32 v28, v27
  ds_read_b64_tr_b16 v[76:77], v29 offset:24576
  ds_read_b64_tr_b16 v[78:79], v29 offset:25600
  ds_read_b64_tr_b16 v[80:81], v30 offset:24576
  ds_read_b64_tr_b16 v[82:83], v30 offset:25600
  ds_read_b64_tr_b16 v[84:85], v31 offset:24576
  ds_read_b64_tr_b16 v[86:87], v31 offset:25600
  ds_read_b64_tr_b16 v[88:89], v32 offset:24576
  ds_read_b64_tr_b16 v[90:91], v32 offset:25600
  s_waitcnt lgkmcnt(15)
  s_waitcnt vmcnt(11)
  v_mfma_f32_16x16x32_bf16 v[44:47], v[96:99], v[152:155], v[44:47]
  v_mfma_f32_16x16x32_bf16 v[48:51], v[100:103], v[152:155], v[48:51]
  buffer_load_dwordx4 v[200:203], v43, s[40:43], s72 offen offset:0 sc1
  v_mfma_f32_16x16x32_bf16 v[52:55], v[104:107], v[152:155], v[52:55]
  v_mfma_f32_16x16x32_bf16 v[56:59], v[108:111], v[152:155], v[56:59]
  ds_read_b64_tr_b16 v[96:97], v29 offset:28672
  ds_read_b64_tr_b16 v[98:99], v29 offset:29696
  ds_read_b64_tr_b16 v[100:101], v30 offset:28672
  ds_read_b64_tr_b16 v[102:103], v30 offset:29696
  ds_read_b64_tr_b16 v[104:105], v31 offset:28672
  ds_read_b64_tr_b16 v[106:107], v31 offset:29696
  ds_read_b64_tr_b16 v[108:109], v32 offset:28672
  ds_read_b64_tr_b16 v[110:111], v32 offset:29696
  s_waitcnt lgkmcnt(15)
  s_waitcnt vmcnt(11)
  v_mov_b32 v25, 3
  ds_write_b32 v26, v25
  v_mfma_f32_16x16x32_bf16 v[44:47], v[116:119], v[156:159], v[44:47]
  v_mfma_f32_16x16x32_bf16 v[48:51], v[120:123], v[156:159], v[48:51]
  buffer_load_dwordx4 v[204:207], v43, s[40:43], s72 offen offset:2048 sc1
  v_mfma_f32_16x16x32_bf16 v[52:55], v[124:127], v[156:159], v[52:55]
  v_mfma_f32_16x16x32_bf16 v[56:59], v[128:131], v[156:159], v[56:59]
k23_gs1:
  v_cmp_gt_u32 vcc, 2, v28
  s_cbranch_vccz k23_go1
  s_nop 0
  ds_read_b32 v28, v27
  s_waitcnt lgkmcnt(0)
  s_branch k23_gs1
k23_go1:

  ds_read_b64_tr_b16 v[116:117], v29 offset:32768
  ds_read_b64_tr_b16 v[118:119], v29 offset:33792
  ds_read_b64_tr_b16 v[120:121], v30 offset:32768
  ds_read_b64_tr_b16 v[122:123], v30 offset:33792
  ds_read_b64_tr_b16 v[124:125], v31 offset:32768
  ds_read_b64_tr_b16 v[126:127], v31 offset:33792
  ds_read_b64_tr_b16 v[128:129], v32 offset:32768
  ds_read_b64_tr_b16 v[130:131], v32 offset:33792
  s_waitcnt lgkmcnt(15)
  s_waitcnt vmcnt(11)
  v_mfma_f32_16x16x32_bf16 v[44:47], v[76:79], v[160:163], v[44:47]
  s_add_u32 m0, s52, 0
  s_lshl_b32 s63, s80, 4
  buffer_load_dwordx4 v22, s[32:35], s63 offen lds
  v_mfma_f32_16x16x32_bf16 v[48:51], v[80:83], v[160:163], v[48:51]
  buffer_load_dwordx4 v[208:211], v43, s[40:43], s73 offen offset:0 sc1
  v_mfma_f32_16x16x32_bf16 v[52:55], v[84:87], v[160:163], v[52:55]
  s_add_u32 m0, s52, 1024
  s_nop 0
  buffer_load_dwordx4 v41, s[32:35], s63 offen lds
  v_mfma_f32_16x16x32_bf16 v[56:59], v[88:91], v[160:163], v[56:59]
  ds_read_b64_tr_b16 v[76:77], v29 offset:36864
  ds_read_b64_tr_b16 v[78:79], v29 offset:37888
  ds_read_b64_tr_b16 v[80:81], v30 offset:36864
  ds_read_b64_tr_b16 v[82:83], v30 offset:37888
  ds_read_b64_tr_b16 v[84:85], v31 offset:36864
  ds_read_b64_tr_b16 v[86:87], v31 offset:37888
  ds_read_b64_tr_b16 v[88:89], v32 offset:36864
  ds_read_b64_tr_b16 v[90:91], v32 offset:37888
  s_waitcnt lgkmcnt(15)
  s_waitcnt vmcnt(13)
  v_mfma_f32_16x16x32_bf16 v[44:47], v[96:99], v[164:167], v[44:47]
  v_mfma_f32_16x16x32_bf16 v[48:51], v[100:103], v[164:167], v[48:51]
  buffer_load_dwordx4 v[212:215], v43, s[40:43], s73 offen offset:2048 sc1
  v_mfma_f32_16x16x32_bf16 v[52:55], v[104:107], v[164:167], v[52:55]
  v_mfma_f32_16x16x32_bf16 v[56:59], v[108:111], v[164:167], v[56:59]
  ds_read_b32 v28, v27
  ds_read_b64_tr_b16 v[96:97], v29 offset:40960
  ds_read_b64_tr_b16 v[98:99], v29 offset:41984
  ds_read_b64_tr_b16 v[100:101], v30 offset:40960
  ds_read_b64_tr_b16 v[102:103], v30 offset:41984
  ds_read_b64_tr_b16 v[104:105], v31 offset:40960
  ds_read_b64_tr_b16 v[106:107], v31 offset:41984
  ds_read_b64_tr_b16 v[108:109], v32 offset:40960
  ds_read_b64_tr_b16 v[110:111], v32 offset:41984
  s_waitcnt lgkmcnt(15)
  s_waitcnt vmcnt(13)
  v_mfma_f32_16x16x32_bf16 v[44:47], v[116:119], v[168:171], v[44:47]
  v_mfma_f32_16x16x32_bf16 v[48:51], v[120:123], v[168:171], v[48:51]
  buffer_load_dwordx4 v[216:219], v43, s[40:43], s74 offen offset:0 sc1
  v_mfma_f32_16x16x32_bf16 v[52:55], v[124:127], v[168:171], v[52:55]
  v_mfma_f32_16x16x32_bf16 v[56:59], v[128:131], v[168:171], v[56:59]
  ds_read_b64_tr_b16 v[116:117], v29 offset:45056
  ds_read_b64_tr_b16 v[118:119], v29 offset:46080
  ds_read_b64_tr_b16 v[120:121], v30 offset:45056
  ds_read_b64_tr_b16 v[122:123], v30 offset:46080
  ds_read_b64_tr_b16 v[124:125], v31 offset:45056
  ds_read_b64_tr_b16 v[126:127], v31 offset:46080
  ds_read_b64_tr_b16 v[128:129], v32 offset:45056
  ds_read_b64_tr_b16 v[130:131], v32 offset:46080
  s_waitcnt lgkmcnt(15)
  s_waitcnt vmcnt(13)
  v_mov_b32 v25, 4
  ds_write_b32 v26, v25
  v_mfma_f32_16x16x32_bf16 v[44:47], v[76:79], v[172:175], v[44:47]
  v_mfma_f32_16x16x32_bf16 v[48:51], v[80:83], v[172:175], v[48:51]
  buffer_load_dwordx4 v[220:223], v43, s[40:43], s74 offen offset:2048 sc1
  v_mfma_f32_16x16x32_bf16 v[52:55], v[84:87], v[172:175], v[52:55]
  v_mfma_f32_16x16x32_bf16 v[56:59], v[88:91], v[172:175], v[56:59]
k23_gs2:
  v_cmp_gt_u32 vcc, 3, v28
  s_cbranch_vccz k23_go2
  s_nop 0
  ds_read_b32 v28, v27
  s_waitcnt lgkmcnt(0)
  s_branch k23_gs2
k23_go2:

  ds_read_b64_tr_b16 v[76:77], v29 offset:49152
  ds_read_b64_tr_b16 v[78:79], v29 offset:50176
  ds_read_b64_tr_b16 v[80:81], v30 offset:49152
  ds_read_b64_tr_b16 v[82:83], v30 offset:50176
  ds_read_b64_tr_b16 v[84:85], v31 offset:49152
  ds_read_b64_tr_b16 v[86:87], v31 offset:50176
  ds_read_b64_tr_b16 v[88:89], v32 offset:49152
  ds_read_b64_tr_b16 v[90:91], v32 offset:50176
  s_waitcnt lgkmcnt(15)
  s_waitcnt vmcnt(13)
  v_mfma_f32_16x16x32_bf16 v[44:47], v[96:99], v[176:179], v[44:47]
  s_add_u32 m0, s52, 8192
  s_lshl_b32 s63, s81, 4
  buffer_load_dwordx4 v22, s[32:35], s63 offen lds
  v_mfma_f32_16x16x32_bf16 v[48:51], v[100:103], v[176:179], v[48:51]
  buffer_load_dwordx4 v[224:227], v43, s[40:43], s75 offen offset:0 sc1
  v_mfma_f32_16x16x32_bf16 v[52:55], v[104:107], v[176:179], v[52:55]
  s_add_u32 m0, s52, 9216
  s_nop 0
  buffer_load_dwordx4 v41, s[32:35], s63 offen lds
  v_mfma_f32_16x16x32_bf16 v[56:59], v[108:111], v[176:179], v[56:59]
  ds_read_b64_tr_b16 v[96:97], v29 offset:53248
  ds_read_b64_tr_b16 v[98:99], v29 offset:54272
  ds_read_b64_tr_b16 v[100:101], v30 offset:53248
  ds_read_b64_tr_b16 v[102:103], v30 offset:54272
  ds_read_b64_tr_b16 v[104:105], v31 offset:53248
  ds_read_b64_tr_b16 v[106:107], v31 offset:54272
  ds_read_b64_tr_b16 v[108:109], v32 offset:53248
  ds_read_b64_tr_b16 v[110:111], v32 offset:54272
  s_waitcnt lgkmcnt(15)
  s_waitcnt vmcnt(15)
  v_mfma_f32_16x16x32_bf16 v[44:47], v[116:119], v[180:183], v[44:47]
  s_add_u32 m0, s52, 16384
  s_lshl_b32 s63, s82, 4
  buffer_load_dwordx4 v22, s[32:35], s63 offen lds
  v_mfma_f32_16x16x32_bf16 v[48:51], v[120:123], v[180:183], v[48:51]
  buffer_load_dwordx4 v[228:231], v43, s[40:43], s75 offen offset:2048 sc1
  v_mfma_f32_16x16x32_bf16 v[52:55], v[124:127], v[180:183], v[52:55]
  s_add_u32 m0, s52, 17408
  s_nop 0
  buffer_load_dwordx4 v41, s[32:35], s63 offen lds
  v_mfma_f32_16x16x32_bf16 v[56:59], v[128:131], v[180:183], v[56:59]
  ds_read_b32 v28, v27
  ds_read_b64_tr_b16 v[116:117], v29 offset:57344
  ds_read_b64_tr_b16 v[118:119], v29 offset:58368
  ds_read_b64_tr_b16 v[120:121], v30 offset:57344
  ds_read_b64_tr_b16 v[122:123], v30 offset:58368
  ds_read_b64_tr_b16 v[124:125], v31 offset:57344
  ds_read_b64_tr_b16 v[126:127], v31 offset:58368
  ds_read_b64_tr_b16 v[128:129], v32 offset:57344
  ds_read_b64_tr_b16 v[130:131], v32 offset:58368
  s_waitcnt lgkmcnt(15)
  s_waitcnt vmcnt(17)
  v_mfma_f32_16x16x32_bf16 v[44:47], v[76:79], v[184:187], v[44:47]
  v_mfma_f32_16x16x32_bf16 v[48:51], v[80:83], v[184:187], v[48:51]
  buffer_load_dwordx4 v[232:235], v43, s[40:43], s76 offen offset:0 sc1
  v_mfma_f32_16x16x32_bf16 v[52:55], v[84:87], v[184:187], v[52:55]
  v_mfma_f32_16x16x32_bf16 v[56:59], v[88:91], v[184:187], v[56:59]
  ds_read_b64_tr_b16 v[76:77], v29 offset:61440
  ds_read_b64_tr_b16 v[78:79], v29 offset:62464
  ds_read_b64_tr_b16 v[80:81], v30 offset:61440
  ds_read_b64_tr_b16 v[82:83], v30 offset:62464
  ds_read_b64_tr_b16 v[84:85], v31 offset:61440
  ds_read_b64_tr_b16 v[86:87], v31 offset:62464
  ds_read_b64_tr_b16 v[88:89], v32 offset:61440
  ds_read_b64_tr_b16 v[90:91], v32 offset:62464
  s_waitcnt lgkmcnt(15)
  s_waitcnt vmcnt(17)
  v_mov_b32 v25, 5
  ds_write_b32 v26, v25
  v_mfma_f32_16x16x32_bf16 v[44:47], v[96:99], v[188:191], v[44:47]
  v_mfma_f32_16x16x32_bf16 v[48:51], v[100:103], v[188:191], v[48:51]
  buffer_load_dwordx4 v[236:239], v43, s[40:43], s76 offen offset:2048 sc1
  v_mfma_f32_16x16x32_bf16 v[52:55], v[104:107], v[188:191], v[52:55]
  v_mfma_f32_16x16x32_bf16 v[56:59], v[108:111], v[188:191], v[56:59]
k23_gs3:
  v_cmp_gt_u32 vcc, 4, v28
  s_cbranch_vccz k23_go3
  s_nop 0
  ds_read_b32 v28, v27
  s_waitcnt lgkmcnt(0)
  s_branch k23_gs3
k23_go3:

  ds_read_b64_tr_b16 v[96:97], v33 offset:0
  ds_read_b64_tr_b16 v[98:99], v33 offset:1024
  ds_read_b64_tr_b16 v[100:101], v34 offset:0
  ds_read_b64_tr_b16 v[102:103], v34 offset:1024
  ds_read_b64_tr_b16 v[104:105], v35 offset:0
  ds_read_b64_tr_b16 v[106:107], v35 offset:1024
  ds_read_b64_tr_b16 v[108:109], v36 offset:0
  ds_read_b64_tr_b16 v[110:111], v36 offset:1024
  s_waitcnt lgkmcnt(15)
  s_waitcnt vmcnt(17)
  v_mfma_f32_16x16x32_bf16 v[44:47], v[116:119], v[192:195], v[44:47]
  s_add_u32 m0, s52, 24576
  s_lshl_b32 s63, s83, 4
  buffer_load_dwordx4 v22, s[32:35], s63 offen lds
  v_mfma_f32_16x16x32_bf16 v[48:51], v[120:123], v[192:195], v[48:51]
  buffer_load_dwordx4 v[240:243], v43, s[40:43], s77 offen offset:0 sc1
  v_mfma_f32_16x16x32_bf16 v[52:55], v[124:127], v[192:195], v[52:55]
  s_add_u32 m0, s52, 25600
  s_nop 0
  buffer_load_dwordx4 v41, s[32:35], s63 offen lds
  v_mfma_f32_16x16x32_bf16 v[56:59], v[128:131], v[192:195], v[56:59]
  ds_read_b64_tr_b16 v[116:117], v33 offset:4096
  ds_read_b64_tr_b16 v[118:119], v33 offset:5120
  ds_read_b64_tr_b16 v[120:121], v34 offset:4096
  ds_read_b64_tr_b16 v[122:123], v34 offset:5120
  ds_read_b64_tr_b16 v[124:125], v35 offset:4096
  ds_read_b64_tr_b16 v[126:127], v35 offset:5120
  ds_read_b64_tr_b16 v[128:129], v36 offset:4096
  ds_read_b64_tr_b16 v[130:131], v36 offset:5120
  s_waitcnt lgkmcnt(15)
  s_waitcnt vmcnt(19)
  v_mfma_f32_16x16x32_bf16 v[44:47], v[76:79], v[196:199], v[44:47]
  s_add_u32 m0, s52, 32768
  s_lshl_b32 s63, s84, 4
  buffer_load_dwordx4 v22, s[32:35], s63 offen lds
  v_mfma_f32_16x16x32_bf16 v[48:51], v[80:83], v[196:199], v[48:51]
  buffer_load_dwordx4 v[244:247], v43, s[40:43], s77 offen offset:2048 sc1
  v_mfma_f32_16x16x32_bf16 v[52:55], v[84:87], v[196:199], v[52:55]
  s_add_u32 m0, s52, 33792
  s_nop 0
  buffer_load_dwordx4 v41, s[32:35], s63 offen lds
  v_mfma_f32_16x16x32_bf16 v[56:59], v[88:91], v[196:199], v[56:59]
  ds_read_b32 v28, v27
  ds_read_b64_tr_b16 v[76:77], v33 offset:8192
  ds_read_b64_tr_b16 v[78:79], v33 offset:9216
  ds_read_b64_tr_b16 v[80:81], v34 offset:8192
  ds_read_b64_tr_b16 v[82:83], v34 offset:9216
  ds_read_b64_tr_b16 v[84:85], v35 offset:8192
  ds_read_b64_tr_b16 v[86:87], v35 offset:9216
  ds_read_b64_tr_b16 v[88:89], v36 offset:8192
  ds_read_b64_tr_b16 v[90:91], v36 offset:9216
  s_waitcnt lgkmcnt(15)
  s_waitcnt vmcnt(21)
  v_mfma_f32_16x16x32_bf16 v[44:47], v[96:99], v[200:203], v[44:47]
  v_mfma_f32_16x16x32_bf16 v[48:51], v[100:103], v[200:203], v[48:51]
  buffer_load_dwordx4 v[136:139], v43, s[40:43], s78 offen offset:0 sc1
  v_mfma_f32_16x16x32_bf16 v[52:55], v[104:107], v[200:203], v[52:55]
  v_mfma_f32_16x16x32_bf16 v[56:59], v[108:111], v[200:203], v[56:59]
  ds_read_b64_tr_b16 v[96:97], v33 offset:12288
  ds_read_b64_tr_b16 v[98:99], v33 offset:13312
  ds_read_b64_tr_b16 v[100:101], v34 offset:12288
  ds_read_b64_tr_b16 v[102:103], v34 offset:13312
  ds_read_b64_tr_b16 v[104:105], v35 offset:12288
  ds_read_b64_tr_b16 v[106:107], v35 offset:13312
  ds_read_b64_tr_b16 v[108:109], v36 offset:12288
  ds_read_b64_tr_b16 v[110:111], v36 offset:13312
  s_waitcnt lgkmcnt(15)
  s_waitcnt vmcnt(21)
  v_mov_b32 v25, 6
  ds_write_b32 v26, v25
  v_mfma_f32_16x16x32_bf16 v[44:47], v[116:119], v[204:207], v[44:47]
  v_mfma_f32_16x16x32_bf16 v[48:51], v[120:123], v[204:207], v[48:51]
  buffer_load_dwordx4 v[140:143], v43, s[40:43], s78 offen offset:2048 sc1
  v_mfma_f32_16x16x32_bf16 v[52:55], v[124:127], v[204:207], v[52:55]
  v_mfma_f32_16x16x32_bf16 v[56:59], v[128:131], v[204:207], v[56:59]
k23_gs4:
  v_cmp_gt_u32 vcc, 5, v28
  s_cbranch_vccz k23_go4
  s_nop 0
  ds_read_b32 v28, v27
  s_waitcnt lgkmcnt(0)
  s_branch k23_gs4
k23_go4:

  ds_read_b64_tr_b16 v[116:117], v33 offset:16384
  ds_read_b64_tr_b16 v[118:119], v33 offset:17408
  ds_read_b64_tr_b16 v[120:121], v34 offset:16384
  ds_read_b64_tr_b16 v[122:123], v34 offset:17408
  ds_read_b64_tr_b16 v[124:125], v35 offset:16384
  ds_read_b64_tr_b16 v[126:127], v35 offset:17408
  ds_read_b64_tr_b16 v[128:129], v36 offset:16384
  ds_read_b64_tr_b16 v[130:131], v36 offset:17408
  s_waitcnt lgkmcnt(15)
  s_waitcnt vmcnt(20)
  v_mfma_f32_16x16x32_bf16 v[44:47], v[76:79], v[208:211], v[44:47]
  s_add_u32 m0, s52, 40960
  s_lshl_b32 s63, s85, 4
  buffer_load_dwordx4 v22, s[32:35], s63 offen lds
  v_mfma_f32_16x16x32_bf16 v[48:51], v[80:83], v[208:211], v[48:51]
  buffer_load_dwordx4 v[144:147], v43, s[40:43], s79 offen offset:0 sc1
  v_mfma_f32_16x16x32_bf16 v[52:55], v[84:87], v[208:211], v[52:55]
  s_add_u32 m0, s52, 41984
  s_nop 0
  buffer_load_dwordx4 v41, s[32:35], s63 offen lds
  v_mfma_f32_16x16x32_bf16 v[56:59], v[88:91], v[208:211], v[56:59]
  ds_read_b64_tr_b16 v[76:77], v33 offset:20480
  ds_read_b64_tr_b16 v[78:79], v33 offset:21504
  ds_read_b64_tr_b16 v[80:81], v34 offset:20480
  ds_read_b64_tr_b16 v[82:83], v34 offset:21504
  ds_read_b64_tr_b16 v[84:85], v35 offset:20480
  ds_read_b64_tr_b16 v[86:87], v35 offset:21504
  ds_read_b64_tr_b16 v[88:89], v36 offset:20480
  ds_read_b64_tr_b16 v[90:91], v36 offset:21504
  s_waitcnt lgkmcnt(15)
  s_waitcnt vmcnt(21)
  v_mfma_f32_16x16x32_bf16 v[44:47], v[96:99], v[212:215], v[44:47]
  s_add_u32 m0, s52, 49152
  s_lshl_b32 s63, s86, 4
  buffer_load_dwordx4 v22, s[32:35], s63 offen lds
  v_mfma_f32_16x16x32_bf16 v[48:51], v[100:103], v[212:215], v[48:51]
  buffer_load_dwordx4 v[148:151], v43, s[40:43], s79 offen offset:2048 sc1
  v_mfma_f32_16x16x32_bf16 v[52:55], v[104:107], v[212:215], v[52:55]
  s_add_u32 m0, s52, 50176
  s_nop 0
  buffer_load_dwordx4 v41, s[32:35], s63 offen lds
  v_mfma_f32_16x16x32_bf16 v[56:59], v[108:111], v[212:215], v[56:59]
  ds_read_b32 v28, v27
  ds_read_b64_tr_b16 v[96:97], v33 offset:24576
  ds_read_b64_tr_b16 v[98:99], v33 offset:25600
  ds_read_b64_tr_b16 v[100:101], v34 offset:24576
  ds_read_b64_tr_b16 v[102:103], v34 offset:25600
  ds_read_b64_tr_b16 v[104:105], v35 offset:24576
  ds_read_b64_tr_b16 v[106:107], v35 offset:25600
  ds_read_b64_tr_b16 v[108:109], v36 offset:24576
  ds_read_b64_tr_b16 v[110:111], v36 offset:25600
  s_waitcnt lgkmcnt(15)
  s_waitcnt vmcnt(23)
  v_mfma_f32_16x16x32_bf16 v[44:47], v[116:119], v[216:219], v[44:47]
  v_mfma_f32_16x16x32_bf16 v[48:51], v[120:123], v[216:219], v[48:51]
  buffer_load_dwordx4 v[152:155], v43, s[40:43], s80 offen offset:0 sc1
  v_mfma_f32_16x16x32_bf16 v[52:55], v[124:127], v[216:219], v[52:55]
  v_mfma_f32_16x16x32_bf16 v[56:59], v[128:131], v[216:219], v[56:59]
  ds_read_b64_tr_b16 v[116:117], v33 offset:28672
  ds_read_b64_tr_b16 v[118:119], v33 offset:29696
  ds_read_b64_tr_b16 v[120:121], v34 offset:28672
  ds_read_b64_tr_b16 v[122:123], v34 offset:29696
  ds_read_b64_tr_b16 v[124:125], v35 offset:28672
  ds_read_b64_tr_b16 v[126:127], v35 offset:29696
  ds_read_b64_tr_b16 v[128:129], v36 offset:28672
  ds_read_b64_tr_b16 v[130:131], v36 offset:29696
  s_waitcnt lgkmcnt(15)
  s_waitcnt vmcnt(23)
  v_mov_b32 v25, 7
  ds_write_b32 v26, v25
  v_mfma_f32_16x16x32_bf16 v[44:47], v[76:79], v[220:223], v[44:47]
  v_mfma_f32_16x16x32_bf16 v[48:51], v[80:83], v[220:223], v[48:51]
  buffer_load_dwordx4 v[156:159], v43, s[40:43], s80 offen offset:2048 sc1
  v_mfma_f32_16x16x32_bf16 v[52:55], v[84:87], v[220:223], v[52:55]
  v_mfma_f32_16x16x32_bf16 v[56:59], v[88:91], v[220:223], v[56:59]
k23_gs5:
  v_cmp_gt_u32 vcc, 6, v28
  s_cbranch_vccz k23_go5
  s_nop 0
  ds_read_b32 v28, v27
  s_waitcnt lgkmcnt(0)
  s_branch k23_gs5
k23_go5:

  ds_read_b64_tr_b16 v[76:77], v33 offset:32768
  ds_read_b64_tr_b16 v[78:79], v33 offset:33792
  ds_read_b64_tr_b16 v[80:81], v34 offset:32768
  ds_read_b64_tr_b16 v[82:83], v34 offset:33792
  ds_read_b64_tr_b16 v[84:85], v35 offset:32768
  ds_read_b64_tr_b16 v[86:87], v35 offset:33792
  ds_read_b64_tr_b16 v[88:89], v36 offset:32768
  ds_read_b64_tr_b16 v[90:91], v36 offset:33792
  s_waitcnt lgkmcnt(15)
  s_waitcnt vmcnt(22)
  v_mfma_f32_16x16x32_bf16 v[44:47], v[96:99], v[224:227], v[44:47]
  s_add_u32 m0, s52, 57344
  s_lshl_b32 s63, s87, 4
  buffer_load_dwordx4 v22, s[32:35], s63 offen lds
  v_mfma_f32_16x16x32_bf16 v[48:51], v[100:103], v[224:227], v[48:51]
  buffer_load_dwordx4 v[160:163], v43, s[40:43], s81 offen offset:0 sc1
  v_mfma_f32_16x16x32_bf16 v[52:55], v[104:107], v[224:227], v[52:55]
  s_add_u32 m0, s52, 58368
  s_nop 0
  buffer_load_dwordx4 v41, s[32:35], s63 offen lds
  v_mfma_f32_16x16x32_bf16 v[56:59], v[108:111], v[224:227], v[56:59]
  ds_read_b64_tr_b16 v[96:97], v33 offset:36864
  ds_read_b64_tr_b16 v[98:99], v33 offset:37888
  ds_read_b64_tr_b16 v[100:101], v34 offset:36864
  ds_read_b64_tr_b16 v[102:103], v34 offset:37888
  ds_read_b64_tr_b16 v[104:105], v35 offset:36864
  ds_read_b64_tr_b16 v[106:107], v35 offset:37888
  ds_read_b64_tr_b16 v[108:109], v36 offset:36864
  ds_read_b64_tr_b16 v[110:111], v36 offset:37888
  s_waitcnt lgkmcnt(15)
  s_waitcnt vmcnt(22)
  v_mfma_f32_16x16x32_bf16 v[44:47], v[116:119], v[228:231], v[44:47]
  s_add_u32 m0, s52, 65536
  s_lshl_b32 s63, s88, 4
  buffer_load_dwordx4 v22, s[32:35], s63 offen lds
  v_mfma_f32_16x16x32_bf16 v[48:51], v[120:123], v[228:231], v[48:51]
  buffer_load_dwordx4 v[164:167], v43, s[40:43], s81 offen offset:2048 sc1
  v_mfma_f32_16x16x32_bf16 v[52:55], v[124:127], v[228:231], v[52:55]
  s_add_u32 m0, s52, 66560
  s_nop 0
  buffer_load_dwordx4 v41, s[32:35], s63 offen lds
  v_mfma_f32_16x16x32_bf16 v[56:59], v[128:131], v[228:231], v[56:59]
  ds_read_b32 v28, v27
  ds_read_b64_tr_b16 v[116:117], v33 offset:40960
  ds_read_b64_tr_b16 v[118:119], v33 offset:41984
  ds_read_b64_tr_b16 v[120:121], v34 offset:40960
  ds_read_b64_tr_b16 v[122:123], v34 offset:41984
  ds_read_b64_tr_b16 v[124:125], v35 offset:40960
  ds_read_b64_tr_b16 v[126:127], v35 offset:41984
  ds_read_b64_tr_b16 v[128:129], v36 offset:40960
  ds_read_b64_tr_b16 v[130:131], v36 offset:41984
  s_waitcnt lgkmcnt(15)
  s_waitcnt vmcnt(23)
  v_mfma_f32_16x16x32_bf16 v[44:47], v[76:79], v[232:235], v[44:47]
  v_mfma_f32_16x16x32_bf16 v[48:51], v[80:83], v[232:235], v[48:51]
  buffer_load_dwordx4 v[168:171], v43, s[40:43], s82 offen offset:0 sc1
  v_mfma_f32_16x16x32_bf16 v[52:55], v[84:87], v[232:235], v[52:55]
  v_mfma_f32_16x16x32_bf16 v[56:59], v[88:91], v[232:235], v[56:59]
  ds_read_b64_tr_b16 v[76:77], v33 offset:45056
  ds_read_b64_tr_b16 v[78:79], v33 offset:46080
  ds_read_b64_tr_b16 v[80:81], v34 offset:45056
  ds_read_b64_tr_b16 v[82:83], v34 offset:46080
  ds_read_b64_tr_b16 v[84:85], v35 offset:45056
  ds_read_b64_tr_b16 v[86:87], v35 offset:46080
  ds_read_b64_tr_b16 v[88:89], v36 offset:45056
  ds_read_b64_tr_b16 v[90:91], v36 offset:46080
  s_waitcnt lgkmcnt(15)
  s_waitcnt vmcnt(23)
  v_mov_b32 v25, 8
  ds_write_b32 v26, v25
  v_mfma_f32_16x16x32_bf16 v[44:47], v[96:99], v[236:239], v[44:47]
  v_mfma_f32_16x16x32_bf16 v[48:51], v[100:103], v[236:239], v[48:51]
  buffer_load_dwordx4 v[172:175], v43, s[40:43], s82 offen offset:2048 sc1
  v_mfma_f32_16x16x32_bf16 v[52:55], v[104:107], v[236:239], v[52:55]
  v_mfma_f32_16x16x32_bf16 v[56:59], v[108:111], v[236:239], v[56:59]
k23_gs6:
  v_cmp_gt_u32 vcc, 7, v28
  s_cbranch_vccz k23_go6
  s_nop 0
  ds_read_b32 v28, v27
  s_waitcnt lgkmcnt(0)
  s_branch k23_gs6
k23_go6:

  ds_read_b64_tr_b16 v[96:97], v33 offset:49152
  ds_read_b64_tr_b16 v[98:99], v33 offset:50176
  ds_read_b64_tr_b16 v[100:101], v34 offset:49152
  ds_read_b64_tr_b16 v[102:103], v34 offset:50176
  ds_read_b64_tr_b16 v[104:105], v35 offset:49152
  ds_read_b64_tr_b16 v[106:107], v35 offset:50176
  ds_read_b64_tr_b16 v[108:109], v36 offset:49152
  ds_read_b64_tr_b16 v[110:111], v36 offset:50176
  s_waitcnt lgkmcnt(15)
  s_waitcnt vmcnt(22)
  v_mfma_f32_16x16x32_bf16 v[44:47], v[116:119], v[240:243], v[44:47]
  s_add_u32 m0, s52, 73728
  s_lshl_b32 s63, s89, 4
  buffer_load_dwordx4 v22, s[32:35], s63 offen lds
  v_mfma_f32_16x16x32_bf16 v[48:51], v[120:123], v[240:243], v[48:51]
  buffer_load_dwordx4 v[176:179], v43, s[40:43], s83 offen offset:0 sc1
  v_mfma_f32_16x16x32_bf16 v[52:55], v[124:127], v[240:243], v[52:55]
  s_add_u32 m0, s52, 74752
  s_nop 0
  buffer_load_dwordx4 v41, s[32:35], s63 offen lds
  v_mfma_f32_16x16x32_bf16 v[56:59], v[128:131], v[240:243], v[56:59]
  ds_read_b64_tr_b16 v[116:117], v33 offset:53248
  ds_read_b64_tr_b16 v[118:119], v33 offset:54272
  ds_read_b64_tr_b16 v[120:121], v34 offset:53248
  ds_read_b64_tr_b16 v[122:123], v34 offset:54272
  ds_read_b64_tr_b16 v[124:125], v35 offset:53248
  ds_read_b64_tr_b16 v[126:127], v35 offset:54272
  ds_read_b64_tr_b16 v[128:129], v36 offset:53248
  ds_read_b64_tr_b16 v[130:131], v36 offset:54272
  s_waitcnt lgkmcnt(15)
  s_waitcnt vmcnt(22)
  v_mfma_f32_16x16x32_bf16 v[44:47], v[76:79], v[244:247], v[44:47]
  s_add_u32 m0, s52, 81920
  s_lshl_b32 s63, s90, 4
  buffer_load_dwordx4 v22, s[32:35], s63 offen lds
  v_mfma_f32_16x16x32_bf16 v[48:51], v[80:83], v[244:247], v[48:51]
  buffer_load_dwordx4 v[180:183], v43, s[40:43], s83 offen offset:2048 sc1
  v_mfma_f32_16x16x32_bf16 v[52:55], v[84:87], v[244:247], v[52:55]
  s_add_u32 m0, s52, 82944
  s_nop 0
  buffer_load_dwordx4 v41, s[32:35], s63 offen lds
  v_mfma_f32_16x16x32_bf16 v[56:59], v[88:91], v[244:247], v[56:59]
  ds_read_b32 v28, v27
  ds_read_b64_tr_b16 v[76:77], v33 offset:57344
  ds_read_b64_tr_b16 v[78:79], v33 offset:58368
  ds_read_b64_tr_b16 v[80:81], v34 offset:57344
  ds_read_b64_tr_b16 v[82:83], v34 offset:58368
  ds_read_b64_tr_b16 v[84:85], v35 offset:57344
  ds_read_b64_tr_b16 v[86:87], v35 offset:58368
  ds_read_b64_tr_b16 v[88:89], v36 offset:57344
  ds_read_b64_tr_b16 v[90:91], v36 offset:58368
  s_waitcnt lgkmcnt(15)
  s_waitcnt vmcnt(23)
  v_mfma_f32_16x16x32_bf16 v[44:47], v[96:99], v[136:139], v[44:47]
  v_mfma_f32_16x16x32_bf16 v[48:51], v[100:103], v[136:139], v[48:51]
  buffer_load_dwordx4 v[184:187], v43, s[40:43], s84 offen offset:0 sc1
  v_mfma_f32_16x16x32_bf16 v[52:55], v[104:107], v[136:139], v[52:55]
  v_mfma_f32_16x16x32_bf16 v[56:59], v[108:111], v[136:139], v[56:59]
  ds_read_b64_tr_b16 v[96:97], v33 offset:61440
  ds_read_b64_tr_b16 v[98:99], v33 offset:62464
  ds_read_b64_tr_b16 v[100:101], v34 offset:61440
  ds_read_b64_tr_b16 v[102:103], v34 offset:62464
  ds_read_b64_tr_b16 v[104:105], v35 offset:61440
  ds_read_b64_tr_b16 v[106:107], v35 offset:62464
  ds_read_b64_tr_b16 v[108:109], v36 offset:61440
  ds_read_b64_tr_b16 v[110:111], v36 offset:62464
  s_waitcnt lgkmcnt(15)
  s_waitcnt vmcnt(23)
  v_mov_b32 v25, 9
  ds_write_b32 v26, v25
  v_mfma_f32_16x16x32_bf16 v[44:47], v[116:119], v[140:143], v[44:47]
  v_mfma_f32_16x16x32_bf16 v[48:51], v[120:123], v[140:143], v[48:51]
  buffer_load_dwordx4 v[188:191], v43, s[40:43], s84 offen offset:2048 sc1
  v_mfma_f32_16x16x32_bf16 v[52:55], v[124:127], v[140:143], v[52:55]
  v_mfma_f32_16x16x32_bf16 v[56:59], v[128:131], v[140:143], v[56:59]
k23_gs7:
  v_cmp_gt_u32 vcc, 8, v28
  s_cbranch_vccz k23_go7
  s_nop 0
  ds_read_b32 v28, v27
  s_waitcnt lgkmcnt(0)
  s_branch k23_gs7
k23_go7:

  ds_read_b64_tr_b16 v[116:117], v29 offset:0
  ds_read_b64_tr_b16 v[118:119], v29 offset:1024
  ds_read_b64_tr_b16 v[120:121], v30 offset:0
  ds_read_b64_tr_b16 v[122:123], v30 offset:1024
  ds_read_b64_tr_b16 v[124:125], v31 offset:0
  ds_read_b64_tr_b16 v[126:127], v31 offset:1024
  ds_read_b64_tr_b16 v[128:129], v32 offset:0
  ds_read_b64_tr_b16 v[130:131], v32 offset:1024
  s_waitcnt lgkmcnt(15)
  s_waitcnt vmcnt(22)
  v_mfma_f32_16x16x32_bf16 v[44:47], v[76:79], v[144:147], v[44:47]
  s_add_u32 m0, s52, 90112
  s_lshl_b32 s63, s91, 4
  buffer_load_dwordx4 v22, s[32:35], s63 offen lds
  v_mfma_f32_16x16x32_bf16 v[48:51], v[80:83], v[144:147], v[48:51]
  buffer_load_dwordx4 v[192:195], v43, s[40:43], s85 offen offset:0 sc1
  v_mfma_f32_16x16x32_bf16 v[52:55], v[84:87], v[144:147], v[52:55]
  s_add_u32 m0, s52, 91136
  s_nop 0
  buffer_load_dwordx4 v41, s[32:35], s63 offen lds
  v_mfma_f32_16x16x32_bf16 v[56:59], v[88:91], v[144:147], v[56:59]
  ds_read_b64_tr_b16 v[76:77], v29 offset:4096
  ds_read_b64_tr_b16 v[78:79], v29 offset:5120
  ds_read_b64_tr_b16 v[80:81], v30 offset:4096
  ds_read_b64_tr_b16 v[82:83], v30 offset:5120
  ds_read_b64_tr_b16 v[84:85], v31 offset:4096
  ds_read_b64_tr_b16 v[86:87], v31 offset:5120
  ds_read_b64_tr_b16 v[88:89], v32 offset:4096
  ds_read_b64_tr_b16 v[90:91], v32 offset:5120
  s_waitcnt lgkmcnt(15)
  s_waitcnt vmcnt(22)
  v_mfma_f32_16x16x32_bf16 v[44:47], v[96:99], v[148:151], v[44:47]
  v_mov_b32 v17, 159792
  s_cmp_eq_u32 s3, 4
  s_cbranch_scc0 k23_zw
  s_mov_b32 s27, 0
k23_spin:
  buffer_load_dword v16, v21, s[40:43], s59 offen sc1
  buffer_load_dword v17, v21, s[40:43], s59 offen offset:1024 sc1
  buffer_load_dword v18, v21, s[40:43], s59 offen offset:2048 sc1
  buffer_load_dword v19, v21, s[40:43], s59 offen offset:3072 sc1
  s_waitcnt vmcnt(0)
  v_xor_b32 v16, s6, v16
  v_xor_b32 v17, s6, v17
  v_xor_b32 v18, s6, v18
  v_xor_b32 v19, s6, v19
  v_or3_b32 v16, v16, v17, v18
  v_or_b32 v16, v16, v19
  v_cmp_ne_u32 vcc, 0, v16
  s_cbranch_vccz k23_go
  s_add_u32 s27, s27, 1
  s_cmp_ge_u32 s27, 0x4000
  s_cbranch_scc1 k23_go
  s_sleep 12
  s_branch k23_spin
k23_go:
  v_mov_b32 v17, 159792
  v_mov_b32 v16, 1
  ds_write_b32 v17, v16
k23_zw:
  ds_read_b32 v16, v17
  s_waitcnt lgkmcnt(0)
  v_cmp_ne_u32 vcc, 1, v16
  s_cbranch_vccz k23_zgo
  s_sleep 2
  s_branch k23_zw
k23_zgo:

  s_xor_b32 s57, s12, 0
  s_lshl_b32 s62, s57, 12
  s_add_u32 s62, s62, s51
  s_lshl_b32 s63, s57, 18
  s_add_u32 s63, s63, s55
  s_add_u32 m0, s52, 98304
  s_nop 0
  buffer_load_dwordx4 v23, s[40:43], s63 offen sc1 lds
  v_mfma_f32_16x16x32_bf16 v[48:51], v[100:103], v[148:151], v[48:51]
  buffer_load_dwordx4 v[196:199], v43, s[40:43], s85 offen offset:2048 sc1
  v_mfma_f32_16x16x32_bf16 v[52:55], v[104:107], v[148:151], v[52:55]
  s_add_u32 m0, s52, 99328
  s_nop 0
  buffer_load_dwordx4 v42, s[40:43], s63 offen sc1 lds
  v_mfma_f32_16x16x32_bf16 v[56:59], v[108:111], v[148:151], v[56:59]
  ds_read_b32 v28, v27
  ds_read_b64_tr_b16 v[96:97], v29 offset:8192
  ds_read_b64_tr_b16 v[98:99], v29 offset:9216
  ds_read_b64_tr_b16 v[100:101], v30 offset:8192
  ds_read_b64_tr_b16 v[102:103], v30 offset:9216
  ds_read_b64_tr_b16 v[104:105], v31 offset:8192
  ds_read_b64_tr_b16 v[106:107], v31 offset:9216
  ds_read_b64_tr_b16 v[108:109], v32 offset:8192
  ds_read_b64_tr_b16 v[110:111], v32 offset:9216
  s_waitcnt vmcnt(23)
  v_mfma_f32_16x16x32_bf16 v[44:47], v[116:119], v[152:155], v[44:47]
  v_mfma_f32_16x16x32_bf16 v[48:51], v[120:123], v[152:155], v[48:51]
  buffer_load_dwordx4 v[200:203], v43, s[40:43], s86 offen offset:0 sc1
  v_mfma_f32_16x16x32_bf16 v[52:55], v[124:127], v[152:155], v[52:55]
  v_mfma_f32_16x16x32_bf16 v[56:59], v[128:131], v[152:155], v[56:59]
  ds_read_b64_tr_b16 v[116:117], v29 offset:12288
  ds_read_b64_tr_b16 v[118:119], v29 offset:13312
  ds_read_b64_tr_b16 v[120:121], v30 offset:12288
  ds_read_b64_tr_b16 v[122:123], v30 offset:13312
  ds_read_b64_tr_b16 v[124:125], v31 offset:12288
  ds_read_b64_tr_b16 v[126:127], v31 offset:13312
  ds_read_b64_tr_b16 v[128:129], v32 offset:12288
  ds_read_b64_tr_b16 v[130:131], v32 offset:13312
  s_waitcnt vmcnt(23)
  v_mov_b32 v25, 10
  ds_write_b32 v26, v25
  v_mfma_f32_16x16x32_bf16 v[44:47], v[76:79], v[156:159], v[44:47]
  v_mfma_f32_16x16x32_bf16 v[48:51], v[80:83], v[156:159], v[48:51]
  buffer_load_dwordx4 v[204:207], v43, s[40:43], s86 offen offset:2048 sc1
  v_mfma_f32_16x16x32_bf16 v[52:55], v[84:87], v[156:159], v[52:55]
  v_mfma_f32_16x16x32_bf16 v[56:59], v[88:91], v[156:159], v[56:59]
  s_waitcnt lgkmcnt(15)
k23_gs8:
  v_cmp_gt_u32 vcc, 9, v28
  s_cbranch_vccz k23_go8
  s_nop 0
  ds_read_b32 v28, v27
  s_waitcnt lgkmcnt(0)
  s_branch k23_gs8
k23_go8:

  ds_read_b64_tr_b16 v[76:77], v29 offset:16384
  ds_read_b64_tr_b16 v[78:79], v29 offset:17408
  ds_read_b64_tr_b16 v[80:81], v30 offset:16384
  ds_read_b64_tr_b16 v[82:83], v30 offset:17408
  ds_read_b64_tr_b16 v[84:85], v31 offset:16384
  ds_read_b64_tr_b16 v[86:87], v31 offset:17408
  ds_read_b64_tr_b16 v[88:89], v32 offset:16384
  ds_read_b64_tr_b16 v[90:91], v32 offset:17408
  s_waitcnt lgkmcnt(15)
  s_waitcnt vmcnt(22)
  v_mfma_f32_16x16x32_bf16 v[44:47], v[96:99], v[160:163], v[44:47]
  s_add_u32 m0, s52, 106496
  s_nop 0
  buffer_load_dwordx4 v21, s[44:47], s62 offen offset:0 lds
  v_mfma_f32_16x16x32_bf16 v[48:51], v[100:103], v[160:163], v[48:51]
  buffer_load_dwordx4 v[208:211], v43, s[40:43], s87 offen offset:0 sc1
  v_mfma_f32_16x16x32_bf16 v[52:55], v[104:107], v[160:163], v[52:55]
  s_add_u32 m0, s52, 106496
  s_nop 0
  buffer_load_dwordx4 v21, s[44:47], s62 offen offset:1024 lds
  v_mfma_f32_16x16x32_bf16 v[56:59], v[108:111], v[160:163], v[56:59]
  ds_read_b64_tr_b16 v[96:97], v29 offset:20480
  ds_read_b64_tr_b16 v[98:99], v29 offset:21504
  ds_read_b64_tr_b16 v[100:101], v30 offset:20480
  ds_read_b64_tr_b16 v[102:103], v30 offset:21504
  ds_read_b64_tr_b16 v[104:105], v31 offset:20480
  ds_read_b64_tr_b16 v[106:107], v31 offset:21504
  ds_read_b64_tr_b16 v[108:109], v32 offset:20480
  ds_read_b64_tr_b16 v[110:111], v32 offset:21504
  s_waitcnt lgkmcnt(15)
  s_waitcnt vmcnt(22)
  v_mfma_f32_16x16x32_bf16 v[44:47], v[116:119], v[164:167], v[44:47]
  s_xor_b32 s57, s12, 1
  s_lshl_b32 s62, s57, 12
  s_add_u32 s62, s62, s51
  s_lshl_b32 s63, s57, 18
  s_add_u32 s63, s63, s55
  s_add_u32 m0, s52, 114688
  s_nop 0
  buffer_load_dwordx4 v23, s[40:43], s63 offen sc1 lds
  v_mfma_f32_16x16x32_bf16 v[48:51], v[120:123], v[164:167], v[48:51]
  buffer_load_dwordx4 v[212:215], v43, s[40:43], s87 offen offset:2048 sc1
  v_mfma_f32_16x16x32_bf16 v[52:55], v[124:127], v[164:167], v[52:55]
  s_add_u32 m0, s52, 115712
  s_nop 0
  buffer_load_dwordx4 v42, s[40:43], s63 offen sc1 lds
  v_mfma_f32_16x16x32_bf16 v[56:59], v[128:131], v[164:167], v[56:59]
  ds_read_b32 v28, v27
  ds_read_b64_tr_b16 v[116:117], v29 offset:24576
  ds_read_b64_tr_b16 v[118:119], v29 offset:25600
  ds_read_b64_tr_b16 v[120:121], v30 offset:24576
  ds_read_b64_tr_b16 v[122:123], v30 offset:25600
  ds_read_b64_tr_b16 v[124:125], v31 offset:24576
  ds_read_b64_tr_b16 v[126:127], v31 offset:25600
  ds_read_b64_tr_b16 v[128:129], v32 offset:24576
  ds_read_b64_tr_b16 v[130:131], v32 offset:25600
  s_waitcnt lgkmcnt(15)
  s_waitcnt vmcnt(23)
  v_mfma_f32_16x16x32_bf16 v[44:47], v[76:79], v[168:171], v[44:47]
  v_mfma_f32_16x16x32_bf16 v[48:51], v[80:83], v[168:171], v[48:51]
  buffer_load_dwordx4 v[216:219], v43, s[40:43], s88 offen offset:0 sc1
  v_mfma_f32_16x16x32_bf16 v[52:55], v[84:87], v[168:171], v[52:55]
  v_mfma_f32_16x16x32_bf16 v[56:59], v[88:91], v[168:171], v[56:59]
  ds_read_b64_tr_b16 v[76:77], v29 offset:28672
  ds_read_b64_tr_b16 v[78:79], v29 offset:29696
  ds_read_b64_tr_b16 v[80:81], v30 offset:28672
  ds_read_b64_tr_b16 v[82:83], v30 offset:29696
  ds_read_b64_tr_b16 v[84:85], v31 offset:28672
  ds_read_b64_tr_b16 v[86:87], v31 offset:29696
  ds_read_b64_tr_b16 v[88:89], v32 offset:28672
  ds_read_b64_tr_b16 v[90:91], v32 offset:29696
  s_waitcnt lgkmcnt(15)
  s_waitcnt vmcnt(23)
  v_mov_b32 v25, 11
  ds_write_b32 v26, v25
  v_mfma_f32_16x16x32_bf16 v[44:47], v[96:99], v[172:175], v[44:47]
  v_mfma_f32_16x16x32_bf16 v[48:51], v[100:103], v[172:175], v[48:51]
  buffer_load_dwordx4 v[220:223], v43, s[40:43], s88 offen offset:2048 sc1
  v_mfma_f32_16x16x32_bf16 v[52:55], v[104:107], v[172:175], v[52:55]
  v_mfma_f32_16x16x32_bf16 v[56:59], v[108:111], v[172:175], v[56:59]
k23_gs9:
  v_cmp_gt_u32 vcc, 10, v28
  s_cbranch_vccz k23_go9
  s_nop 0
  ds_read_b32 v28, v27
  s_waitcnt lgkmcnt(0)
  s_branch k23_gs9
k23_go9:

  ds_read_b64_tr_b16 v[96:97], v29 offset:32768
  ds_read_b64_tr_b16 v[98:99], v29 offset:33792
  ds_read_b64_tr_b16 v[100:101], v30 offset:32768
  ds_read_b64_tr_b16 v[102:103], v30 offset:33792
  ds_read_b64_tr_b16 v[104:105], v31 offset:32768
  ds_read_b64_tr_b16 v[106:107], v31 offset:33792
  ds_read_b64_tr_b16 v[108:109], v32 offset:32768
  ds_read_b64_tr_b16 v[110:111], v32 offset:33792
  s_waitcnt lgkmcnt(15)
  s_waitcnt vmcnt(22)
  v_mfma_f32_16x16x32_bf16 v[44:47], v[116:119], v[176:179], v[44:47]
  s_add_u32 m0, s52, 122880
  s_nop 0
  buffer_load_dwordx4 v21, s[44:47], s62 offen offset:0 lds
  v_mfma_f32_16x16x32_bf16 v[48:51], v[120:123], v[176:179], v[48:51]
  buffer_load_dwordx4 v[224:227], v43, s[40:43], s89 offen offset:0 sc1
  v_mfma_f32_16x16x32_bf16 v[52:55], v[124:127], v[176:179], v[52:55]
  s_add_u32 m0, s52, 122880
  s_nop 0
  buffer_load_dwordx4 v21, s[44:47], s62 offen offset:1024 lds
  v_mfma_f32_16x16x32_bf16 v[56:59], v[128:131], v[176:179], v[56:59]
  ds_read_b64_tr_b16 v[116:117], v29 offset:36864
  ds_read_b64_tr_b16 v[118:119], v29 offset:37888
  ds_read_b64_tr_b16 v[120:121], v30 offset:36864
  ds_read_b64_tr_b16 v[122:123], v30 offset:37888
  ds_read_b64_tr_b16 v[124:125], v31 offset:36864
  ds_read_b64_tr_b16 v[126:127], v31 offset:37888
  ds_read_b64_tr_b16 v[128:129], v32 offset:36864
  ds_read_b64_tr_b16 v[130:131], v32 offset:37888
  s_waitcnt lgkmcnt(15)
  s_waitcnt vmcnt(22)
  v_mfma_f32_16x16x32_bf16 v[44:47], v[76:79], v[180:183], v[44:47]
  s_xor_b32 s57, s12, 2
  s_lshl_b32 s62, s57, 12
  s_add_u32 s62, s62, s51
  s_lshl_b32 s63, s57, 18
  s_add_u32 s63, s63, s55
  s_add_u32 m0, s52, 0
  s_nop 0
  buffer_load_dwordx4 v23, s[40:43], s63 offen sc1 lds
  v_mfma_f32_16x16x32_bf16 v[48:51], v[80:83], v[180:183], v[48:51]
  buffer_load_dwordx4 v[228:231], v43, s[40:43], s89 offen offset:2048 sc1
  v_mfma_f32_16x16x32_bf16 v[52:55], v[84:87], v[180:183], v[52:55]
  s_add_u32 m0, s52, 1024
  s_nop 0
  buffer_load_dwordx4 v42, s[40:43], s63 offen sc1 lds
  v_mfma_f32_16x16x32_bf16 v[56:59], v[88:91], v[180:183], v[56:59]
  ds_read_b32 v28, v27
  ds_read_b64_tr_b16 v[76:77], v29 offset:40960
  ds_read_b64_tr_b16 v[78:79], v29 offset:41984
  ds_read_b64_tr_b16 v[80:81], v30 offset:40960
  ds_read_b64_tr_b16 v[82:83], v30 offset:41984
  ds_read_b64_tr_b16 v[84:85], v31 offset:40960
  ds_read_b64_tr_b16 v[86:87], v31 offset:41984
  ds_read_b64_tr_b16 v[88:89], v32 offset:40960
  ds_read_b64_tr_b16 v[90:91], v32 offset:41984
  s_waitcnt lgkmcnt(15)
  s_waitcnt vmcnt(23)
  v_mfma_f32_16x16x32_bf16 v[44:47], v[96:99], v[184:187], v[44:47]
  v_mfma_f32_16x16x32_bf16 v[48:51], v[100:103], v[184:187], v[48:51]
  buffer_load_dwordx4 v[232:235], v43, s[40:43], s90 offen offset:0 sc1
  v_mfma_f32_16x16x32_bf16 v[52:55], v[104:107], v[184:187], v[52:55]
  v_mfma_f32_16x16x32_bf16 v[56:59], v[108:111], v[184:187], v[56:59]
  ds_read_b64_tr_b16 v[96:97], v29 offset:45056
  ds_read_b64_tr_b16 v[98:99], v29 offset:46080
  ds_read_b64_tr_b16 v[100:101], v30 offset:45056
  ds_read_b64_tr_b16 v[102:103], v30 offset:46080
  ds_read_b64_tr_b16 v[104:105], v31 offset:45056
  ds_read_b64_tr_b16 v[106:107], v31 offset:46080
  ds_read_b64_tr_b16 v[108:109], v32 offset:45056
  ds_read_b64_tr_b16 v[110:111], v32 offset:46080
  s_waitcnt lgkmcnt(15)
  s_waitcnt vmcnt(23)
  v_mov_b32 v25, 12
  ds_write_b32 v26, v25
  v_mfma_f32_16x16x32_bf16 v[44:47], v[116:119], v[188:191], v[44:47]
  v_mfma_f32_16x16x32_bf16 v[48:51], v[120:123], v[188:191], v[48:51]
  buffer_load_dwordx4 v[236:239], v43, s[40:43], s90 offen offset:2048 sc1
  v_mfma_f32_16x16x32_bf16 v[52:55], v[124:127], v[188:191], v[52:55]
  v_mfma_f32_16x16x32_bf16 v[56:59], v[128:131], v[188:191], v[56:59]
k23_gs10:
  v_cmp_gt_u32 vcc, 11, v28
  s_cbranch_vccz k23_go10
  s_nop 0
  ds_read_b32 v28, v27
  s_waitcnt lgkmcnt(0)
  s_branch k23_gs10
k23_go10:

  ds_read_b64_tr_b16 v[116:117], v29 offset:49152
  ds_read_b64_tr_b16 v[118:119], v29 offset:50176
  ds_read_b64_tr_b16 v[120:121], v30 offset:49152
  ds_read_b64_tr_b16 v[122:123], v30 offset:50176
  ds_read_b64_tr_b16 v[124:125], v31 offset:49152
  ds_read_b64_tr_b16 v[126:127], v31 offset:50176
  ds_read_b64_tr_b16 v[128:129], v32 offset:49152
  ds_read_b64_tr_b16 v[130:131], v32 offset:50176
  s_waitcnt lgkmcnt(15)
  s_waitcnt vmcnt(22)
  v_mfma_f32_16x16x32_bf16 v[44:47], v[76:79], v[192:195], v[44:47]
  s_add_u32 m0, s52, 8192
  s_nop 0
  buffer_load_dwordx4 v21, s[44:47], s62 offen offset:0 lds
  v_mfma_f32_16x16x32_bf16 v[48:51], v[80:83], v[192:195], v[48:51]
  buffer_load_dwordx4 v[240:243], v43, s[40:43], s91 offen offset:0 sc1
  v_mfma_f32_16x16x32_bf16 v[52:55], v[84:87], v[192:195], v[52:55]
  s_add_u32 m0, s52, 8192
  s_nop 0
  buffer_load_dwordx4 v21, s[44:47], s62 offen offset:1024 lds
  v_mfma_f32_16x16x32_bf16 v[56:59], v[88:91], v[192:195], v[56:59]
  ds_read_b64_tr_b16 v[76:77], v29 offset:53248
  ds_read_b64_tr_b16 v[78:79], v29 offset:54272
  ds_read_b64_tr_b16 v[80:81], v30 offset:53248
  ds_read_b64_tr_b16 v[82:83], v30 offset:54272
  ds_read_b64_tr_b16 v[84:85], v31 offset:53248
  ds_read_b64_tr_b16 v[86:87], v31 offset:54272
  ds_read_b64_tr_b16 v[88:89], v32 offset:53248
  ds_read_b64_tr_b16 v[90:91], v32 offset:54272
  s_waitcnt lgkmcnt(15)
  s_waitcnt vmcnt(22)
  v_mfma_f32_16x16x32_bf16 v[44:47], v[96:99], v[196:199], v[44:47]
  s_xor_b32 s57, s12, 3
  s_lshl_b32 s62, s57, 12
  s_add_u32 s62, s62, s51
  s_lshl_b32 s63, s57, 18
  s_add_u32 s63, s63, s55
  s_add_u32 m0, s52, 16384
  s_nop 0
  buffer_load_dwordx4 v23, s[40:43], s63 offen sc1 lds
  v_mfma_f32_16x16x32_bf16 v[48:51], v[100:103], v[196:199], v[48:51]
  buffer_load_dwordx4 v[244:247], v43, s[40:43], s91 offen offset:2048 sc1
  v_mfma_f32_16x16x32_bf16 v[52:55], v[104:107], v[196:199], v[52:55]
  s_add_u32 m0, s52, 17408
  s_nop 0
  buffer_load_dwordx4 v42, s[40:43], s63 offen sc1 lds
  v_mfma_f32_16x16x32_bf16 v[56:59], v[108:111], v[196:199], v[56:59]
  ds_read_b32 v28, v27
  ds_read_b64_tr_b16 v[96:97], v29 offset:57344
  ds_read_b64_tr_b16 v[98:99], v29 offset:58368
  ds_read_b64_tr_b16 v[100:101], v30 offset:57344
  ds_read_b64_tr_b16 v[102:103], v30 offset:58368
  ds_read_b64_tr_b16 v[104:105], v31 offset:57344
  ds_read_b64_tr_b16 v[106:107], v31 offset:58368
  ds_read_b64_tr_b16 v[108:109], v32 offset:57344
  ds_read_b64_tr_b16 v[110:111], v32 offset:58368
  s_waitcnt lgkmcnt(15)
  s_waitcnt vmcnt(23)
  v_mfma_f32_16x16x32_bf16 v[44:47], v[116:119], v[200:203], v[44:47]
  v_mfma_f32_16x16x32_bf16 v[48:51], v[120:123], v[200:203], v[48:51]
  v_mfma_f32_16x16x32_bf16 v[52:55], v[124:127], v[200:203], v[52:55]
  v_mfma_f32_16x16x32_bf16 v[56:59], v[128:131], v[200:203], v[56:59]
  ds_read_b64_tr_b16 v[116:117], v29 offset:61440
  ds_read_b64_tr_b16 v[118:119], v29 offset:62464
  ds_read_b64_tr_b16 v[120:121], v30 offset:61440
  ds_read_b64_tr_b16 v[122:123], v30 offset:62464
  ds_read_b64_tr_b16 v[124:125], v31 offset:61440
  ds_read_b64_tr_b16 v[126:127], v31 offset:62464
  ds_read_b64_tr_b16 v[128:129], v32 offset:61440
  ds_read_b64_tr_b16 v[130:131], v32 offset:62464
  s_waitcnt lgkmcnt(15)
  s_waitcnt vmcnt(22)
  v_mov_b32 v25, 13
  ds_write_b32 v26, v25
  v_mfma_f32_16x16x32_bf16 v[44:47], v[76:79], v[204:207], v[44:47]
  v_mfma_f32_16x16x32_bf16 v[48:51], v[80:83], v[204:207], v[48:51]
  v_mfma_f32_16x16x32_bf16 v[52:55], v[84:87], v[204:207], v[52:55]
  v_mfma_f32_16x16x32_bf16 v[56:59], v[88:91], v[204:207], v[56:59]
k23_gs11:
  v_cmp_gt_u32 vcc, 12, v28
  s_cbranch_vccz k23_go11
  s_nop 0
  ds_read_b32 v28, v27
  s_waitcnt lgkmcnt(0)
  s_branch k23_gs11
k23_go11:

  ds_read_b64_tr_b16 v[76:77], v33 offset:0
  ds_read_b64_tr_b16 v[78:79], v33 offset:1024
  ds_read_b64_tr_b16 v[80:81], v34 offset:0
  ds_read_b64_tr_b16 v[82:83], v34 offset:1024
  ds_read_b64_tr_b16 v[84:85], v35 offset:0
  ds_read_b64_tr_b16 v[86:87], v35 offset:1024
  ds_read_b64_tr_b16 v[88:89], v36 offset:0
  ds_read_b64_tr_b16 v[90:91], v36 offset:1024
  s_waitcnt lgkmcnt(15)
  s_waitcnt vmcnt(20)
  v_mfma_f32_16x16x32_bf16 v[44:47], v[96:99], v[208:211], v[44:47]
  s_add_u32 m0, s52, 24576
  s_nop 0
  buffer_load_dwordx4 v21, s[44:47], s62 offen offset:0 lds
  v_mfma_f32_16x16x32_bf16 v[48:51], v[100:103], v[208:211], v[48:51]
  v_mfma_f32_16x16x32_bf16 v[52:55], v[104:107], v[208:211], v[52:55]
  s_add_u32 m0, s52, 24576
  s_nop 0
  buffer_load_dwordx4 v21, s[44:47], s62 offen offset:1024 lds
  v_mfma_f32_16x16x32_bf16 v[56:59], v[108:111], v[208:211], v[56:59]
  ds_read_b64_tr_b16 v[96:97], v33 offset:4096
  ds_read_b64_tr_b16 v[98:99], v33 offset:5120
  ds_read_b64_tr_b16 v[100:101], v34 offset:4096
  ds_read_b64_tr_b16 v[102:103], v34 offset:5120
  ds_read_b64_tr_b16 v[104:105], v35 offset:4096
  ds_read_b64_tr_b16 v[106:107], v35 offset:5120
  ds_read_b64_tr_b16 v[108:109], v36 offset:4096
  ds_read_b64_tr_b16 v[110:111], v36 offset:5120
  s_waitcnt lgkmcnt(15)
  s_waitcnt vmcnt(19)
  v_mfma_f32_16x16x32_bf16 v[44:47], v[116:119], v[212:215], v[44:47]
  s_xor_b32 s57, s12, 4
  s_lshl_b32 s62, s57, 12
  s_add_u32 s62, s62, s51
  s_lshl_b32 s63, s57, 18
  s_add_u32 s63, s63, s55
  s_add_u32 m0, s52, 32768
  s_nop 0
  buffer_load_dwordx4 v23, s[40:43], s63 offen sc1 lds
  v_mfma_f32_16x16x32_bf16 v[48:51], v[120:123], v[212:215], v[48:51]
  v_mfma_f32_16x16x32_bf16 v[52:55], v[124:127], v[212:215], v[52:55]
  s_add_u32 m0, s52, 33792
  s_nop 0
  buffer_load_dwordx4 v42, s[40:43], s63 offen sc1 lds
  v_mfma_f32_16x16x32_bf16 v[56:59], v[128:131], v[212:215], v[56:59]
  ds_read_b32 v28, v27
  ds_read_b64_tr_b16 v[116:117], v33 offset:8192
  ds_read_b64_tr_b16 v[118:119], v33 offset:9216
  ds_read_b64_tr_b16 v[120:121], v34 offset:8192
  ds_read_b64_tr_b16 v[122:123], v34 offset:9216
  ds_read_b64_tr_b16 v[124:125], v35 offset:8192
  ds_read_b64_tr_b16 v[126:127], v35 offset:9216
  ds_read_b64_tr_b16 v[128:129], v36 offset:8192
  ds_read_b64_tr_b16 v[130:131], v36 offset:9216
  s_waitcnt lgkmcnt(15)
  s_waitcnt vmcnt(19)
  v_mfma_f32_16x16x32_bf16 v[44:47], v[76:79], v[216:219], v[44:47]
  v_mfma_f32_16x16x32_bf16 v[48:51], v[80:83], v[216:219], v[48:51]
  v_mfma_f32_16x16x32_bf16 v[52:55], v[84:87], v[216:219], v[52:55]
  v_mfma_f32_16x16x32_bf16 v[56:59], v[88:91], v[216:219], v[56:59]
  ds_read_b64_tr_b16 v[76:77], v33 offset:12288
  ds_read_b64_tr_b16 v[78:79], v33 offset:13312
  ds_read_b64_tr_b16 v[80:81], v34 offset:12288
  ds_read_b64_tr_b16 v[82:83], v34 offset:13312
  ds_read_b64_tr_b16 v[84:85], v35 offset:12288
  ds_read_b64_tr_b16 v[86:87], v35 offset:13312
  ds_read_b64_tr_b16 v[88:89], v36 offset:12288
  ds_read_b64_tr_b16 v[90:91], v36 offset:13312
  s_waitcnt lgkmcnt(15)
  s_waitcnt vmcnt(18)
  s_waitcnt vmcnt(15)
  v_mov_b32 v25, 14
  ds_write_b32 v26, v25
  v_mfma_f32_16x16x32_bf16 v[44:47], v[96:99], v[220:223], v[44:47]
  v_mfma_f32_16x16x32_bf16 v[48:51], v[100:103], v[220:223], v[48:51]
  v_mfma_f32_16x16x32_bf16 v[52:55], v[104:107], v[220:223], v[52:55]
  v_mfma_f32_16x16x32_bf16 v[56:59], v[108:111], v[220:223], v[56:59]
k23_gs12:
  v_cmp_gt_u32 vcc, 13, v28
  s_cbranch_vccz k23_go12
  s_nop 0
  ds_read_b32 v28, v27
  s_waitcnt lgkmcnt(0)
  s_branch k23_gs12
k23_go12:

  ds_read_b64_tr_b16 v[96:97], v33 offset:16384
  ds_read_b64_tr_b16 v[98:99], v33 offset:17408
  ds_read_b64_tr_b16 v[100:101], v34 offset:16384
  ds_read_b64_tr_b16 v[102:103], v34 offset:17408
  ds_read_b64_tr_b16 v[104:105], v35 offset:16384
  ds_read_b64_tr_b16 v[106:107], v35 offset:17408
  ds_read_b64_tr_b16 v[108:109], v36 offset:16384
  ds_read_b64_tr_b16 v[110:111], v36 offset:17408
  s_waitcnt lgkmcnt(15)
  v_mfma_f32_16x16x32_bf16 v[44:47], v[116:119], v[224:227], v[44:47]
  s_add_u32 m0, s52, 40960
  s_nop 0
  buffer_load_dwordx4 v21, s[44:47], s62 offen offset:0 lds
  v_mfma_f32_16x16x32_bf16 v[48:51], v[120:123], v[224:227], v[48:51]
  v_mfma_f32_16x16x32_bf16 v[52:55], v[124:127], v[224:227], v[52:55]
  s_add_u32 m0, s52, 40960
  s_nop 0
  buffer_load_dwordx4 v21, s[44:47], s62 offen offset:1024 lds
  v_mfma_f32_16x16x32_bf16 v[56:59], v[128:131], v[224:227], v[56:59]
  buffer_load_dwordx4 v[8:11], v20, s[28:31], s23 offen
  buffer_load_dwordx4 v[12:15], v20, s[28:31], s13 offen
  ds_read_b64_tr_b16 v[116:117], v33 offset:20480
  ds_read_b64_tr_b16 v[118:119], v33 offset:21504
  ds_read_b64_tr_b16 v[120:121], v34 offset:20480
  ds_read_b64_tr_b16 v[122:123], v34 offset:21504
  ds_read_b64_tr_b16 v[124:125], v35 offset:20480
  ds_read_b64_tr_b16 v[126:127], v35 offset:21504
  ds_read_b64_tr_b16 v[128:129], v36 offset:20480
  ds_read_b64_tr_b16 v[130:131], v36 offset:21504
  s_waitcnt lgkmcnt(15)
  s_waitcnt vmcnt(17)
  s_waitcnt vmcnt(11)
  v_mov_b32 v25, 15
  ds_write_b32 v26, v25
  v_mfma_f32_16x16x32_bf16 v[44:47], v[76:79], v[228:231], v[44:47]
  s_xor_b32 s57, s12, 5
  s_lshl_b32 s62, s57, 12
  s_add_u32 s62, s62, s51
  s_lshl_b32 s63, s57, 18
  s_add_u32 s63, s63, s55
  s_add_u32 m0, s52, 49152
  s_nop 0
  buffer_load_dwordx4 v23, s[40:43], s63 offen sc1 lds
  v_mfma_f32_16x16x32_bf16 v[48:51], v[80:83], v[228:231], v[48:51]
  v_mfma_f32_16x16x32_bf16 v[52:55], v[84:87], v[228:231], v[52:55]
  s_add_u32 m0, s52, 50176
  s_nop 0
  buffer_load_dwordx4 v42, s[40:43], s63 offen sc1 lds
  v_mfma_f32_16x16x32_bf16 v[56:59], v[88:91], v[228:231], v[56:59]
  ds_read_b32 v28, v27
  ds_read_b64_tr_b16 v[76:77], v33 offset:24576
  ds_read_b64_tr_b16 v[78:79], v33 offset:25600
  ds_read_b64_tr_b16 v[80:81], v34 offset:24576
  ds_read_b64_tr_b16 v[82:83], v34 offset:25600
  ds_read_b64_tr_b16 v[84:85], v35 offset:24576
  ds_read_b64_tr_b16 v[86:87], v35 offset:25600
  ds_read_b64_tr_b16 v[88:89], v36 offset:24576
  ds_read_b64_tr_b16 v[90:91], v36 offset:25600
  s_waitcnt lgkmcnt(15)
  v_mfma_f32_16x16x32_bf16 v[44:47], v[96:99], v[232:235], v[44:47]
  v_mfma_f32_16x16x32_bf16 v[48:51], v[100:103], v[232:235], v[48:51]
  v_mfma_f32_16x16x32_bf16 v[52:55], v[104:107], v[232:235], v[52:55]
  v_mfma_f32_16x16x32_bf16 v[56:59], v[108:111], v[232:235], v[56:59]
  ds_read_b64_tr_b16 v[96:97], v33 offset:28672
  ds_read_b64_tr_b16 v[98:99], v33 offset:29696
  ds_read_b64_tr_b16 v[100:101], v34 offset:28672
  ds_read_b64_tr_b16 v[102:103], v34 offset:29696
  ds_read_b64_tr_b16 v[104:105], v35 offset:28672
  ds_read_b64_tr_b16 v[106:107], v35 offset:29696
  ds_read_b64_tr_b16 v[108:109], v36 offset:28672
  ds_read_b64_tr_b16 v[110:111], v36 offset:29696
  s_waitcnt lgkmcnt(15)
  s_waitcnt vmcnt(8)
  v_mov_b32 v25, 16
  ds_write_b32 v26, v25
  v_mfma_f32_16x16x32_bf16 v[44:47], v[116:119], v[236:239], v[44:47]
  v_mfma_f32_16x16x32_bf16 v[48:51], v[120:123], v[236:239], v[48:51]
  v_mfma_f32_16x16x32_bf16 v[52:55], v[124:127], v[236:239], v[52:55]
  v_mfma_f32_16x16x32_bf16 v[56:59], v[128:131], v[236:239], v[56:59]
k23_gs13:
  v_cmp_gt_u32 vcc, 14, v28
  s_cbranch_vccz k23_go13
  s_nop 0
  ds_read_b32 v28, v27
  s_waitcnt lgkmcnt(0)
  s_branch k23_gs13
k23_go13:

  ds_read_b64_tr_b16 v[132:133], v38 offset:32768
  ds_read_b64_tr_b16 v[134:135], v38 offset:33792
  ds_read_b128 v[116:119], v40 offset:40960
  ds_read_b128 v[120:123], v40 offset:41216
  ds_read_b128 v[124:127], v40 offset:45056
  ds_read_b128 v[128:131], v40 offset:45312
  s_waitcnt lgkmcnt(15)
  v_mfma_f32_16x16x32_bf16 v[44:47], v[76:79], v[240:243], v[44:47]
  s_add_u32 m0, s52, 57344
  s_nop 0
  buffer_load_dwordx4 v21, s[44:47], s62 offen offset:0 lds
  v_mfma_f32_16x16x32_bf16 v[48:51], v[80:83], v[240:243], v[48:51]
  v_mfma_f32_16x16x32_bf16 v[52:55], v[84:87], v[240:243], v[52:55]
  s_add_u32 m0, s52, 57344
  s_nop 0
  buffer_load_dwordx4 v21, s[44:47], s62 offen offset:1024 lds
  v_mfma_f32_16x16x32_bf16 v[56:59], v[88:91], v[240:243], v[56:59]
  ds_read_b64_tr_b16 v[92:93], v38 offset:36864
  ds_read_b64_tr_b16 v[94:95], v38 offset:37888
  ds_read_b128 v[76:79], v40 offset:43008
  ds_read_b128 v[80:83], v40 offset:43264
  ds_read_b128 v[84:87], v40 offset:47104
  ds_read_b128 v[88:91], v40 offset:47360
  s_waitcnt lgkmcnt(13)
  s_waitcnt vmcnt(6)
  v_mov_b32 v25, 17
  ds_write_b32 v26, v25
  v_mfma_f32_16x16x32_bf16 v[44:47], v[96:99], v[244:247], v[44:47]
  s_xor_b32 s57, s12, 6
  s_lshl_b32 s62, s57, 12
  s_add_u32 s62, s62, s51
  s_lshl_b32 s63, s57, 18
  s_add_u32 s63, s63, s55
  s_add_u32 m0, s52, 65536
  s_nop 0
  buffer_load_dwordx4 v23, s[40:43], s63 offen sc1 lds
  v_mfma_f32_16x16x32_bf16 v[48:51], v[100:103], v[244:247], v[48:51]
  v_mfma_f32_16x16x32_bf16 v[52:55], v[104:107], v[244:247], v[52:55]
  s_add_u32 m0, s52, 66560
  s_nop 0
  buffer_load_dwordx4 v42, s[40:43], s63 offen sc1 lds
  v_mfma_f32_16x16x32_bf16 v[56:59], v[108:111], v[244:247], v[56:59]
  ds_read_b32 v28, v27
  ds_read_b64_tr_b16 v[112:113], v38 offset:49152
  ds_read_b64_tr_b16 v[114:115], v38 offset:50176
  ds_read_b128 v[96:99], v40 offset:57344
  ds_read_b128 v[100:103], v40 offset:57600
  ds_read_b128 v[104:107], v40 offset:61440
  ds_read_b128 v[108:111], v40 offset:61696
  s_waitcnt lgkmcnt(14)
  v_mfma_f32_16x16x32_bf16 v[60:63], v[116:119], v[132:135], 0
  v_mfma_f32_16x16x32_bf16 v[64:67], v[120:123], v[132:135], 0
  v_mfma_f32_16x16x32_bf16 v[68:71], v[124:127], v[132:135], 0
  v_mfma_f32_16x16x32_bf16 v[72:75], v[128:131], v[132:135], 0
  ds_read_b64_tr_b16 v[132:133], v38 offset:53248
  ds_read_b64_tr_b16 v[134:135], v38 offset:54272
  ds_read_b128 v[116:119], v40 offset:59392
  ds_read_b128 v[120:123], v40 offset:59648
  ds_read_b128 v[124:127], v40 offset:63488
  ds_read_b128 v[128:131], v40 offset:63744
  s_waitcnt lgkmcnt(14)
  s_waitcnt vmcnt(2)
  v_mov_b32 v25, 18
  ds_write_b32 v26, v25
  v_mfma_f32_16x16x32_bf16 v[60:63], v[76:79], v[92:95], v[60:63]
  v_mfma_f32_16x16x32_bf16 v[64:67], v[80:83], v[92:95], v[64:67]
  v_mfma_f32_16x16x32_bf16 v[68:71], v[84:87], v[92:95], v[68:71]
  v_mfma_f32_16x16x32_bf16 v[72:75], v[88:91], v[92:95], v[72:75]
  s_waitcnt lgkmcnt(13)
k23_gs14:
  v_cmp_gt_u32 vcc, 16, v28
  s_cbranch_vccz k23_go14
  s_nop 0
  ds_read_b32 v28, v27
  s_waitcnt lgkmcnt(0)
  s_branch k23_gs14
k23_go14:

  ds_read_b64_tr_b16 v[92:93], v37 offset:0
  ds_read_b64_tr_b16 v[94:95], v37 offset:1024
  ds_read_b128 v[76:79], v39 offset:8192
  ds_read_b128 v[80:83], v39 offset:8448
  ds_read_b128 v[84:87], v39 offset:12288
  ds_read_b128 v[88:91], v39 offset:12544
  s_waitcnt lgkmcnt(13)
  v_mfma_f32_16x16x32_bf16 v[60:63], v[96:99], v[112:115], v[60:63]
  s_add_u32 m0, s52, 73728
  s_nop 0
  buffer_load_dwordx4 v21, s[44:47], s62 offen offset:0 lds
  v_cvt_pk_bf16_f32 v136, v44, v45
  v_cvt_pk_bf16_f32 v137, v46, v47
  v_cvt_pk_bf16_f32 v138, v48, v49
  v_cvt_pk_bf16_f32 v139, v50, v51
  v_cvt_pk_bf16_f32 v140, v52, v53
  v_cvt_pk_bf16_f32 v141, v54, v55
  v_cvt_pk_bf16_f32 v142, v56, v57
  v_cvt_pk_bf16_f32 v143, v58, v59
  v_mfma_f32_16x16x32_bf16 v[64:67], v[100:103], v[112:115], v[64:67]
  v_lshlrev_b32 v44, 16, v136
  v_and_b32 v45, s49, v136
  v_lshlrev_b32 v46, 16, v137
  v_and_b32 v47, s49, v137
  v_lshlrev_b32 v48, 16, v138
  v_and_b32 v49, s49, v138
  v_lshlrev_b32 v50, 16, v139
  v_and_b32 v51, s49, v139
  v_mfma_f32_16x16x32_bf16 v[68:71], v[104:107], v[112:115], v[68:71]
  s_add_u32 m0, s52, 73728
  s_nop 0
  buffer_load_dwordx4 v21, s[44:47], s62 offen offset:1024 lds
  v_lshlrev_b32 v52, 16, v140
  v_and_b32 v53, s49, v140
  v_lshlrev_b32 v54, 16, v141
  v_and_b32 v55, s49, v141
  v_lshlrev_b32 v56, 16, v142
  v_and_b32 v57, s49, v142
  v_lshlrev_b32 v58, 16, v143
  v_and_b32 v59, s49, v143
  v_mfma_f32_16x16x32_bf16 v[72:75], v[108:111], v[112:115], v[72:75]
  v_mul_f32 v136, 0xbfb8aa3b, v44
  v_mul_f32 v137, 0xbfb8aa3b, v45
  v_mul_f32 v138, 0xbfb8aa3b, v46
  v_mul_f32 v139, 0xbfb8aa3b, v47
  v_mul_f32 v140, 0xbfb8aa3b, v48
  v_mul_f32 v141, 0xbfb8aa3b, v49
  v_mul_f32 v142, 0xbfb8aa3b, v50
  v_mul_f32 v143, 0xbfb8aa3b, v51
  ds_read_b64_tr_b16 v[112:113], v37 offset:4096
  ds_read_b64_tr_b16 v[114:115], v37 offset:5120
  ds_read_b128 v[96:99], v39 offset:10240
  ds_read_b128 v[100:103], v39 offset:10496
  ds_read_b128 v[104:107], v39 offset:14336
  ds_read_b128 v[108:111], v39 offset:14592
  s_waitcnt lgkmcnt(13)
  s_waitcnt vmcnt(0)
  v_mov_b32 v25, 19
  ds_write_b32 v26, v25
  v_mfma_f32_16x16x32_bf16 v[60:63], v[116:119], v[132:135], v[60:63]
  s_xor_b32 s57, s12, 7
  s_lshl_b32 s62, s57, 12
  s_add_u32 s62, s62, s51
  s_lshl_b32 s63, s57, 18
  s_add_u32 s63, s63, s55
  s_add_u32 m0, s52, 81920
  s_nop 0
  buffer_load_dwordx4 v23, s[40:43], s63 offen sc1 lds
  v_mul_f32 v144, 0xbfb8aa3b, v52
  v_mul_f32 v145, 0xbfb8aa3b, v53
  v_mul_f32 v146, 0xbfb8aa3b, v54
  v_mul_f32 v147, 0xbfb8aa3b, v55
  v_mul_f32 v148, 0xbfb8aa3b, v56
  v_mul_f32 v149, 0xbfb8aa3b, v57
  v_mul_f32 v150, 0xbfb8aa3b, v58
  v_mul_f32 v151, 0xbfb8aa3b, v59
  v_mfma_f32_16x16x32_bf16 v[64:67], v[120:123], v[132:135], v[64:67]
  v_exp_f32 v136, v136
  v_exp_f32 v137, v137
  v_exp_f32 v138, v138
  v_exp_f32 v139, v139
  v_mfma_f32_16x16x32_bf16 v[68:71], v[124:127], v[132:135], v[68:71]
  s_add_u32 m0, s52, 82944
  s_nop 0
  buffer_load_dwordx4 v42, s[40:43], s63 offen sc1 lds
  v_exp_f32 v140, v140
  v_exp_f32 v141, v141
  v_exp_f32 v142, v142
  v_exp_f32 v143, v143
  v_mfma_f32_16x16x32_bf16 v[72:75], v[128:131], v[132:135], v[72:75]
  v_exp_f32 v144, v144
  v_exp_f32 v145, v145
  v_exp_f32 v146, v146
  v_exp_f32 v147, v147
  ds_read_b32 v28, v27
  ds_read_b64_tr_b16 v[132:133], v37 offset:16384
  ds_read_b64_tr_b16 v[134:135], v37 offset:17408
  ds_read_b128 v[116:119], v39 offset:24576
  ds_read_b128 v[120:123], v39 offset:24832
  ds_read_b128 v[124:127], v39 offset:28672
  ds_read_b128 v[128:131], v39 offset:28928
  s_waitcnt lgkmcnt(14)
  v_mfma_f32_16x16x32_bf16 v[60:63], v[76:79], v[92:95], v[60:63]
  v_exp_f32 v148, v148
  v_exp_f32 v149, v149
  v_exp_f32 v150, v150
  v_exp_f32 v151, v151
  v_mfma_f32_16x16x32_bf16 v[64:67], v[80:83], v[92:95], v[64:67]
  v_add_f32 v136, 1.0, v136
  v_add_f32 v137, 1.0, v137
  v_add_f32 v138, 1.0, v138
  v_add_f32 v139, 1.0, v139
  v_add_f32 v140, 1.0, v140
  v_add_f32 v141, 1.0, v141
  v_add_f32 v142, 1.0, v142
  v_add_f32 v143, 1.0, v143
  v_mfma_f32_16x16x32_bf16 v[68:71], v[84:87], v[92:95], v[68:71]
  v_add_f32 v144, 1.0, v144
  v_add_f32 v145, 1.0, v145
  v_add_f32 v146, 1.0, v146
  v_add_f32 v147, 1.0, v147
  v_add_f32 v148, 1.0, v148
  v_add_f32 v149, 1.0, v149
  v_add_f32 v150, 1.0, v150
  v_add_f32 v151, 1.0, v151
  v_mfma_f32_16x16x32_bf16 v[72:75], v[88:91], v[92:95], v[72:75]
  v_rcp_f32 v136, v136
  v_rcp_f32 v137, v137
  v_rcp_f32 v138, v138
  v_rcp_f32 v139, v139
  ds_read_b64_tr_b16 v[92:93], v37 offset:20480
  ds_read_b64_tr_b16 v[94:95], v37 offset:21504
  ds_read_b128 v[76:79], v39 offset:26624
  ds_read_b128 v[80:83], v39 offset:26880
  ds_read_b128 v[84:87], v39 offset:30720
  ds_read_b128 v[88:91], v39 offset:30976
  s_waitcnt lgkmcnt(14)
  v_mov_b32 v25, 20
  ds_write_b32 v26, v25
  v_mfma_f32_16x16x32_bf16 v[60:63], v[96:99], v[112:115], v[60:63]
  v_rcp_f32 v140, v140
  v_rcp_f32 v141, v141
  v_rcp_f32 v142, v142
  v_rcp_f32 v143, v143
  v_mfma_f32_16x16x32_bf16 v[64:67], v[100:103], v[112:115], v[64:67]
  v_rcp_f32 v144, v144
  v_rcp_f32 v145, v145
  v_rcp_f32 v146, v146
  v_rcp_f32 v147, v147
  v_mfma_f32_16x16x32_bf16 v[68:71], v[104:107], v[112:115], v[68:71]
  v_rcp_f32 v148, v148
  v_rcp_f32 v149, v149
  v_rcp_f32 v150, v150
  v_rcp_f32 v151, v151
  v_mfma_f32_16x16x32_bf16 v[72:75], v[108:111], v[112:115], v[72:75]
  v_mul_f32 v44, v44, v136
  v_mul_f32 v45, v45, v137
  v_mul_f32 v46, v46, v138
  v_mul_f32 v47, v47, v139
  v_mul_f32 v48, v48, v140
  v_mul_f32 v49, v49, v141
  v_mul_f32 v50, v50, v142
  v_mul_f32 v51, v51, v143
  s_waitcnt lgkmcnt(13)
k23_gs15:
  v_cmp_gt_u32 vcc, 18, v28
  s_cbranch_vccz k23_go15
  s_nop 0
  ds_read_b32 v28, v27
  s_waitcnt lgkmcnt(0)
  s_branch k23_gs15
k23_go15:

  ds_read_b64_tr_b16 v[112:113], v37 offset:32768
  ds_read_b64_tr_b16 v[114:115], v37 offset:33792
  ds_read_b128 v[96:99], v39 offset:40960
  ds_read_b128 v[100:103], v39 offset:41216
  ds_read_b128 v[104:107], v39 offset:45056
  ds_read_b128 v[108:111], v39 offset:45312
  s_waitcnt lgkmcnt(13)
  v_mfma_f32_16x16x32_bf16 v[60:63], v[116:119], v[132:135], v[60:63]
  s_add_u32 m0, s52, 90112
  s_nop 0
  buffer_load_dwordx4 v21, s[44:47], s62 offen offset:0 lds
  v_mul_f32 v52, v52, v144
  v_mul_f32 v53, v53, v145
  v_mul_f32 v54, v54, v146
  v_mul_f32 v55, v55, v147
  v_mul_f32 v56, v56, v148
  v_mul_f32 v57, v57, v149
  v_mul_f32 v58, v58, v150
  v_mul_f32 v59, v59, v151
  v_mfma_f32_16x16x32_bf16 v[64:67], v[120:123], v[132:135], v[64:67]
  v_cvt_pk_bf16_f32 v136, v44, v45
  v_cvt_pk_bf16_f32 v137, v46, v47
  v_cvt_pk_bf16_f32 v138, v48, v49
  v_cvt_pk_bf16_f32 v139, v50, v51
  v_cvt_pk_bf16_f32 v140, v52, v53
  v_cvt_pk_bf16_f32 v141, v54, v55
  v_cvt_pk_bf16_f32 v142, v56, v57
  v_cvt_pk_bf16_f32 v143, v58, v59
  v_mfma_f32_16x16x32_bf16 v[68:71], v[124:127], v[132:135], v[68:71]
  s_add_u32 m0, s52, 90112
  s_nop 0
  buffer_load_dwordx4 v21, s[44:47], s62 offen offset:1024 lds
  v_lshlrev_b32 v44, 16, v136
  v_and_b32 v45, s49, v136
  v_lshlrev_b32 v46, 16, v137
  v_and_b32 v47, s49, v137
  v_lshlrev_b32 v48, 16, v138
  v_and_b32 v49, s49, v138
  v_lshlrev_b32 v50, 16, v139
  v_and_b32 v51, s49, v139
  v_mfma_f32_16x16x32_bf16 v[72:75], v[128:131], v[132:135], v[72:75]
  v_lshlrev_b32 v52, 16, v140
  v_and_b32 v53, s49, v140
  v_lshlrev_b32 v54, 16, v141
  v_and_b32 v55, s49, v141
  v_lshlrev_b32 v56, 16, v142
  v_and_b32 v57, s49, v142
  v_lshlrev_b32 v58, 16, v143
  v_and_b32 v59, s49, v143
  ds_read_b64_tr_b16 v[132:133], v37 offset:36864
  ds_read_b64_tr_b16 v[134:135], v37 offset:37888
  ds_read_b128 v[116:119], v39 offset:43008
  ds_read_b128 v[120:123], v39 offset:43264
  ds_read_b128 v[124:127], v39 offset:47104
  ds_read_b128 v[128:131], v39 offset:47360
  s_waitcnt lgkmcnt(13)
  s_waitcnt vmcnt(0)
  v_mov_b32 v25, 21
  ds_write_b32 v26, v25
  v_mfma_f32_16x16x32_bf16 v[60:63], v[76:79], v[92:95], v[60:63]
  v_mfma_f32_16x16x32_bf16 v[64:67], v[80:83], v[92:95], v[64:67]
  v_mfma_f32_16x16x32_bf16 v[68:71], v[84:87], v[92:95], v[68:71]
  v_mfma_f32_16x16x32_bf16 v[72:75], v[88:91], v[92:95], v[72:75]
  ds_read_b32 v28, v27
  ds_read_b64_tr_b16 v[92:93], v37 offset:49152
  ds_read_b64_tr_b16 v[94:95], v37 offset:50176
  ds_read_b128 v[76:79], v39 offset:57344
  ds_read_b128 v[80:83], v39 offset:57600
  ds_read_b128 v[84:87], v39 offset:61440
  ds_read_b128 v[88:91], v39 offset:61696
  s_waitcnt lgkmcnt(14)
  v_mfma_f32_16x16x32_bf16 v[60:63], v[96:99], v[112:115], v[60:63]
  v_mfma_f32_16x16x32_bf16 v[64:67], v[100:103], v[112:115], v[64:67]
  v_mfma_f32_16x16x32_bf16 v[68:71], v[104:107], v[112:115], v[68:71]
  v_mfma_f32_16x16x32_bf16 v[72:75], v[108:111], v[112:115], v[72:75]
  ds_read_b64_tr_b16 v[112:113], v37 offset:53248
  ds_read_b64_tr_b16 v[114:115], v37 offset:54272
  ds_read_b128 v[96:99], v39 offset:59392
  ds_read_b128 v[100:103], v39 offset:59648
  ds_read_b128 v[104:107], v39 offset:63488
  ds_read_b128 v[108:111], v39 offset:63744
  s_waitcnt lgkmcnt(14)
  v_mfma_f32_16x16x32_bf16 v[60:63], v[116:119], v[132:135], v[60:63]
  v_mfma_f32_16x16x32_bf16 v[64:67], v[120:123], v[132:135], v[64:67]
  v_mfma_f32_16x16x32_bf16 v[68:71], v[124:127], v[132:135], v[68:71]
  v_mfma_f32_16x16x32_bf16 v[72:75], v[128:131], v[132:135], v[72:75]
  s_waitcnt lgkmcnt(12)
k23_gs16:
  v_cmp_gt_u32 vcc, 21, v28
  s_cbranch_vccz k23_go16
  s_nop 0
  ds_read_b32 v28, v27
  s_waitcnt lgkmcnt(0)
  s_branch k23_gs16
k23_go16:

  ds_read_b64_tr_b16 v[132:133], v38 offset:0
  ds_read_b64_tr_b16 v[134:135], v38 offset:1024
  ds_read_b128 v[116:119], v40 offset:8192
  ds_read_b128 v[120:123], v40 offset:8448
  ds_read_b128 v[124:127], v40 offset:12288
  ds_read_b128 v[128:131], v40 offset:12544
  s_waitcnt lgkmcnt(12)
  v_mfma_f32_16x16x32_bf16 v[60:63], v[76:79], v[92:95], v[60:63]
  v_mfma_f32_16x16x32_bf16 v[64:67], v[80:83], v[92:95], v[64:67]
  v_mfma_f32_16x16x32_bf16 v[68:71], v[84:87], v[92:95], v[68:71]
  v_mfma_f32_16x16x32_bf16 v[72:75], v[88:91], v[92:95], v[72:75]
  ds_read_b64_tr_b16 v[92:93], v38 offset:4096
  ds_read_b64_tr_b16 v[94:95], v38 offset:5120
  ds_read_b128 v[76:79], v40 offset:10240
  ds_read_b128 v[80:83], v40 offset:10496
  ds_read_b128 v[84:87], v40 offset:14336
  ds_read_b128 v[88:91], v40 offset:14592
  s_waitcnt lgkmcnt(12)
  v_mfma_f32_16x16x32_bf16 v[60:63], v[96:99], v[112:115], v[60:63]
  v_mfma_f32_16x16x32_bf16 v[64:67], v[100:103], v[112:115], v[64:67]
  v_mfma_f32_16x16x32_bf16 v[68:71], v[104:107], v[112:115], v[68:71]
  v_mfma_f32_16x16x32_bf16 v[72:75], v[108:111], v[112:115], v[72:75]
  ds_read_b64_tr_b16 v[112:113], v38 offset:16384
  ds_read_b64_tr_b16 v[114:115], v38 offset:17408
  ds_read_b128 v[96:99], v40 offset:24576
  ds_read_b128 v[100:103], v40 offset:24832
  ds_read_b128 v[104:107], v40 offset:28672
  ds_read_b128 v[108:111], v40 offset:28928
  s_waitcnt lgkmcnt(12)
  v_mfma_f32_16x16x32_bf16 v[60:63], v[116:119], v[132:135], v[60:63]
  v_mfma_f32_16x16x32_bf16 v[64:67], v[120:123], v[132:135], v[64:67]
  v_mfma_f32_16x16x32_bf16 v[68:71], v[124:127], v[132:135], v[68:71]
  v_mfma_f32_16x16x32_bf16 v[72:75], v[128:131], v[132:135], v[72:75]
  ds_read_b64_tr_b16 v[132:133], v38 offset:20480
  ds_read_b64_tr_b16 v[134:135], v38 offset:21504
  ds_read_b128 v[116:119], v40 offset:26624
  ds_read_b128 v[120:123], v40 offset:26880
  ds_read_b128 v[124:127], v40 offset:30720
  ds_read_b128 v[128:131], v40 offset:30976
  s_waitcnt lgkmcnt(12)
  v_mfma_f32_16x16x32_bf16 v[60:63], v[76:79], v[92:95], v[60:63]
  v_mfma_f32_16x16x32_bf16 v[64:67], v[80:83], v[92:95], v[64:67]
  v_mfma_f32_16x16x32_bf16 v[68:71], v[84:87], v[92:95], v[68:71]
  v_mfma_f32_16x16x32_bf16 v[72:75], v[88:91], v[92:95], v[72:75]
  s_waitcnt lgkmcnt(6)
  v_mfma_f32_16x16x32_bf16 v[60:63], v[96:99], v[112:115], v[60:63]
  v_mfma_f32_16x16x32_bf16 v[64:67], v[100:103], v[112:115], v[64:67]
  v_mfma_f32_16x16x32_bf16 v[68:71], v[104:107], v[112:115], v[68:71]
  v_mfma_f32_16x16x32_bf16 v[72:75], v[108:111], v[112:115], v[72:75]
  s_waitcnt lgkmcnt(0)
  v_mfma_f32_16x16x32_bf16 v[60:63], v[116:119], v[132:135], v[60:63]
  v_mfma_f32_16x16x32_bf16 v[64:67], v[120:123], v[132:135], v[64:67]
  v_mfma_f32_16x16x32_bf16 v[68:71], v[124:127], v[132:135], v[68:71]
  v_mfma_f32_16x16x32_bf16 v[72:75], v[128:131], v[132:135], v[72:75]
  s_nop 7
  v_cvt_pk_bf16_f32 v160, v60, v61
  v_cvt_pk_bf16_f32 v161, v62, v63
  v_cvt_pk_bf16_f32 v162, v64, v65
  v_cvt_pk_bf16_f32 v163, v66, v67
  v_cvt_pk_bf16_f32 v164, v68, v69
  v_cvt_pk_bf16_f32 v165, v70, v71
  v_cvt_pk_bf16_f32 v166, v72, v73
  v_cvt_pk_bf16_f32 v167, v74, v75
  v_lshlrev_b32 v60, 16, v160
  v_and_b32 v61, s49, v160
  v_lshlrev_b32 v62, 16, v161
  v_and_b32 v63, s49, v161
  v_lshlrev_b32 v64, 16, v162
  v_and_b32 v65, s49, v162
  v_lshlrev_b32 v66, 16, v163
  v_and_b32 v67, s49, v163
  v_lshlrev_b32 v68, 16, v164
  v_and_b32 v69, s49, v164
  v_lshlrev_b32 v70, 16, v165
  v_and_b32 v71, s49, v165
  v_lshlrev_b32 v72, 16, v166
  v_and_b32 v73, s49, v166
  v_lshlrev_b32 v74, 16, v167
  v_and_b32 v75, s49, v167
  v_mul_f32 v60, v60, v44
  v_mul_f32 v61, v61, v45
  v_mul_f32 v62, v62, v46
  v_mul_f32 v63, v63, v47
  v_mul_f32 v64, v64, v48
  v_mul_f32 v65, v65, v49
  v_mul_f32 v66, v66, v50
  v_mul_f32 v67, v67, v51
  v_mul_f32 v68, v68, v52
  v_mul_f32 v69, v69, v53
  v_mul_f32 v70, v70, v54
  v_mul_f32 v71, v71, v55
  v_mul_f32 v72, v72, v56
  v_mul_f32 v73, v73, v57
  v_mul_f32 v74, v74, v58
  v_mul_f32 v75, v75, v59
  v_cvt_pk_bf16_f32 v152, v60, v61
  v_cvt_pk_bf16_f32 v153, v62, v63
  v_cvt_pk_bf16_f32 v154, v64, v65
  v_cvt_pk_bf16_f32 v155, v66, v67
  v_cvt_pk_bf16_f32 v156, v68, v69
  v_cvt_pk_bf16_f32 v157, v70, v71
  v_cvt_pk_bf16_f32 v158, v72, v73
  v_cvt_pk_bf16_f32 v159, v74, v75
  v_lshrrev_b32 v5, 1, v4
  v_and_b32 v6, 7, v2
  v_xor_b32 v5, v5, v6
  v_and_b32 v7, 1, v4
  v_lshlrev_b32 v7, 3, v7
  v_lshl_add_u32 v7, v3, 7, v7
  s_lshl_b32 s26, s7, 11
  s_add_u32 s26, s26, 131072
  v_add_u32 v7, s26, v7
  s_barrier

  v_xor_b32 v1, 0, v5
  v_lshl_add_u32 v1, v1, 4, v7
  ds_write_b64 v1, v[152:153]
  v_xor_b32 v1, 2, v5
  v_lshl_add_u32 v1, v1, 4, v7
  ds_write_b64 v1, v[154:155]
  v_xor_b32 v1, 4, v5
  v_lshl_add_u32 v1, v1, 4, v7
  ds_write_b64 v1, v[156:157]
  v_xor_b32 v1, 6, v5
  v_lshl_add_u32 v1, v1, 4, v7
  ds_write_b64 v1, v[158:159]
  v_lshrrev_b32 v4, 3, v2
  v_xor_b32 v6, v6, v4
  v_lshlrev_b32 v6, 4, v6
  v_lshl_add_u32 v6, v4, 7, v6
  v_add_u32 v6, s26, v6
  s_waitcnt lgkmcnt(0)
  ds_read_b128 v[160:163], v6
  ds_read_b128 v[164:167], v6 offset:1024

  s_waitcnt vmcnt(0)
  v_lshlrev_b32 v44, 16, v8
  v_and_b32 v45, s49, v8
  v_lshlrev_b32 v46, 16, v9
  v_and_b32 v47, s49, v9
  v_lshlrev_b32 v48, 16, v10
  v_and_b32 v49, s49, v10
  v_lshlrev_b32 v50, 16, v11
  v_and_b32 v51, s49, v11
  v_lshlrev_b32 v52, 16, v12
  v_and_b32 v53, s49, v12
  v_lshlrev_b32 v54, 16, v13
  v_and_b32 v55, s49, v13
  v_lshlrev_b32 v56, 16, v14
  v_and_b32 v57, s49, v14
  v_lshlrev_b32 v58, 16, v15
  v_and_b32 v59, s49, v15
  s_waitcnt lgkmcnt(0)
  v_lshlrev_b32 v60, 16, v160
  v_and_b32 v61, s49, v160
  v_lshlrev_b32 v62, 16, v161
  v_and_b32 v63, s49, v161
  v_lshlrev_b32 v64, 16, v162
  v_and_b32 v65, s49, v162
  v_lshlrev_b32 v66, 16, v163
  v_and_b32 v67, s49, v163
  v_lshlrev_b32 v68, 16, v164
  v_and_b32 v69, s49, v164
  v_lshlrev_b32 v70, 16, v165
  v_and_b32 v71, s49, v165
  v_lshlrev_b32 v72, 16, v166
  v_and_b32 v73, s49, v166
  v_lshlrev_b32 v74, 16, v167
  v_and_b32 v75, s49, v167
  v_add_f32 v60, v60, v44
  v_add_f32 v61, v61, v45
  v_add_f32 v62, v62, v46
  v_add_f32 v63, v63, v47
  v_add_f32 v64, v64, v48
  v_add_f32 v65, v65, v49
  v_add_f32 v66, v66, v50
  v_add_f32 v67, v67, v51
  v_add_f32 v68, v68, v52
  v_add_f32 v69, v69, v53
  v_add_f32 v70, v70, v54
  v_add_f32 v71, v71, v55
  v_add_f32 v72, v72, v56
  v_add_f32 v73, v73, v57
  v_add_f32 v74, v74, v58
  v_add_f32 v75, v75, v59
  v_cvt_pk_bf16_f32 v152, v60, v61
  v_cvt_pk_bf16_f32 v153, v62, v63
  v_cvt_pk_bf16_f32 v154, v64, v65
  v_cvt_pk_bf16_f32 v155, v66, v67
  v_cvt_pk_bf16_f32 v156, v68, v69
  v_cvt_pk_bf16_f32 v157, v70, v71
  v_cvt_pk_bf16_f32 v158, v72, v73
  v_cvt_pk_bf16_f32 v159, v74, v75
  buffer_store_dwordx4 v[152:155], v20, s[36:39], s23 offen sc1
  buffer_store_dwordx4 v[156:159], v20, s[36:39], s13 offen sc1
  s_endpgm
k23_conv:
  s_barrier
  s_mov_b32 s13, s3
  s_lshl_b32 s60, s2, 13
  s_lshl_b32 s61, s13, 10
  s_add_u32 s60, s60, s61
  s_add_u32 s60, s60, 8388608
  s_add_u32 s61, s60, 4096
  s_lshl_b32 s27, s13, 9
  v_lshlrev_b32 v1, 7, v4
  v_add3_u32 v1, v1, v3, s27
  s_movk_i32 s27, 144
  v_mul_lo_u32 v6, v3, s27
  v_add_u32 v6, 131072, v6
  v_lshl_add_u32 v5, v4, 3, v6
  s_lshl_b32 s27, s13, 5
  v_add_u32 v5, s27, v5
  v_lshl_add_u32 v6, v4, 4, v6

  s_setprio 2
  s_lshl_b32 s27, s13, 2
  s_add_u32 s27, s27, 159760
  v_mov_b32 v112, s27
  v_mov_b32 v114, 0
  v_and_b32 v113, 3, v2
  v_lshlrev_b32 v113, 2, v113
  v_add_u32 v113, 159760, v113

  v_xor_b32 v56, s48, v212
  v_xor_b32 v57, s48, v213
  v_xor_b32 v58, s48, v214
  v_xor_b32 v59, s48, v215
  s_nop 1
  v_mfma_f32_16x16x32_f16 v[8:11], v[208:211], v[128:131], 0
  v_mfma_f32_16x16x32_f16 v[16:19], v[208:211], v[136:139], 0
  v_mfma_f32_16x16x32_f16 v[12:15], v[208:211], v[132:135], 0
  v_mfma_f32_16x16x32_f16 v[20:23], v[208:211], v[140:143], 0
  v_mfma_f32_16x16x32_f16 v[8:11], v[56:59], v[136:139], v[8:11]
  v_mfma_f32_16x16x32_f16 v[16:19], v[212:215], v[128:131], v[16:19]
  v_mfma_f32_16x16x32_f16 v[12:15], v[56:59], v[140:143], v[12:15]
  v_mfma_f32_16x16x32_f16 v[20:23], v[212:215], v[132:135], v[20:23]
  s_nop 7
  v_fma_mix_f32 v64, v16, v144, 0 op_sel:[0,1,0] op_sel_hi:[0,1,0]
  v_fma_mix_f32 v65, v8, v144, 0 op_sel:[0,1,0] op_sel_hi:[0,1,0]

  v_fma_mix_f32 v66, v17, v145, 0 op_sel:[0,1,0] op_sel_hi:[0,1,0]
  v_fma_mix_f32 v67, v9, v145, 0 op_sel:[0,1,0] op_sel_hi:[0,1,0]

  v_fma_mix_f32 v68, v18, v146, 0 op_sel:[0,1,0] op_sel_hi:[0,1,0]
  v_fma_mix_f32 v69, v10, v146, 0 op_sel:[0,1,0] op_sel_hi:[0,1,0]

  v_fma_mix_f32 v70, v19, v147, 0 op_sel:[0,1,0] op_sel_hi:[0,1,0]
  v_fma_mix_f32 v71, v11, v147, 0 op_sel:[0,1,0] op_sel_hi:[0,1,0]

  v_fma_mix_f32 v8, v8, v144, -v64 op_sel:[0,0,0] op_sel_hi:[0,1,0]
  v_fma_mix_f32 v16, v16, v144, v65 op_sel:[0,0,0] op_sel_hi:[0,1,0]

  v_fma_mix_f32 v9, v9, v145, -v66 op_sel:[0,0,0] op_sel_hi:[0,1,0]
  v_fma_mix_f32 v17, v17, v145, v67 op_sel:[0,0,0] op_sel_hi:[0,1,0]

  v_fma_mix_f32 v10, v10, v146, -v68 op_sel:[0,0,0] op_sel_hi:[0,1,0]
  v_fma_mix_f32 v18, v18, v146, v69 op_sel:[0,0,0] op_sel_hi:[0,1,0]

  v_fma_mix_f32 v11, v11, v147, -v70 op_sel:[0,0,0] op_sel_hi:[0,1,0]
  v_fma_mix_f32 v19, v19, v147, v71 op_sel:[0,0,0] op_sel_hi:[0,1,0]

  v_fma_mix_f32 v64, v20, v148, 0 op_sel:[0,1,0] op_sel_hi:[0,1,0]
  v_fma_mix_f32 v65, v12, v148, 0 op_sel:[0,1,0] op_sel_hi:[0,1,0]

  v_fma_mix_f32 v66, v21, v149, 0 op_sel:[0,1,0] op_sel_hi:[0,1,0]
  v_fma_mix_f32 v67, v13, v149, 0 op_sel:[0,1,0] op_sel_hi:[0,1,0]

  v_fma_mix_f32 v68, v22, v150, 0 op_sel:[0,1,0] op_sel_hi:[0,1,0]
  v_fma_mix_f32 v69, v14, v150, 0 op_sel:[0,1,0] op_sel_hi:[0,1,0]

  v_fma_mix_f32 v70, v23, v151, 0 op_sel:[0,1,0] op_sel_hi:[0,1,0]
  v_fma_mix_f32 v71, v15, v151, 0 op_sel:[0,1,0] op_sel_hi:[0,1,0]

  v_fma_mix_f32 v12, v12, v148, -v64 op_sel:[0,0,0] op_sel_hi:[0,1,0]
  v_fma_mix_f32 v20, v20, v148, v65 op_sel:[0,0,0] op_sel_hi:[0,1,0]

  v_fma_mix_f32 v13, v13, v149, -v66 op_sel:[0,0,0] op_sel_hi:[0,1,0]
  v_fma_mix_f32 v21, v21, v149, v67 op_sel:[0,0,0] op_sel_hi:[0,1,0]

  v_fma_mix_f32 v14, v14, v150, -v68 op_sel:[0,0,0] op_sel_hi:[0,1,0]
  v_fma_mix_f32 v22, v22, v150, v69 op_sel:[0,0,0] op_sel_hi:[0,1,0]

  v_fma_mix_f32 v15, v15, v151, -v70 op_sel:[0,0,0] op_sel_hi:[0,1,0]
  v_fma_mix_f32 v23, v23, v151, v71 op_sel:[0,0,0] op_sel_hi:[0,1,0]

  v_cvt_pk_f16_f32 v72, v8, v9
  v_cvt_pk_f16_f32 v73, v10, v11
  v_cvt_pk_f16_f32 v74, v12, v13
  v_cvt_pk_f16_f32 v75, v14, v15
  v_cvt_pk_f16_f32 v76, v16, v17
  v_cvt_pk_f16_f32 v77, v18, v19
  v_cvt_pk_f16_f32 v78, v20, v21
  v_cvt_pk_f16_f32 v79, v22, v23
  ds_write_b64 v5, v[72:73] offset:0
  ds_write_b64 v5, v[74:75] offset:2304
  ds_write_b64 v5, v[76:77] offset:4608
  ds_write_b64 v5, v[78:79] offset:6912
  v_mov_b32 v114, 1
  s_waitcnt lgkmcnt(0)
  ds_write_b32 v112, v114

k23_cs1:
  ds_read_b32 v114, v113
  s_waitcnt lgkmcnt(0)
  v_cmp_gt_u32 vcc, 1, v114
  s_cbranch_vccnz k23_cs1

  ds_read_b128 v[24:27], v6 offset:0
  ds_read_b128 v[28:31], v6 offset:64
  ds_read_b128 v[32:35], v6 offset:2304
  ds_read_b128 v[36:39], v6 offset:2368
  ds_read_b128 v[40:43], v6 offset:4608
  ds_read_b128 v[44:47], v6 offset:4672
  ds_read_b128 v[48:51], v6 offset:6912
  ds_read_b128 v[52:55], v6 offset:6976
  v_xor_b32 v56, s48, v160
  v_xor_b32 v57, s48, v161
  v_xor_b32 v58, s48, v162
  v_xor_b32 v59, s48, v163
  v_xor_b32 v60, s48, v164
  v_xor_b32 v61, s48, v165
  v_xor_b32 v62, s48, v166
  v_xor_b32 v63, s48, v167
  s_waitcnt lgkmcnt(0)
  v_mfma_f32_16x16x32_f16 v[8:11], v[152:155], v[24:27], 0
  v_mfma_f32_16x16x32_f16 v[16:19], v[160:163], v[24:27], 0
  v_mfma_f32_16x16x32_f16 v[12:15], v[152:155], v[32:35], 0
  v_mfma_f32_16x16x32_f16 v[20:23], v[160:163], v[32:35], 0
  v_mfma_f32_16x16x32_f16 v[8:11], v[56:59], v[40:43], v[8:11]
  v_mfma_f32_16x16x32_f16 v[16:19], v[152:155], v[40:43], v[16:19]
  v_mfma_f32_16x16x32_f16 v[12:15], v[56:59], v[48:51], v[12:15]
  v_mfma_f32_16x16x32_f16 v[20:23], v[152:155], v[48:51], v[20:23]
  v_mfma_f32_16x16x32_f16 v[8:11], v[156:159], v[28:31], v[8:11]
  v_mfma_f32_16x16x32_f16 v[16:19], v[164:167], v[28:31], v[16:19]
  v_mfma_f32_16x16x32_f16 v[12:15], v[156:159], v[36:39], v[12:15]
  v_mfma_f32_16x16x32_f16 v[20:23], v[164:167], v[36:39], v[20:23]
  v_mfma_f32_16x16x32_f16 v[8:11], v[60:63], v[44:47], v[8:11]
  v_mfma_f32_16x16x32_f16 v[16:19], v[156:159], v[44:47], v[16:19]
  v_mfma_f32_16x16x32_f16 v[12:15], v[60:63], v[52:55], v[12:15]
  v_mfma_f32_16x16x32_f16 v[20:23], v[156:159], v[52:55], v[20:23]
  s_cmp_eq_u32 s2, 0
  s_cbranch_scc1 k2_special

  s_nop 7
  v_lshlrev_b32 v66, 16, v216
  v_and_b32 v67, s49, v216
  v_mul_f32 v64, v16, v67
  v_mul_f32 v65, v8, v67
  v_fma_f32 v8, v8, v66, -v64
  v_fma_f32 v16, v16, v66, v65

  v_lshlrev_b32 v70, 16, v217
  v_and_b32 v71, s49, v217
  v_mul_f32 v68, v17, v71
  v_mul_f32 v69, v9, v71
  v_fma_f32 v9, v9, v70, -v68
  v_fma_f32 v17, v17, v70, v69

  v_lshlrev_b32 v66, 16, v218
  v_and_b32 v67, s49, v218
  v_mul_f32 v64, v18, v67
  v_mul_f32 v65, v10, v67
  v_fma_f32 v10, v10, v66, -v64
  v_fma_f32 v18, v18, v66, v65

  v_lshlrev_b32 v70, 16, v219
  v_and_b32 v71, s49, v219
  v_mul_f32 v68, v19, v71
  v_mul_f32 v69, v11, v71
  v_fma_f32 v11, v11, v70, -v68
  v_fma_f32 v19, v19, v70, v69

  v_lshlrev_b32 v66, 16, v220
  v_and_b32 v67, s49, v220
  v_mul_f32 v64, v20, v67
  v_mul_f32 v65, v12, v67
  v_fma_f32 v12, v12, v66, -v64
  v_fma_f32 v20, v20, v66, v65

  v_lshlrev_b32 v70, 16, v221
  v_and_b32 v71, s49, v221
  v_mul_f32 v68, v21, v71
  v_mul_f32 v69, v13, v71
  v_fma_f32 v13, v13, v70, -v68
  v_fma_f32 v21, v21, v70, v69

  v_lshlrev_b32 v66, 16, v222
  v_and_b32 v67, s49, v222
  v_mul_f32 v64, v22, v67
  v_mul_f32 v65, v14, v67
  v_fma_f32 v14, v14, v66, -v64
  v_fma_f32 v22, v22, v66, v65

  v_lshlrev_b32 v70, 16, v223
  v_and_b32 v71, s49, v223
  v_mul_f32 v68, v23, v71
  v_mul_f32 v69, v15, v71
  v_fma_f32 v15, v15, v70, -v68
  v_fma_f32 v23, v23, v70, v69

  s_branch k2_join
k2_special:
  v_lshlrev_b32 v80, 16, v216
  v_and_b32 v81, s49, v216
  v_lshlrev_b32 v82, 16, v232
  v_and_b32 v83, s49, v232
  v_lshlrev_b32 v128, 16, v224
  v_and_b32 v129, s49, v224
  v_lshlrev_b32 v130, 16, v240
  v_and_b32 v131, s49, v240

  v_lshlrev_b32 v84, 16, v217
  v_and_b32 v85, s49, v217
  v_lshlrev_b32 v86, 16, v233
  v_and_b32 v87, s49, v233
  v_lshlrev_b32 v132, 16, v225
  v_and_b32 v133, s49, v225
  v_lshlrev_b32 v134, 16, v241
  v_and_b32 v135, s49, v241

  v_lshlrev_b32 v88, 16, v218
  v_and_b32 v89, s49, v218
  v_lshlrev_b32 v90, 16, v234
  v_and_b32 v91, s49, v234
  v_lshlrev_b32 v136, 16, v226
  v_and_b32 v137, s49, v226
  v_lshlrev_b32 v138, 16, v242
  v_and_b32 v139, s49, v242

  v_lshlrev_b32 v92, 16, v219
  v_and_b32 v93, s49, v219
  v_lshlrev_b32 v94, 16, v235
  v_and_b32 v95, s49, v235
  v_lshlrev_b32 v140, 16, v227
  v_and_b32 v141, s49, v227
  v_lshlrev_b32 v142, 16, v243
  v_and_b32 v143, s49, v243

  v_lshlrev_b32 v96, 16, v220
  v_and_b32 v97, s49, v220
  v_lshlrev_b32 v98, 16, v236
  v_and_b32 v99, s49, v236
  v_lshlrev_b32 v144, 16, v228
  v_and_b32 v145, s49, v228
  v_lshlrev_b32 v146, 16, v244
  v_and_b32 v147, s49, v244

  v_lshlrev_b32 v100, 16, v221
  v_and_b32 v101, s49, v221
  v_lshlrev_b32 v102, 16, v237
  v_and_b32 v103, s49, v237
  v_lshlrev_b32 v148, 16, v229
  v_and_b32 v149, s49, v229
  v_lshlrev_b32 v150, 16, v245
  v_and_b32 v151, s49, v245

  v_lshlrev_b32 v104, 16, v222
  v_and_b32 v105, s49, v222
  v_lshlrev_b32 v106, 16, v238
  v_and_b32 v107, s49, v238
  v_lshlrev_b32 v152, 16, v230
  v_and_b32 v153, s49, v230
  v_lshlrev_b32 v154, 16, v246
  v_and_b32 v155, s49, v246

  v_lshlrev_b32 v108, 16, v223
  v_and_b32 v109, s49, v223
  v_lshlrev_b32 v110, 16, v239
  v_and_b32 v111, s49, v239
  v_lshlrev_b32 v156, 16, v231
  v_and_b32 v157, s49, v231
  v_lshlrev_b32 v158, 16, v247
  v_and_b32 v159, s49, v247

  v_add_f32 v80, v80, v82
  v_sub_f32 v81, v81, v83
  v_add_f32 v128, v128, v130
  v_sub_f32 v129, v129, v131

  v_add_f32 v84, v84, v86
  v_sub_f32 v85, v85, v87
  v_add_f32 v132, v132, v134
  v_sub_f32 v133, v133, v135

  v_add_f32 v88, v88, v90
  v_sub_f32 v89, v89, v91
  v_add_f32 v136, v136, v138
  v_sub_f32 v137, v137, v139

  v_add_f32 v92, v92, v94
  v_sub_f32 v93, v93, v95
  v_add_f32 v140, v140, v142
  v_sub_f32 v141, v141, v143

  v_add_f32 v96, v96, v98
  v_sub_f32 v97, v97, v99
  v_add_f32 v144, v144, v146
  v_sub_f32 v145, v145, v147

  v_add_f32 v100, v100, v102
  v_sub_f32 v101, v101, v103
  v_add_f32 v148, v148, v150
  v_sub_f32 v149, v149, v151

  v_add_f32 v104, v104, v106
  v_sub_f32 v105, v105, v107
  v_add_f32 v152, v152, v154
  v_sub_f32 v153, v153, v155

  v_add_f32 v108, v108, v110
  v_sub_f32 v109, v109, v111
  v_add_f32 v156, v156, v158
  v_sub_f32 v157, v157, v159

  v_sub_f32 v82, v80, v128
  v_sub_f32 v83, v81, v129
  v_add_f32 v80, v80, v128
  v_add_f32 v81, v81, v129

  v_sub_f32 v86, v84, v132
  v_sub_f32 v87, v85, v133
  v_add_f32 v84, v84, v132
  v_add_f32 v85, v85, v133

  v_sub_f32 v90, v88, v136
  v_sub_f32 v91, v89, v137
  v_add_f32 v88, v88, v136
  v_add_f32 v89, v89, v137

  v_sub_f32 v94, v92, v140
  v_sub_f32 v95, v93, v141
  v_add_f32 v92, v92, v140
  v_add_f32 v93, v93, v141

  v_sub_f32 v98, v96, v144
  v_sub_f32 v99, v97, v145
  v_add_f32 v96, v96, v144
  v_add_f32 v97, v97, v145

  v_sub_f32 v102, v100, v148
  v_sub_f32 v103, v101, v149
  v_add_f32 v100, v100, v148
  v_add_f32 v101, v101, v149

  v_sub_f32 v106, v104, v152
  v_sub_f32 v107, v105, v153
  v_add_f32 v104, v104, v152
  v_add_f32 v105, v105, v153

  v_sub_f32 v110, v108, v156
  v_sub_f32 v111, v109, v157
  v_add_f32 v108, v108, v156
  v_add_f32 v109, v109, v157

  v_mul_f32 v80, 0x3e800000, v80
  v_mul_f32 v81, 0x3e800000, v81
  v_mul_f32 v82, 0x3e800000, v82
  v_mul_f32 v83, 0x3e800000, v83
  v_mul_f32 v84, 0x3e800000, v84
  v_mul_f32 v85, 0x3e800000, v85
  v_mul_f32 v86, 0x3e800000, v86
  v_mul_f32 v87, 0x3e800000, v87
  v_mul_f32 v88, 0x3e800000, v88
  v_mul_f32 v89, 0x3e800000, v89
  v_mul_f32 v90, 0x3e800000, v90
  v_mul_f32 v91, 0x3e800000, v91
  v_mul_f32 v92, 0x3e800000, v92
  v_mul_f32 v93, 0x3e800000, v93
  v_mul_f32 v94, 0x3e800000, v94
  v_mul_f32 v95, 0x3e800000, v95
  v_mul_f32 v96, 0x3e800000, v96
  v_mul_f32 v97, 0x3e800000, v97
  v_mul_f32 v98, 0x3e800000, v98
  v_mul_f32 v99, 0x3e800000, v99
  v_mul_f32 v100, 0x3e800000, v100
  v_mul_f32 v101, 0x3e800000, v101
  v_mul_f32 v102, 0x3e800000, v102
  v_mul_f32 v103, 0x3e800000, v103
  v_mul_f32 v104, 0x3e800000, v104
  v_mul_f32 v105, 0x3e800000, v105
  v_mul_f32 v106, 0x3e800000, v106
  v_mul_f32 v107, 0x3e800000, v107
  v_mul_f32 v108, 0x3e800000, v108
  v_mul_f32 v109, 0x3e800000, v109
  v_mul_f32 v110, 0x3e800000, v110
  v_mul_f32 v111, 0x3e800000, v111
  v_cvt_pk_f16_f32 v64, v8, v16
  v_add_u32 v65, 37376, v1
  v_lshlrev_b32 v65, 2, v65
  ds_write_b32 v65, v64

  v_cvt_pk_f16_f32 v66, v9, v17
  v_add_u32 v67, 37408, v1
  v_lshlrev_b32 v67, 2, v67
  ds_write_b32 v67, v66

  v_cvt_pk_f16_f32 v64, v10, v18
  v_add_u32 v65, 37440, v1
  v_lshlrev_b32 v65, 2, v65
  ds_write_b32 v65, v64

  v_cvt_pk_f16_f32 v66, v11, v19
  v_add_u32 v67, 37472, v1
  v_lshlrev_b32 v67, 2, v67
  ds_write_b32 v67, v66

  v_cvt_pk_f16_f32 v64, v12, v20
  v_add_u32 v65, 37392, v1
  v_lshlrev_b32 v65, 2, v65
  ds_write_b32 v65, v64

  v_cvt_pk_f16_f32 v66, v13, v21
  v_add_u32 v67, 37424, v1
  v_lshlrev_b32 v67, 2, v67
  ds_write_b32 v67, v66

  v_cvt_pk_f16_f32 v64, v14, v22
  v_add_u32 v65, 37456, v1
  v_lshlrev_b32 v65, 2, v65
  ds_write_b32 v65, v64

  v_cvt_pk_f16_f32 v66, v15, v23
  v_add_u32 v67, 37488, v1
  v_lshlrev_b32 v67, 2, v67
  ds_write_b32 v67, v66

  v_mul_f32 v32, v8, v80
  v_mul_f32 v33, v8, v81
  v_mul_f32 v34, v9, v84
  v_mul_f32 v35, v9, v85
  v_mul_f32 v36, v10, v88
  v_mul_f32 v37, v10, v89
  v_mul_f32 v38, v11, v92
  v_mul_f32 v39, v11, v93
  v_mul_f32 v40, v12, v96
  v_mul_f32 v41, v12, v97
  v_mul_f32 v42, v13, v100
  v_mul_f32 v43, v13, v101
  v_mul_f32 v44, v14, v104
  v_mul_f32 v45, v14, v105
  v_mul_f32 v46, v15, v108
  v_mul_f32 v47, v15, v109
  v_fma_f32 v32, -v16, v81, v32
  v_fma_f32 v33, v16, v80, v33
  v_fma_f32 v34, -v17, v85, v34
  v_fma_f32 v35, v17, v84, v35
  v_fma_f32 v36, -v18, v89, v36
  v_fma_f32 v37, v18, v88, v37
  v_fma_f32 v38, -v19, v93, v38
  v_fma_f32 v39, v19, v92, v39
  v_fma_f32 v40, -v20, v97, v40
  v_fma_f32 v41, v20, v96, v41
  v_fma_f32 v42, -v21, v101, v42
  v_fma_f32 v43, v21, v100, v43
  v_fma_f32 v44, -v22, v105, v44
  v_fma_f32 v45, v22, v104, v45
  v_fma_f32 v46, -v23, v109, v46
  v_fma_f32 v47, v23, v108, v47
  v_mov_b32 v114, 2
  s_waitcnt lgkmcnt(0)
  ds_write_b32 v112, v114

k23_cs2s:
  ds_read_b32 v114, v113
  s_waitcnt lgkmcnt(0)
  v_cmp_gt_u32 vcc, 2, v114
  s_cbranch_vccnz k23_cs2s

  v_add_u32 v68, 0, v1
  v_sub_u32 v68, 2048, v68
  v_and_b32 v68, 2047, v68
  v_lshlrev_b32 v68, 2, v68
  v_add_u32 v68, 149504, v68
  ds_read_b32 v24, v68

  v_add_u32 v68, 32, v1
  v_sub_u32 v68, 2048, v68
  v_and_b32 v68, 2047, v68
  v_lshlrev_b32 v68, 2, v68
  v_add_u32 v68, 149504, v68
  ds_read_b32 v25, v68

  v_add_u32 v68, 64, v1
  v_sub_u32 v68, 2048, v68
  v_and_b32 v68, 2047, v68
  v_lshlrev_b32 v68, 2, v68
  v_add_u32 v68, 149504, v68
  ds_read_b32 v26, v68

  v_add_u32 v68, 96, v1
  v_sub_u32 v68, 2048, v68
  v_and_b32 v68, 2047, v68
  v_lshlrev_b32 v68, 2, v68
  v_add_u32 v68, 149504, v68
  ds_read_b32 v27, v68

  v_add_u32 v68, 16, v1
  v_sub_u32 v68, 2048, v68
  v_and_b32 v68, 2047, v68
  v_lshlrev_b32 v68, 2, v68
  v_add_u32 v68, 149504, v68
  ds_read_b32 v28, v68

  v_add_u32 v68, 48, v1
  v_sub_u32 v68, 2048, v68
  v_and_b32 v68, 2047, v68
  v_lshlrev_b32 v68, 2, v68
  v_add_u32 v68, 149504, v68
  ds_read_b32 v29, v68

  v_add_u32 v68, 80, v1
  v_sub_u32 v68, 2048, v68
  v_and_b32 v68, 2047, v68
  v_lshlrev_b32 v68, 2, v68
  v_add_u32 v68, 149504, v68
  ds_read_b32 v30, v68

  v_add_u32 v68, 112, v1
  v_sub_u32 v68, 2048, v68
  v_and_b32 v68, 2047, v68
  v_lshlrev_b32 v68, 2, v68
  v_add_u32 v68, 149504, v68
  ds_read_b32 v31, v68

  s_waitcnt lgkmcnt(0)
  v_fma_mix_f32 v32, v82, v24, v32 op_sel:[0,0,0] op_sel_hi:[0,1,0]
  v_fma_mix_f32 v33, v83, v24, v33 op_sel:[0,0,0] op_sel_hi:[0,1,0]

  v_fma_mix_f32 v34, v86, v25, v34 op_sel:[0,0,0] op_sel_hi:[0,1,0]
  v_fma_mix_f32 v35, v87, v25, v35 op_sel:[0,0,0] op_sel_hi:[0,1,0]

  v_fma_mix_f32 v36, v90, v26, v36 op_sel:[0,0,0] op_sel_hi:[0,1,0]
  v_fma_mix_f32 v37, v91, v26, v37 op_sel:[0,0,0] op_sel_hi:[0,1,0]

  v_fma_mix_f32 v38, v94, v27, v38 op_sel:[0,0,0] op_sel_hi:[0,1,0]
  v_fma_mix_f32 v39, v95, v27, v39 op_sel:[0,0,0] op_sel_hi:[0,1,0]

  v_fma_mix_f32 v40, v98, v28, v40 op_sel:[0,0,0] op_sel_hi:[0,1,0]
  v_fma_mix_f32 v41, v99, v28, v41 op_sel:[0,0,0] op_sel_hi:[0,1,0]

  v_fma_mix_f32 v42, v102, v29, v42 op_sel:[0,0,0] op_sel_hi:[0,1,0]
  v_fma_mix_f32 v43, v103, v29, v43 op_sel:[0,0,0] op_sel_hi:[0,1,0]

  v_fma_mix_f32 v44, v106, v30, v44 op_sel:[0,0,0] op_sel_hi:[0,1,0]
  v_fma_mix_f32 v45, v107, v30, v45 op_sel:[0,0,0] op_sel_hi:[0,1,0]

  v_fma_mix_f32 v46, v110, v31, v46 op_sel:[0,0,0] op_sel_hi:[0,1,0]
  v_fma_mix_f32 v47, v111, v31, v47 op_sel:[0,0,0] op_sel_hi:[0,1,0]

  v_fma_mix_f32 v8, v83, v24, v32 op_sel:[0,1,0] op_sel_hi:[0,1,0]
  v_fma_mix_f32 v16, -v82, v24, v33 op_sel:[0,1,0] op_sel_hi:[0,1,0]

  v_fma_mix_f32 v9, v87, v25, v34 op_sel:[0,1,0] op_sel_hi:[0,1,0]
  v_fma_mix_f32 v17, -v86, v25, v35 op_sel:[0,1,0] op_sel_hi:[0,1,0]

  v_fma_mix_f32 v10, v91, v26, v36 op_sel:[0,1,0] op_sel_hi:[0,1,0]
  v_fma_mix_f32 v18, -v90, v26, v37 op_sel:[0,1,0] op_sel_hi:[0,1,0]

  v_fma_mix_f32 v11, v95, v27, v38 op_sel:[0,1,0] op_sel_hi:[0,1,0]
  v_fma_mix_f32 v19, -v94, v27, v39 op_sel:[0,1,0] op_sel_hi:[0,1,0]

  v_fma_mix_f32 v12, v99, v28, v40 op_sel:[0,1,0] op_sel_hi:[0,1,0]
  v_fma_mix_f32 v20, -v98, v28, v41 op_sel:[0,1,0] op_sel_hi:[0,1,0]

  v_fma_mix_f32 v13, v103, v29, v42 op_sel:[0,1,0] op_sel_hi:[0,1,0]
  v_fma_mix_f32 v21, -v102, v29, v43 op_sel:[0,1,0] op_sel_hi:[0,1,0]

  v_fma_mix_f32 v14, v107, v30, v44 op_sel:[0,1,0] op_sel_hi:[0,1,0]
  v_fma_mix_f32 v22, -v106, v30, v45 op_sel:[0,1,0] op_sel_hi:[0,1,0]

  v_fma_mix_f32 v15, v111, v31, v46 op_sel:[0,1,0] op_sel_hi:[0,1,0]
  v_fma_mix_f32 v23, -v110, v31, v47 op_sel:[0,1,0] op_sel_hi:[0,1,0]

k2_join:
  v_cvt_pk_bf16_f32 v72, v8, v9
  v_cvt_pk_bf16_f32 v73, v10, v11
  v_cvt_pk_bf16_f32 v74, v12, v13
  v_cvt_pk_bf16_f32 v75, v14, v15
  v_cvt_pk_bf16_f32 v76, v16, v17
  v_cvt_pk_bf16_f32 v77, v18, v19
  v_cvt_pk_bf16_f32 v78, v20, v21
  v_cvt_pk_bf16_f32 v79, v22, v23
  ds_write_b64 v5, v[72:73] offset:9216
  ds_write_b64 v5, v[74:75] offset:11520
  ds_write_b64 v5, v[76:77] offset:13824
  ds_write_b64 v5, v[78:79] offset:16128
  v_mov_b32 v114, 3
  s_waitcnt lgkmcnt(0)
  ds_write_b32 v112, v114

k23_cs3:
  ds_read_b32 v114, v113
  s_waitcnt lgkmcnt(0)
  v_cmp_gt_u32 vcc, 3, v114
  s_cbranch_vccnz k23_cs3

  ds_read_b128 v[24:27], v6 offset:9216
  ds_read_b128 v[28:31], v6 offset:9280
  ds_read_b128 v[32:35], v6 offset:11520
  ds_read_b128 v[36:39], v6 offset:11584
  ds_read_b128 v[40:43], v6 offset:13824
  ds_read_b128 v[44:47], v6 offset:13888
  ds_read_b128 v[48:51], v6 offset:16128
  ds_read_b128 v[52:55], v6 offset:16192
  v_xor_b32 v56, s48, v176
  v_xor_b32 v57, s48, v177
  v_xor_b32 v58, s48, v178
  v_xor_b32 v59, s48, v179
  v_xor_b32 v60, s48, v180
  v_xor_b32 v61, s48, v181
  v_xor_b32 v62, s48, v182
  v_xor_b32 v63, s48, v183
  s_waitcnt lgkmcnt(0)
  v_mfma_f32_16x16x32_bf16 v[8:11], v[24:27], v[168:171], 0
  v_mfma_f32_16x16x32_bf16 v[16:19], v[24:27], v[176:179], 0
  v_mfma_f32_16x16x32_bf16 v[12:15], v[32:35], v[168:171], 0
  v_mfma_f32_16x16x32_bf16 v[20:23], v[32:35], v[176:179], 0
  v_mfma_f32_16x16x32_bf16 v[8:11], v[40:43], v[56:59], v[8:11]
  v_mfma_f32_16x16x32_bf16 v[16:19], v[40:43], v[168:171], v[16:19]
  v_mfma_f32_16x16x32_bf16 v[12:15], v[48:51], v[56:59], v[12:15]
  v_mfma_f32_16x16x32_bf16 v[20:23], v[48:51], v[168:171], v[20:23]
  v_mfma_f32_16x16x32_bf16 v[8:11], v[28:31], v[172:175], v[8:11]
  v_mfma_f32_16x16x32_bf16 v[16:19], v[28:31], v[180:183], v[16:19]
  v_mfma_f32_16x16x32_bf16 v[12:15], v[36:39], v[172:175], v[12:15]
  v_mfma_f32_16x16x32_bf16 v[20:23], v[36:39], v[180:183], v[20:23]
  v_mfma_f32_16x16x32_bf16 v[8:11], v[44:47], v[60:63], v[8:11]
  v_mfma_f32_16x16x32_bf16 v[16:19], v[44:47], v[172:175], v[16:19]
  v_mfma_f32_16x16x32_bf16 v[12:15], v[52:55], v[60:63], v[12:15]
  v_mfma_f32_16x16x32_bf16 v[20:23], v[52:55], v[172:175], v[20:23]
  s_nop 7
  v_fma_mix_f32 v64, v16, v184, 0 op_sel:[0,1,0] op_sel_hi:[0,1,0]
  v_fma_mix_f32 v65, v8, v184, 0 op_sel:[0,1,0] op_sel_hi:[0,1,0]

  v_fma_mix_f32 v66, v17, v185, 0 op_sel:[0,1,0] op_sel_hi:[0,1,0]
  v_fma_mix_f32 v67, v9, v185, 0 op_sel:[0,1,0] op_sel_hi:[0,1,0]

  v_fma_mix_f32 v68, v18, v186, 0 op_sel:[0,1,0] op_sel_hi:[0,1,0]
  v_fma_mix_f32 v69, v10, v186, 0 op_sel:[0,1,0] op_sel_hi:[0,1,0]

  v_fma_mix_f32 v70, v19, v187, 0 op_sel:[0,1,0] op_sel_hi:[0,1,0]
  v_fma_mix_f32 v71, v11, v187, 0 op_sel:[0,1,0] op_sel_hi:[0,1,0]

  v_fma_mix_f32 v8, v8, v184, -v64 op_sel:[0,0,0] op_sel_hi:[0,1,0]
  v_fma_mix_f32 v16, v16, v184, v65 op_sel:[0,0,0] op_sel_hi:[0,1,0]

  v_fma_mix_f32 v9, v9, v185, -v66 op_sel:[0,0,0] op_sel_hi:[0,1,0]
  v_fma_mix_f32 v17, v17, v185, v67 op_sel:[0,0,0] op_sel_hi:[0,1,0]

  v_fma_mix_f32 v10, v10, v186, -v68 op_sel:[0,0,0] op_sel_hi:[0,1,0]
  v_fma_mix_f32 v18, v18, v186, v69 op_sel:[0,0,0] op_sel_hi:[0,1,0]

  v_fma_mix_f32 v11, v11, v187, -v70 op_sel:[0,0,0] op_sel_hi:[0,1,0]
  v_fma_mix_f32 v19, v19, v187, v71 op_sel:[0,0,0] op_sel_hi:[0,1,0]

  v_fma_mix_f32 v64, v20, v188, 0 op_sel:[0,1,0] op_sel_hi:[0,1,0]
  v_fma_mix_f32 v65, v12, v188, 0 op_sel:[0,1,0] op_sel_hi:[0,1,0]

  v_fma_mix_f32 v66, v21, v189, 0 op_sel:[0,1,0] op_sel_hi:[0,1,0]
  v_fma_mix_f32 v67, v13, v189, 0 op_sel:[0,1,0] op_sel_hi:[0,1,0]

  v_fma_mix_f32 v68, v22, v190, 0 op_sel:[0,1,0] op_sel_hi:[0,1,0]
  v_fma_mix_f32 v69, v14, v190, 0 op_sel:[0,1,0] op_sel_hi:[0,1,0]

  v_fma_mix_f32 v70, v23, v191, 0 op_sel:[0,1,0] op_sel_hi:[0,1,0]
  v_fma_mix_f32 v71, v15, v191, 0 op_sel:[0,1,0] op_sel_hi:[0,1,0]

  v_fma_mix_f32 v12, v12, v188, -v64 op_sel:[0,0,0] op_sel_hi:[0,1,0]
  v_fma_mix_f32 v20, v20, v188, v65 op_sel:[0,0,0] op_sel_hi:[0,1,0]

  v_fma_mix_f32 v13, v13, v189, -v66 op_sel:[0,0,0] op_sel_hi:[0,1,0]
  v_fma_mix_f32 v21, v21, v189, v67 op_sel:[0,0,0] op_sel_hi:[0,1,0]

  v_fma_mix_f32 v14, v14, v190, -v68 op_sel:[0,0,0] op_sel_hi:[0,1,0]
  v_fma_mix_f32 v22, v22, v190, v69 op_sel:[0,0,0] op_sel_hi:[0,1,0]

  v_fma_mix_f32 v15, v15, v191, -v70 op_sel:[0,0,0] op_sel_hi:[0,1,0]
  v_fma_mix_f32 v23, v23, v191, v71 op_sel:[0,0,0] op_sel_hi:[0,1,0]

  v_cvt_pk_bf16_f32 v72, v8, v9
  v_cvt_pk_bf16_f32 v73, v10, v11
  v_cvt_pk_bf16_f32 v74, v12, v13
  v_cvt_pk_bf16_f32 v75, v14, v15
  v_cvt_pk_bf16_f32 v76, v16, v17
  v_cvt_pk_bf16_f32 v77, v18, v19
  v_cvt_pk_bf16_f32 v78, v20, v21
  v_cvt_pk_bf16_f32 v79, v22, v23
  v_xor_b32 v56, s48, v76
  v_xor_b32 v57, s48, v77
  v_xor_b32 v58, s48, v78
  v_xor_b32 v59, s48, v79
  s_nop 1
  v_mfma_f32_16x16x32_bf16 v[8:11], v[192:195], v[72:75], 0
  v_mfma_f32_16x16x32_bf16 v[16:19], v[200:203], v[72:75], 0
  v_mfma_f32_16x16x32_bf16 v[12:15], v[196:199], v[72:75], 0
  v_mfma_f32_16x16x32_bf16 v[20:23], v[204:207], v[72:75], 0
  v_mfma_f32_16x16x32_bf16 v[8:11], v[200:203], v[56:59], v[8:11]
  v_mfma_f32_16x16x32_bf16 v[16:19], v[192:195], v[76:79], v[16:19]
  v_mfma_f32_16x16x32_bf16 v[12:15], v[204:207], v[56:59], v[12:15]
  v_mfma_f32_16x16x32_bf16 v[20:23], v[196:199], v[76:79], v[20:23]
  v_lshlrev_b32 v5, 6, v3
  v_and_b32 v1, 1, v4
  v_lshl_add_u32 v5, v1, 5, v5
  v_lshrrev_b32 v1, 1, v4
  v_lshl_add_u32 v5, v1, 4, v5
  s_add_u32 s60, s60, 2097152
  s_add_u32 s61, s61, 2097152
  s_nop 3

  v_cvt_pk_bf16_f32 v72, v8, v9
  v_cvt_pk_bf16_f32 v73, v10, v11
  v_cvt_pk_bf16_f32 v74, v12, v13
  v_cvt_pk_bf16_f32 v75, v14, v15
  v_cvt_pk_bf16_f32 v76, v16, v17
  v_cvt_pk_bf16_f32 v77, v18, v19
  v_cvt_pk_bf16_f32 v78, v20, v21
  v_cvt_pk_bf16_f32 v79, v22, v23
  s_nop 1
  v_permlane16_swap_b32 v72, v74
  v_permlane16_swap_b32 v73, v75
  v_permlane16_swap_b32 v76, v78
  v_permlane16_swap_b32 v77, v79
  buffer_store_dwordx4 v[72:75], v5, s[40:43], s60 offen sc1
  buffer_store_dwordx4 v[76:79], v5, s[40:43], s61 offen sc1
  s_waitcnt vmcnt(0)
  v_mov_b32 v114, 4
  s_waitcnt lgkmcnt(0)
  ds_write_b32 v112, v114

k23_cs4:
  ds_read_b32 v114, v113
  s_waitcnt lgkmcnt(0)
  v_cmp_gt_u32 vcc, 4, v114
  s_cbranch_vccnz k23_cs4

  s_cmp_eq_u32 s13, 0
  s_cbranch_scc0 k23_nosig
  s_lshl_b32 s26, s2, 4
  s_add_u32 s26, s26, 15728640
  v_mov_b32 v1, s6
  v_mov_b32 v7, 0
  s_mov_b64 exec, 1
  buffer_store_dword v1, v7, s[40:43], s26 offen sc1
  s_mov_b64 exec, -1
k23_nosig:

k23_end:
  s_endpgm
code_end:
.set CA0, 0x3d80
.set CB0, 0x3e00
.set CA1, 0x3d80
.set CB1, 0x3e00
.set CA2, 0x3d80
.set CB2, 0x3e00
.set CA3, 0x3d80
.set CB3, 0x3e00
.set CA4, 0x3d80
.set CB4, 0x3e00
.set CA5, 0x3d80
.set CB5, 0x3e00
.set CA6, 0x3d7f
.set CB6, 0x3dff
.set CA7, 0x3d7f
.set CB7, 0x3dff
.set CA8, 0x3d7f
.set CB8, 0x3dff
.set CA9, 0x3d7e
.set CB9, 0x3dfe
.set CA10, 0x3d7e
.set CB10, 0x3dfe
.set CA11, 0x3d7e
.set CB11, 0x3dfe
.set CA12, 0x3d7d
.set CB12, 0x3dfd
.set CA13, 0x3d7d
.set CB13, 0x3dfd
.set CA14, 0x3d7c
.set CB14, 0x3dfc
.set CA15, 0x3d7c
.set CB15, 0x3dfc
.set CA16, 0x3d7b
.set CB16, 0x3dfb
.set CA17, 0x3d7a
.set CB17, 0x3dfa
.set CA18, 0x3d7a
.set CB18, 0x3dfa
.set CA19, 0x3d79
.set CB19, 0x3df9
.set CA20, 0x3d78
.set CB20, 0x3df8
.set CA21, 0x3d78
.set CB21, 0x3df8
.set CA22, 0x3d77
.set CB22, 0x3df7
.set CA23, 0x3d76
.set CB23, 0x3df6
.set CA24, 0x3d75
.set CB24, 0x3df5
.set CA25, 0x3d74
.set CB25, 0x3df4
.set CA26, 0x3d73
.set CB26, 0x3df3
.set CA27, 0x3d72
.set CB27, 0x3df2
.set CA28, 0x3d71
.set CB28, 0x3df1
.set CA29, 0x3d70
.set CB29, 0x3df0
.set CA30, 0x3d6f
.set CB30, 0x3def
.set CA31, 0x3d6e
.set CB31, 0x3dee
.set CA32, 0x3d6d
.set CB32, 0x3ded
.set CA33, 0x3d6b
.set CB33, 0x3deb
.set CA34, 0x3d6a
.set CB34, 0x3dea
.set CA35, 0x3d69
.set CB35, 0x3de9
.set CA36, 0x3d67
.set CB36, 0x3de7
.set CA37, 0x3d66
.set CB37, 0x3de6
.set CA38, 0x3d65
.set CB38, 0x3de5
.set CA39, 0x3d63
.set CB39, 0x3de3
.set CA40, 0x3d62
.set CB40, 0x3de2
.set CA41, 0x3d60
.set CB41, 0x3de0
.set CA42, 0x3d5f
.set CB42, 0x3ddf
.set CA43, 0x3d5d
.set CB43, 0x3ddd
.set CA44, 0x3d5c
.set CB44, 0x3ddc
.set CA45, 0x3d5a
.set CB45, 0x3dda
.set CA46, 0x3d58
.set CB46, 0x3dd8
.set CA47, 0x3d57
.set CB47, 0x3dd7
.set CA48, 0x3d55
.set CB48, 0x3dd5
.set CA49, 0x3d53
.set CB49, 0x3dd3
.set CA50, 0x3d51
.set CB50, 0x3dd1
.set CA51, 0x3d4f
.set CB51, 0x3dcf
.set CA52, 0x3d4e
.set CB52, 0x3dce
.set CA53, 0x3d4c
.set CB53, 0x3dcc
.set CA54, 0x3d4a
.set CB54, 0x3dca
.set CA55, 0x3d48
.set CB55, 0x3dc8
.set CA56, 0x3d46
.set CB56, 0x3dc6
.set CA57, 0x3d44
.set CB57, 0x3dc4
.set CA58, 0x3d42
.set CB58, 0x3dc2
.set CA59, 0x3d40
.set CB59, 0x3dc0
.set CA60, 0x3d3e
.set CB60, 0x3dbe
.set CA61, 0x3d3c
.set CB61, 0x3dbc
.set CA62, 0x3d39
.set CB62, 0x3db9
.set CA63, 0x3d37
.set CB63, 0x3db7
.set CA64, 0x3d35
.set CB64, 0x3db5
.set CA65, 0x3d33
.set CB65, 0x3db3
.set CA66, 0x3d31
.set CB66, 0x3db1
.set CA67, 0x3d2e
.set CB67, 0x3dae
.set CA68, 0x3d2c
.set CB68, 0x3dac
.set CA69, 0x3d2a
.set CB69, 0x3daa
.set CA70, 0x3d27
.set CB70, 0x3da7
.set CA71, 0x3d25
.set CB71, 0x3da5
.set CA72, 0x3d22
.set CB72, 0x3da2
.set CA73, 0x3d20
.set CB73, 0x3da0
.set CA74, 0x3d1d
.set CB74, 0x3d9d
.set CA75, 0x3d1b
.set CB75, 0x3d9b
.set CA76, 0x3d18
.set CB76, 0x3d98
.set CA77, 0x3d16
.set CB77, 0x3d96
.set CA78, 0x3d13
.set CB78, 0x3d93
.set CA79, 0x3d11
.set CB79, 0x3d91
.set CA80, 0x3d0e
.set CB80, 0x3d8e
.set CA81, 0x3d0c
.set CB81, 0x3d8c
.set CA82, 0x3d09
.set CB82, 0x3d89
.set CA83, 0x3d06
.set CB83, 0x3d86
.set CA84, 0x3d04
.set CB84, 0x3d84
.set CA85, 0x3d01
.set CB85, 0x3d81
.set CA86, 0x3cfc
.set CB86, 0x3d7c
.set CA87, 0x3cf7
.set CB87, 0x3d77
.set CA88, 0x3cf1
.set CB88, 0x3d71
.set CA89, 0x3cec
.set CB89, 0x3d6c
.set CA90, 0x3ce6
.set CB90, 0x3d66
.set CA91, 0x3ce1
.set CB91, 0x3d61
.set CA92, 0x3cdb
.set CB92, 0x3d5b
.set CA93, 0x3cd5
.set CB93, 0x3d55
.set CA94, 0x3ccf
.set CB94, 0x3d4f
.set CA95, 0x3cca
.set CB95, 0x3d4a
.set CA96, 0x3cc4
.set CB96, 0x3d44
.set CA97, 0x3cbe
.set CB97, 0x3d3e
.set CA98, 0x3cb8
.set CB98, 0x3d38
.set CA99, 0x3cb2
.set CB99, 0x3d32
.set CA100, 0x3cac
.set CB100, 0x3d2c
.set CA101, 0x3ca7
.set CB101, 0x3d27
.set CA102, 0x3ca1
.set CB102, 0x3d21
.set CA103, 0x3c9b
.set CB103, 0x3d1b
.set CA104, 0x3c95
.set CB104, 0x3d15
.set CA105, 0x3c8f
.set CB105, 0x3d0f
.set CA106, 0x3c89
.set CB106, 0x3d09
.set CA107, 0x3c82
.set CB107, 0x3d02
.set CA108, 0x3c79
.set CB108, 0x3cf9
.set CA109, 0x3c6d
.set CB109, 0x3ced
.set CA110, 0x3c60
.set CB110, 0x3ce0
.set CA111, 0x3c54
.set CB111, 0x3cd4
.set CA112, 0x3c48
.set CB112, 0x3cc8
.set CA113, 0x3c3b
.set CB113, 0x3cbb
.set CA114, 0x3c2f
.set CB114, 0x3caf
.set CA115, 0x3c23
.set CB115, 0x3ca3
.set CA116, 0x3c16
.set CB116, 0x3c96
.set CA117, 0x3c0a
.set CB117, 0x3c8a
.set CA118, 0x3bfb
.set CB118, 0x3c7b
.set CA119, 0x3be2
.set CB119, 0x3c62
.set CA120, 0x3bc9
.set CB120, 0x3c49
.set CA121, 0x3bb0
.set CB121, 0x3c30
.set CA122, 0x3b97
.set CB122, 0x3c17
.set CA123, 0x3b7b
.set CB123, 0x3bfb
.set CA124, 0x3b49
.set CB124, 0x3bc9
.set CA125, 0x3b17
.set CB125, 0x3b97
.set CA126, 0x3ac9
.set CB126, 0x3b49
.set CA127, 0x3a49
.set CB127, 0x3ac9
.set CA128, 0x0000
.set CB128, 0x0000
.set CA129, 0xba49
.set CB129, 0xbac9
.set CA130, 0xbac9
.set CB130, 0xbb49
.set CA131, 0xbb17
.set CB131, 0xbb97
.set CA132, 0xbb49
.set CB132, 0xbbc9
.set CA133, 0xbb7b
.set CB133, 0xbbfb
.set CA134, 0xbb97
.set CB134, 0xbc17
.set CA135, 0xbbb0
.set CB135, 0xbc30
.set CA136, 0xbbc9
.set CB136, 0xbc49
.set CA137, 0xbbe2
.set CB137, 0xbc62
.set CA138, 0xbbfb
.set CB138, 0xbc7b
.set CA139, 0xbc0a
.set CB139, 0xbc8a
.set CA140, 0xbc16
.set CB140, 0xbc96
.set CA141, 0xbc23
.set CB141, 0xbca3
.set CA142, 0xbc2f
.set CB142, 0xbcaf
.set CA143, 0xbc3b
.set CB143, 0xbcbb
.set CA144, 0xbc48
.set CB144, 0xbcc8
.set CA145, 0xbc54
.set CB145, 0xbcd4
.set CA146, 0xbc60
.set CB146, 0xbce0
.set CA147, 0xbc6d
.set CB147, 0xbced
.set CA148, 0xbc79
.set CB148, 0xbcf9
.set CA149, 0xbc82
.set CB149, 0xbd02
.set CA150, 0xbc89
.set CB150, 0xbd09
.set CA151, 0xbc8f
.set CB151, 0xbd0f
.set CA152, 0xbc95
.set CB152, 0xbd15
.set CA153, 0xbc9b
.set CB153, 0xbd1b
.set CA154, 0xbca1
.set CB154, 0xbd21
.set CA155, 0xbca7
.set CB155, 0xbd27
.set CA156, 0xbcac
.set CB156, 0xbd2c
.set CA157, 0xbcb2
.set CB157, 0xbd32
.set CA158, 0xbcb8
.set CB158, 0xbd38
.set CA159, 0xbcbe
.set CB159, 0xbd3e
.set CA160, 0xbcc4
.set CB160, 0xbd44
.set CA161, 0xbcca
.set CB161, 0xbd4a
.set CA162, 0xbccf
.set CB162, 0xbd4f
.set CA163, 0xbcd5
.set CB163, 0xbd55
.set CA164, 0xbcdb
.set CB164, 0xbd5b
.set CA165, 0xbce1
.set CB165, 0xbd61
.set CA166, 0xbce6
.set CB166, 0xbd66
.set CA167, 0xbcec
.set CB167, 0xbd6c
.set CA168, 0xbcf1
.set CB168, 0xbd71
.set CA169, 0xbcf7
.set CB169, 0xbd77
.set CA170, 0xbcfc
.set CB170, 0xbd7c
.set CA171, 0xbd01
.set CB171, 0xbd81
.set CA172, 0xbd04
.set CB172, 0xbd84
.set CA173, 0xbd06
.set CB173, 0xbd86
.set CA174, 0xbd09
.set CB174, 0xbd89
.set CA175, 0xbd0c
.set CB175, 0xbd8c
.set CA176, 0xbd0e
.set CB176, 0xbd8e
.set CA177, 0xbd11
.set CB177, 0xbd91
.set CA178, 0xbd13
.set CB178, 0xbd93
.set CA179, 0xbd16
.set CB179, 0xbd96
.set CA180, 0xbd18
.set CB180, 0xbd98
.set CA181, 0xbd1b
.set CB181, 0xbd9b
.set CA182, 0xbd1d
.set CB182, 0xbd9d
.set CA183, 0xbd20
.set CB183, 0xbda0
.set CA184, 0xbd22
.set CB184, 0xbda2
.set CA185, 0xbd25
.set CB185, 0xbda5
.set CA186, 0xbd27
.set CB186, 0xbda7
.set CA187, 0xbd2a
.set CB187, 0xbdaa
.set CA188, 0xbd2c
.set CB188, 0xbdac
.set CA189, 0xbd2e
.set CB189, 0xbdae
.set CA190, 0xbd31
.set CB190, 0xbdb1
.set CA191, 0xbd33
.set CB191, 0xbdb3
.set CA192, 0xbd35
.set CB192, 0xbdb5
.set CA193, 0xbd37
.set CB193, 0xbdb7
.set CA194, 0xbd39
.set CB194, 0xbdb9
.set CA195, 0xbd3c
.set CB195, 0xbdbc
.set CA196, 0xbd3e
.set CB196, 0xbdbe
.set CA197, 0xbd40
.set CB197, 0xbdc0
.set CA198, 0xbd42
.set CB198, 0xbdc2
.set CA199, 0xbd44
.set CB199, 0xbdc4
.set CA200, 0xbd46
.set CB200, 0xbdc6
.set CA201, 0xbd48
.set CB201, 0xbdc8
.set CA202, 0xbd4a
.set CB202, 0xbdca
.set CA203, 0xbd4c
.set CB203, 0xbdcc
.set CA204, 0xbd4e
.set CB204, 0xbdce
.set CA205, 0xbd4f
.set CB205, 0xbdcf
.set CA206, 0xbd51
.set CB206, 0xbdd1
.set CA207, 0xbd53
.set CB207, 0xbdd3
.set CA208, 0xbd55
.set CB208, 0xbdd5
.set CA209, 0xbd57
.set CB209, 0xbdd7
.set CA210, 0xbd58
.set CB210, 0xbdd8
.set CA211, 0xbd5a
.set CB211, 0xbdda
.set CA212, 0xbd5c
.set CB212, 0xbddc
.set CA213, 0xbd5d
.set CB213, 0xbddd
.set CA214, 0xbd5f
.set CB214, 0xbddf
.set CA215, 0xbd60
.set CB215, 0xbde0
.set CA216, 0xbd62
.set CB216, 0xbde2
.set CA217, 0xbd63
.set CB217, 0xbde3
.set CA218, 0xbd65
.set CB218, 0xbde5
.set CA219, 0xbd66
.set CB219, 0xbde6
.set CA220, 0xbd67
.set CB220, 0xbde7
.set CA221, 0xbd69
.set CB221, 0xbde9
.set CA222, 0xbd6a
.set CB222, 0xbdea
.set CA223, 0xbd6b
.set CB223, 0xbdeb
.set CA224, 0xbd6d
.set CB224, 0xbded
.set CA225, 0xbd6e
.set CB225, 0xbdee
.set CA226, 0xbd6f
.set CB226, 0xbdef
.set CA227, 0xbd70
.set CB227, 0xbdf0
.set CA228, 0xbd71
.set CB228, 0xbdf1
.set CA229, 0xbd72
.set CB229, 0xbdf2
.set CA230, 0xbd73
.set CB230, 0xbdf3
.set CA231, 0xbd74
.set CB231, 0xbdf4
.set CA232, 0xbd75
.set CB232, 0xbdf5
.set CA233, 0xbd76
.set CB233, 0xbdf6
.set CA234, 0xbd77
.set CB234, 0xbdf7
.set CA235, 0xbd78
.set CB235, 0xbdf8
.set CA236, 0xbd78
.set CB236, 0xbdf8
.set CA237, 0xbd79
.set CB237, 0xbdf9
.set CA238, 0xbd7a
.set CB238, 0xbdfa
.set CA239, 0xbd7a
.set CB239, 0xbdfa
.set CA240, 0xbd7b
.set CB240, 0xbdfb
.set CA241, 0xbd7c
.set CB241, 0xbdfc
.set CA242, 0xbd7c
.set CB242, 0xbdfc
.set CA243, 0xbd7d
.set CB243, 0xbdfd
.set CA244, 0xbd7d
.set CB244, 0xbdfd
.set CA245, 0xbd7e
.set CB245, 0xbdfe
.set CA246, 0xbd7e
.set CB246, 0xbdfe
.set CA247, 0xbd7e
.set CB247, 0xbdfe
.set CA248, 0xbd7f
.set CB248, 0xbdff
.set CA249, 0xbd7f
.set CB249, 0xbdff
.set CA250, 0xbd7f
.set CB250, 0xbdff
.set CA251, 0xbd80
.set CB251, 0xbe00
.set CA252, 0xbd80
.set CB252, 0xbe00
.set CA253, 0xbd80
.set CB253, 0xbe00
.set CA254, 0xbd80
.set CB254, 0xbe00
.set CA255, 0xbd80
.set CB255, 0xbe00
.set CA256, 0xbd80
.set CB256, 0xbe00
.set CA257, 0xbd80
.set CB257, 0xbe00
.set CA258, 0xbd80
.set CB258, 0xbe00
.set CA259, 0xbd80
.set CB259, 0xbe00
.set CA260, 0xbd80
.set CB260, 0xbe00
.set CA261, 0xbd80
.set CB261, 0xbe00
.set CA262, 0xbd7f
.set CB262, 0xbdff
.set CA263, 0xbd7f
.set CB263, 0xbdff
.set CA264, 0xbd7f
.set CB264, 0xbdff
.set CA265, 0xbd7e
.set CB265, 0xbdfe
.set CA266, 0xbd7e
.set CB266, 0xbdfe
.set CA267, 0xbd7e
.set CB267, 0xbdfe
.set CA268, 0xbd7d
.set CB268, 0xbdfd
.set CA269, 0xbd7d
.set CB269, 0xbdfd
.set CA270, 0xbd7c
.set CB270, 0xbdfc
.set CA271, 0xbd7c
.set CB271, 0xbdfc
.set CA272, 0xbd7b
.set CB272, 0xbdfb
.set CA273, 0xbd7a
.set CB273, 0xbdfa
.set CA274, 0xbd7a
.set CB274, 0xbdfa
.set CA275, 0xbd79
.set CB275, 0xbdf9
.set CA276, 0xbd78
.set CB276, 0xbdf8
.set CA277, 0xbd78
.set CB277, 0xbdf8
.set CA278, 0xbd77
.set CB278, 0xbdf7
.set CA279, 0xbd76
.set CB279, 0xbdf6
.set CA280, 0xbd75
.set CB280, 0xbdf5
.set CA281, 0xbd74
.set CB281, 0xbdf4
.set CA282, 0xbd73
.set CB282, 0xbdf3
.set CA283, 0xbd72
.set CB283, 0xbdf2
.set CA284, 0xbd71
.set CB284, 0xbdf1
.set CA285, 0xbd70
.set CB285, 0xbdf0
.set CA286, 0xbd6f
.set CB286, 0xbdef
.set CA287, 0xbd6e
.set CB287, 0xbdee
.set CA288, 0xbd6d
.set CB288, 0xbded
.set CA289, 0xbd6b
.set CB289, 0xbdeb
.set CA290, 0xbd6a
.set CB290, 0xbdea
.set CA291, 0xbd69
.set CB291, 0xbde9
.set CA292, 0xbd67
.set CB292, 0xbde7
.set CA293, 0xbd66
.set CB293, 0xbde6
.set CA294, 0xbd65
.set CB294, 0xbde5
.set CA295, 0xbd63
.set CB295, 0xbde3
.set CA296, 0xbd62
.set CB296, 0xbde2
.set CA297, 0xbd60
.set CB297, 0xbde0
.set CA298, 0xbd5f
.set CB298, 0xbddf
.set CA299, 0xbd5d
.set CB299, 0xbddd
.set CA300, 0xbd5c
.set CB300, 0xbddc
.set CA301, 0xbd5a
.set CB301, 0xbdda
.set CA302, 0xbd58
.set CB302, 0xbdd8
.set CA303, 0xbd57
.set CB303, 0xbdd7
.set CA304, 0xbd55
.set CB304, 0xbdd5
.set CA305, 0xbd53
.set CB305, 0xbdd3
.set CA306, 0xbd51
.set CB306, 0xbdd1
.set CA307, 0xbd4f
.set CB307, 0xbdcf
.set CA308, 0xbd4e
.set CB308, 0xbdce
.set CA309, 0xbd4c
.set CB309, 0xbdcc
.set CA310, 0xbd4a
.set CB310, 0xbdca
.set CA311, 0xbd48
.set CB311, 0xbdc8
.set CA312, 0xbd46
.set CB312, 0xbdc6
.set CA313, 0xbd44
.set CB313, 0xbdc4
.set CA314, 0xbd42
.set CB314, 0xbdc2
.set CA315, 0xbd40
.set CB315, 0xbdc0
.set CA316, 0xbd3e
.set CB316, 0xbdbe
.set CA317, 0xbd3c
.set CB317, 0xbdbc
.set CA318, 0xbd39
.set CB318, 0xbdb9
.set CA319, 0xbd37
.set CB319, 0xbdb7
.set CA320, 0xbd35
.set CB320, 0xbdb5
.set CA321, 0xbd33
.set CB321, 0xbdb3
.set CA322, 0xbd31
.set CB322, 0xbdb1
.set CA323, 0xbd2e
.set CB323, 0xbdae
.set CA324, 0xbd2c
.set CB324, 0xbdac
.set CA325, 0xbd2a
.set CB325, 0xbdaa
.set CA326, 0xbd27
.set CB326, 0xbda7
.set CA327, 0xbd25
.set CB327, 0xbda5
.set CA328, 0xbd22
.set CB328, 0xbda2
.set CA329, 0xbd20
.set CB329, 0xbda0
.set CA330, 0xbd1d
.set CB330, 0xbd9d
.set CA331, 0xbd1b
.set CB331, 0xbd9b
.set CA332, 0xbd18
.set CB332, 0xbd98
.set CA333, 0xbd16
.set CB333, 0xbd96
.set CA334, 0xbd13
.set CB334, 0xbd93
.set CA335, 0xbd11
.set CB335, 0xbd91
.set CA336, 0xbd0e
.set CB336, 0xbd8e
.set CA337, 0xbd0c
.set CB337, 0xbd8c
.set CA338, 0xbd09
.set CB338, 0xbd89
.set CA339, 0xbd06
.set CB339, 0xbd86
.set CA340, 0xbd04
.set CB340, 0xbd84
.set CA341, 0xbd01
.set CB341, 0xbd81
.set CA342, 0xbcfc
.set CB342, 0xbd7c
.set CA343, 0xbcf7
.set CB343, 0xbd77
.set CA344, 0xbcf1
.set CB344, 0xbd71
.set CA345, 0xbcec
.set CB345, 0xbd6c
.set CA346, 0xbce6
.set CB346, 0xbd66
.set CA347, 0xbce1
.set CB347, 0xbd61
.set CA348, 0xbcdb
.set CB348, 0xbd5b
.set CA349, 0xbcd5
.set CB349, 0xbd55
.set CA350, 0xbccf
.set CB350, 0xbd4f
.set CA351, 0xbcca
.set CB351, 0xbd4a
.set CA352, 0xbcc4
.set CB352, 0xbd44
.set CA353, 0xbcbe
.set CB353, 0xbd3e
.set CA354, 0xbcb8
.set CB354, 0xbd38
.set CA355, 0xbcb2
.set CB355, 0xbd32
.set CA356, 0xbcac
.set CB356, 0xbd2c
.set CA357, 0xbca7
.set CB357, 0xbd27
.set CA358, 0xbca1
.set CB358, 0xbd21
.set CA359, 0xbc9b
.set CB359, 0xbd1b
.set CA360, 0xbc95
.set CB360, 0xbd15
.set CA361, 0xbc8f
.set CB361, 0xbd0f
.set CA362, 0xbc89
.set CB362, 0xbd09
.set CA363, 0xbc82
.set CB363, 0xbd02
.set CA364, 0xbc79
.set CB364, 0xbcf9
.set CA365, 0xbc6d
.set CB365, 0xbced
.set CA366, 0xbc60
.set CB366, 0xbce0
.set CA367, 0xbc54
.set CB367, 0xbcd4
.set CA368, 0xbc48
.set CB368, 0xbcc8
.set CA369, 0xbc3b
.set CB369, 0xbcbb
.set CA370, 0xbc2f
.set CB370, 0xbcaf
.set CA371, 0xbc23
.set CB371, 0xbca3
.set CA372, 0xbc16
.set CB372, 0xbc96
.set CA373, 0xbc0a
.set CB373, 0xbc8a
.set CA374, 0xbbfb
.set CB374, 0xbc7b
.set CA375, 0xbbe2
.set CB375, 0xbc62
.set CA376, 0xbbc9
.set CB376, 0xbc49
.set CA377, 0xbbb0
.set CB377, 0xbc30
.set CA378, 0xbb97
.set CB378, 0xbc17
.set CA379, 0xbb7b
.set CB379, 0xbbfb
.set CA380, 0xbb49
.set CB380, 0xbbc9
.set CA381, 0xbb17
.set CB381, 0xbb97
.set CA382, 0xbac9
.set CB382, 0xbb49
.set CA383, 0xba49
.set CB383, 0xbac9
.set CA384, 0x0000
.set CB384, 0x0000
.set CA385, 0x3a49
.set CB385, 0x3ac9
.set CA386, 0x3ac9
.set CB386, 0x3b49
.set CA387, 0x3b17
.set CB387, 0x3b97
.set CA388, 0x3b49
.set CB388, 0x3bc9
.set CA389, 0x3b7b
.set CB389, 0x3bfb
.set CA390, 0x3b97
.set CB390, 0x3c17
.set CA391, 0x3bb0
.set CB391, 0x3c30
.set CA392, 0x3bc9
.set CB392, 0x3c49
.set CA393, 0x3be2
.set CB393, 0x3c62
.set CA394, 0x3bfb
.set CB394, 0x3c7b
.set CA395, 0x3c0a
.set CB395, 0x3c8a
.set CA396, 0x3c16
.set CB396, 0x3c96
.set CA397, 0x3c23
.set CB397, 0x3ca3
.set CA398, 0x3c2f
.set CB398, 0x3caf
.set CA399, 0x3c3b
.set CB399, 0x3cbb
.set CA400, 0x3c48
.set CB400, 0x3cc8
.set CA401, 0x3c54
.set CB401, 0x3cd4
.set CA402, 0x3c60
.set CB402, 0x3ce0
.set CA403, 0x3c6d
.set CB403, 0x3ced
.set CA404, 0x3c79
.set CB404, 0x3cf9
.set CA405, 0x3c82
.set CB405, 0x3d02
.set CA406, 0x3c89
.set CB406, 0x3d09
.set CA407, 0x3c8f
.set CB407, 0x3d0f
.set CA408, 0x3c95
.set CB408, 0x3d15
.set CA409, 0x3c9b
.set CB409, 0x3d1b
.set CA410, 0x3ca1
.set CB410, 0x3d21
.set CA411, 0x3ca7
.set CB411, 0x3d27
.set CA412, 0x3cac
.set CB412, 0x3d2c
.set CA413, 0x3cb2
.set CB413, 0x3d32
.set CA414, 0x3cb8
.set CB414, 0x3d38
.set CA415, 0x3cbe
.set CB415, 0x3d3e
.set CA416, 0x3cc4
.set CB416, 0x3d44
.set CA417, 0x3cca
.set CB417, 0x3d4a
.set CA418, 0x3ccf
.set CB418, 0x3d4f
.set CA419, 0x3cd5
.set CB419, 0x3d55
.set CA420, 0x3cdb
.set CB420, 0x3d5b
.set CA421, 0x3ce1
.set CB421, 0x3d61
.set CA422, 0x3ce6
.set CB422, 0x3d66
.set CA423, 0x3cec
.set CB423, 0x3d6c
.set CA424, 0x3cf1
.set CB424, 0x3d71
.set CA425, 0x3cf7
.set CB425, 0x3d77
.set CA426, 0x3cfc
.set CB426, 0x3d7c
.set CA427, 0x3d01
.set CB427, 0x3d81
.set CA428, 0x3d04
.set CB428, 0x3d84
.set CA429, 0x3d06
.set CB429, 0x3d86
.set CA430, 0x3d09
.set CB430, 0x3d89
.set CA431, 0x3d0c
.set CB431, 0x3d8c
.set CA432, 0x3d0e
.set CB432, 0x3d8e
.set CA433, 0x3d11
.set CB433, 0x3d91
.set CA434, 0x3d13
.set CB434, 0x3d93
.set CA435, 0x3d16
.set CB435, 0x3d96
.set CA436, 0x3d18
.set CB436, 0x3d98
.set CA437, 0x3d1b
.set CB437, 0x3d9b
.set CA438, 0x3d1d
.set CB438, 0x3d9d
.set CA439, 0x3d20
.set CB439, 0x3da0
.set CA440, 0x3d22
.set CB440, 0x3da2
.set CA441, 0x3d25
.set CB441, 0x3da5
.set CA442, 0x3d27
.set CB442, 0x3da7
.set CA443, 0x3d2a
.set CB443, 0x3daa
.set CA444, 0x3d2c
.set CB444, 0x3dac
.set CA445, 0x3d2e
.set CB445, 0x3dae
.set CA446, 0x3d31
.set CB446, 0x3db1
.set CA447, 0x3d33
.set CB447, 0x3db3
.set CA448, 0x3d35
.set CB448, 0x3db5
.set CA449, 0x3d37
.set CB449, 0x3db7
.set CA450, 0x3d39
.set CB450, 0x3db9
.set CA451, 0x3d3c
.set CB451, 0x3dbc
.set CA452, 0x3d3e
.set CB452, 0x3dbe
.set CA453, 0x3d40
.set CB453, 0x3dc0
.set CA454, 0x3d42
.set CB454, 0x3dc2
.set CA455, 0x3d44
.set CB455, 0x3dc4
.set CA456, 0x3d46
.set CB456, 0x3dc6
.set CA457, 0x3d48
.set CB457, 0x3dc8
.set CA458, 0x3d4a
.set CB458, 0x3dca
.set CA459, 0x3d4c
.set CB459, 0x3dcc
.set CA460, 0x3d4e
.set CB460, 0x3dce
.set CA461, 0x3d4f
.set CB461, 0x3dcf
.set CA462, 0x3d51
.set CB462, 0x3dd1
.set CA463, 0x3d53
.set CB463, 0x3dd3
.set CA464, 0x3d55
.set CB464, 0x3dd5
.set CA465, 0x3d57
.set CB465, 0x3dd7
.set CA466, 0x3d58
.set CB466, 0x3dd8
.set CA467, 0x3d5a
.set CB467, 0x3dda
.set CA468, 0x3d5c
.set CB468, 0x3ddc
.set CA469, 0x3d5d
.set CB469, 0x3ddd
.set CA470, 0x3d5f
.set CB470, 0x3ddf
.set CA471, 0x3d60
.set CB471, 0x3de0
.set CA472, 0x3d62
.set CB472, 0x3de2
.set CA473, 0x3d63
.set CB473, 0x3de3
.set CA474, 0x3d65
.set CB474, 0x3de5
.set CA475, 0x3d66
.set CB475, 0x3de6
.set CA476, 0x3d67
.set CB476, 0x3de7
.set CA477, 0x3d69
.set CB477, 0x3de9
.set CA478, 0x3d6a
.set CB478, 0x3dea
.set CA479, 0x3d6b
.set CB479, 0x3deb
.set CA480, 0x3d6d
.set CB480, 0x3ded
.set CA481, 0x3d6e
.set CB481, 0x3dee
.set CA482, 0x3d6f
.set CB482, 0x3def
.set CA483, 0x3d70
.set CB483, 0x3df0
.set CA484, 0x3d71
.set CB484, 0x3df1
.set CA485, 0x3d72
.set CB485, 0x3df2
.set CA486, 0x3d73
.set CB486, 0x3df3
.set CA487, 0x3d74
.set CB487, 0x3df4
.set CA488, 0x3d75
.set CB488, 0x3df5
.set CA489, 0x3d76
.set CB489, 0x3df6
.set CA490, 0x3d77
.set CB490, 0x3df7
.set CA491, 0x3d78
.set CB491, 0x3df8
.set CA492, 0x3d78
.set CB492, 0x3df8
.set CA493, 0x3d79
.set CB493, 0x3df9
.set CA494, 0x3d7a
.set CB494, 0x3dfa
.set CA495, 0x3d7a
.set CB495, 0x3dfa
.set CA496, 0x3d7b
.set CB496, 0x3dfb
.set CA497, 0x3d7c
.set CB497, 0x3dfc
.set CA498, 0x3d7c
.set CB498, 0x3dfc
.set CA499, 0x3d7d
.set CB499, 0x3dfd
.set CA500, 0x3d7d
.set CB500, 0x3dfd
.set CA501, 0x3d7e
.set CB501, 0x3dfe
.set CA502, 0x3d7e
.set CB502, 0x3dfe
.set CA503, 0x3d7e
.set CB503, 0x3dfe
.set CA504, 0x3d7f
.set CB504, 0x3dff
.set CA505, 0x3d7f
.set CB505, 0x3dff
.set CA506, 0x3d7f
.set CB506, 0x3dff
.set CA507, 0x3d80
.set CB507, 0x3e00
.set CA508, 0x3d80
.set CB508, 0x3e00
.set CA509, 0x3d80
.set CB509, 0x3e00
.set CA510, 0x3d80
.set CB510, 0x3e00
.set CA511, 0x3d80
.set CB511, 0x3e00
.altmacro
.macro f8 a,b,c,d,e,f,g,h
.short CA\a, CA\b, CA\c, CA\d, CA\e, CA\f, CA\g, CA\h
.endm
.macro g8 a,b,c,d,e,f,g,h
.short CB\a, CB\b, CB\c, CB\d, CB\e, CB\f, CB\g, CB\h
.endm
.macro g8s a,b,c,d,e,f,g,h
.short CA\a, CA\b, CB\c, CB\d, CB\e, CB\f, CB\g, CB\h
.endm
.macro flane k, o, d
f8 %((\d*\k+\o)&511), %(((\d+1)*\k+\o)&511), %(((\d+2)*\k+\o)&511), %(((\d+3)*\k+\o)&511), %(((\d+4)*\k+\o)&511), %(((\d+5)*\k+\o)&511), %(((\d+6)*\k+\o)&511), %(((\d+7)*\k+\o)&511)
.endm
.macro fhalf n0, d
.set nn, \n0
.rept 32
flane %((nn>>1)-256*(nn==1)), %(128*(nn&1)*(1+(nn==1))), \d
.set nn, nn+1
.endr
.endm
.macro ftile n0
.set dd, 0
.rept 64
fhalf \n0, %dd
.set dd, dd+8
.endr
.endm
.section .rodata,"a"
.p2align 8
tab_F:
.set tt, 0
.rept 16
ftile %(32*tt)
.set tt, tt+1
.endr

.macro glane d, k
g8 %((\d*\k)&511), %((\d*\k+128)&511), %((\d*(\k+1))&511), %((\d*(\k+1)+128)&511), %((\d*(\k+4))&511), %((\d*(\k+4)+128)&511), %((\d*(\k+5))&511), %((\d*(\k+5)+128)&511)
.endm
.macro glane0 d
g8s 0, %((\d*256)&511), %((\d*1)&511), %((\d+128)&511), %((\d*4)&511), %((\d*4+128)&511), %((\d*5)&511), %((\d*5+128)&511)
.endm
.macro ghalf d0, k
.set ll, 0
.rept 32
glane %(\d0+ll), \k
.set ll, ll+1
.endr
.endm
.macro ghalf0 d0
.set ll, 0
.rept 32
glane0 %(\d0+ll)
.set ll, ll+1
.endr
.endm
.macro gtile d0
ghalf0 \d0
ghalf \d0, 2
.set gg, 1
.rept 31
ghalf \d0, %(8*gg)
ghalf \d0, %(8*gg+2)
.set gg, gg+1
.endr
.endm
.p2align 8
tab_G:
.set tt, 0
.rept 16
gtile %(32*tt)
.set tt, tt+1
.endr
.noaltmacro
.p2align 8
tab_S:

.quad 0x3000300030003000,0x3000300030003000,0x2ea72f642fd93000,0x263e2a1f2c722da8,0x2a1f2da82f643000,0xaf64ada8aa1f0000,0xa63e2a1f2ea73000,0xac72af64afd9ada8
.quad 0xada800002da83000,0x2da88000ada8b000,0xafd9aa1f2c723000,0x2ea72f64263eada8,0xaf64ada82a1f3000,0xaa1f2da82f648000,0xac72af64263e3000,0xafd9aa1f2ea72da8
.quad 0x8000b00000003000,0x8000b00000003000,0x2c72af64a63e3000,0x2fd9aa1faea72da8,0x2f64ada8aa1f3000,0x2a1f2da8af640000,0x2fd9aa1fac723000,0xaea72f64a63eada8
.quad 0x2da88000ada83000,0xada800002da8b000,0x263e2a1faea73000,0x2c72af642fd9ada8,0xaa1f2da8af643000,0x2f64ada82a1f8000,0xaea72f64afd93000,0xa63e2a1fac722da8
.quad 0x3000300030003000,0x3000300030003000,0xac72aa1fa63e0000,0xafd9af64aea7ada8,0xaa1fada8af64b000,0x2f642da82a1f8000,0x2fd92f642c728000,0xaea7aa1f263e2da8
.quad 0xada800002da83000,0x2da88000ada8b000,0xa63eaf64aea70000,0xac722a1f2fd92da8,0x2f642da8aa1fb000,0x2a1fada8af640000,0xaea72a1f2fd98000,0xa63e2f642c72ada8
.quad 0x8000b00000003000,0x8000b00000003000,0x2ea72a1fafd90000,0x263e2f64ac72ada8,0xaf642da82a1fb000,0xaa1fada82f648000,0x263eaf642ea78000,0x2c722a1fafd92da8
.quad 0x2da88000ada83000,0xada800002da8b000,0xafd92f64ac720000,0x2ea7aa1fa63e2da8,0x2a1fada82f64b000,0xaf642da8aa1f0000,0x2c72aa1f263e8000,0x2fd9af642ea7ada8
.quad 0x3000300030003000,0x3000300030003000,0xaea7af64afd9b000,0xa63eaa1fac72ada8,0x2a1f2da82f643000,0xaf64ada8aa1f0000,0x263eaa1faea7b000,0x2c722f642fd92da8
.quad 0xada800002da83000,0x2da88000ada8b000,0x2fd92a1fac72b000,0xaea7af64a63e2da8,0xaf64ada82a1f3000,0xaa1f2da82f648000,0x2c722f64a63eb000,0x2fd92a1faea7ada8
.quad 0x8000b00000003000,0x8000b00000003000,0xac722f64263eb000,0xafd92a1f2ea7ada8,0x2f64ada8aa1f3000,0x2a1f2da8af640000,0xafd92a1f2c72b000,0x2ea7af64263e2da8
.quad 0x2da88000ada83000,0xada800002da8b000,0xa63eaa1f2ea7b000,0xac722f64afd92da8,0xaa1f2da8af643000,0x2f64ada82a1f8000,0x2ea7af642fd9b000,0x263eaa1f2c72ada8
.quad 0x3000300030003000,0x3000300030003000,0x2c722a1f263e8000,0x2fd92f642ea72da8,0xaa1fada8af64b000,0x2f642da82a1f8000,0xafd9af64ac720000,0x2ea72a1fa63eada8
.quad 0xada800002da83000,0x2da88000ada8b000,0x263e2f642ea78000,0x2c72aa1fafd9ada8,0x2f642da8aa1fb000,0x2a1fada8af640000,0x2ea7aa1fafd90000,0x263eaf64ac722da8
.quad 0x8000b00000003000,0x8000b00000003000,0xaea7aa1f2fd98000,0xa63eaf642c722da8,0xaf642da82a1fb000,0xaa1fada82f648000,0xa63e2f64aea70000,0xac72aa1f2fd9ada8
.quad 0x2da88000ada83000,0xada800002da8b000,0x2fd9af642c728000,0xaea72a1f263eada8,0x2a1fada82f64b000,0xaf642da8aa1f0000,0xac722a1fa63e0000,0xafd92f64aea72da8
.quad 0xb0003000b0003000,0xb0003000b0003000,0xaea72f64afd93000,0xa63e2a1fac722da8,0xaa1f2da8af643000,0x2f64ada82a1f0000,0x263e2a1faea73000,0x2c72af642fd9ada8
.quad 0x2da80000ada83000,0xada880002da8b000,0x2fd9aa1fac723000,0xaea72f64a63eada8,0x2f64ada8aa1f3000,0x2a1f2da8af648000,0x2c72af64a63e3000,0x2fd9aa1faea72da8
.quad 0xb00080003000,0xb00080003000,0xac72af64263e3000,0xafd9aa1f2ea72da8,0xaf64ada82a1f3000,0xaa1f2da82f640000,0xafd9aa1f2c723000,0x2ea72f64263eada8
.quad 0xada880002da83000,0x2da80000ada8b000,0xa63e2a1f2ea73000,0xac72af64afd9ada8,0x2a1f2da82f643000,0xaf64ada8aa1f8000,0x2ea72f642fd93000,0x263e2a1f2c722da8
.quad 0xb0003000b0003000,0xb0003000b0003000,0x2c72aa1f263e0000,0x2fd9af642ea7ada8,0x2a1fada82f64b000,0xaf642da8aa1f8000,0xafd92f64ac728000,0x2ea7aa1fa63e2da8
.quad 0x2da80000ada83000,0xada880002da8b000,0x263eaf642ea70000,0x2c722a1fafd92da8,0xaf642da82a1fb000,0xaa1fada82f640000,0x2ea72a1fafd98000,0x263e2f64ac72ada8
.quad 0xb00080003000,0xb00080003000,0xaea72a1f2fd90000,0xa63e2f642c72ada8,0x2f642da8aa1fb000,0x2a1fada8af648000,0xa63eaf64aea78000,0xac722a1f2fd92da8
.quad 0xada880002da83000,0x2da80000ada8b000,0x2fd92f642c720000,0xaea7aa1f263e2da8,0xaa1fada8af64b000,0x2f642da82a1f0000,0xac72aa1fa63e8000,0xafd9af64aea7ada8
.quad 0xb0003000b0003000,0xb0003000b0003000,0x2ea7af642fd9b000,0x263eaa1f2c72ada8,0xaa1f2da8af643000,0x2f64ada82a1f0000,0xa63eaa1f2ea7b000,0xac722f64afd92da8
.quad 0x2da80000ada83000,0xada880002da8b000,0xafd92a1f2c72b000,0x2ea7af64263e2da8,0x2f64ada8aa1f3000,0x2a1f2da8af648000,0xac722f64263eb000,0xafd92a1f2ea7ada8
.quad 0xb00080003000,0xb00080003000,0x2c722f64a63eb000,0x2fd92a1faea7ada8,0xaf64ada82a1f3000,0xaa1f2da82f640000,0x2fd92a1fac72b000,0xaea7af64a63e2da8
.quad 0xada880002da83000,0x2da80000ada8b000,0x263eaa1faea7b000,0x2c722f642fd92da8,0x2a1f2da82f643000,0xaf64ada8aa1f8000,0xaea7af64afd9b000,0xa63eaa1fac72ada8
.quad 0xb0003000b0003000,0xb0003000b0003000,0xac722a1fa63e8000,0xafd92f64aea72da8,0x2a1fada82f64b000,0xaf642da8aa1f8000,0x2fd9af642c720000,0xaea72a1f263eada8
.quad 0x2da80000ada83000,0xada880002da8b000,0xa63e2f64aea78000,0xac72aa1f2fd9ada8,0xaf642da82a1fb000,0xaa1fada82f640000,0xaea7aa1f2fd90000,0xa63eaf642c722da8
.quad 0xb00080003000,0xb00080003000,0x2ea7aa1fafd98000,0x263eaf64ac722da8,0x2f642da8aa1fb000,0x2a1fada8af648000,0x263e2f642ea70000,0x2c72aa1fafd9ada8
.quad 0xada880002da83000,0x2da80000ada8b000,0xafd9af64ac728000,0x2ea72a1fa63eada8,0xaa1fada8af64b000,0x2f642da82a1f0000,0x2c722a1f263e0000,0x2fd92f642ea72da8
.quad 0x8000800080008000,0x8000800080008000,0xac72aa1fa63e8000,0xafd9af64aea7ada8,0xaf64ada8aa1f8000,0xaa1fada8af64b000,0xafd9af64ac728000,0x2ea72a1fa63eada8
.quad 0xada8b000ada88000,0x2da830002da88000,0xa63eaf64aea78000,0xac722a1f2fd92da8,0x2a1fada8af648000,0xaf64ada82a1f3000,0x2ea7aa1fafd98000,0x263eaf64ac722da8
.quad 0x30008000b0008000,0x30008000b0008000,0x2ea72a1fafd98000,0x263e2f64ac72ada8,0x2a1f2da8af648000,0xaf642da82a1fb000,0xa63e2f64aea78000,0xac72aa1f2fd9ada8
.quad 0xada83000ada88000,0x2da8b0002da88000,0xafd92f64ac728000,0x2ea7aa1fa63e2da8,0xaf642da8aa1f8000,0xaa1f2da8af643000,0xac722a1fa63e8000,0xafd92f64aea72da8
.quad 0x8000800080008000,0x8000800080008000,0xaea7af64afd9b000,0xa63eaa1fac72ada8,0x2f642da82a1f8000,0x2a1f2da82f643000,0xa63e2a1f2ea73000,0xac72af64afd9ada8
.quad 0xada8b000ada88000,0x2da830002da88000,0x2fd92a1fac72b000,0xaea7af64a63e2da8,0xaa1f2da82f648000,0x2f642da8aa1fb000,0xac72af64263e3000,0xafd9aa1f2ea72da8
.quad 0x30008000b0008000,0x30008000b0008000,0xac722f64263eb000,0xafd92a1f2ea7ada8,0xaa1fada82f648000,0x2f64ada8aa1f3000,0x2fd9aa1fac723000,0xaea72f64a63eada8
.quad 0xada83000ada88000,0x2da8b0002da88000,0xa63eaa1f2ea7b000,0xac722f64afd92da8,0x2f64ada82a1f8000,0x2a1fada82f64b000,0xaea72f64afd93000,0xa63e2a1fac722da8
.quad 0x8000800080008000,0x8000800080008000,0x2c722a1f263e8000,0x2fd92f642ea72da8,0xaf64ada8aa1f8000,0xaa1fada8af64b000,0x2fd92f642c728000,0xaea7aa1f263e2da8
.quad 0xada8b000ada88000,0x2da830002da88000,0x263e2f642ea78000,0x2c72aa1fafd9ada8,0x2a1fada8af648000,0xaf64ada82a1f3000,0xaea72a1f2fd98000,0xa63e2f642c72ada8
.quad 0x30008000b0008000,0x30008000b0008000,0xaea7aa1f2fd98000,0xa63eaf642c722da8,0x2a1f2da8af648000,0xaf642da82a1fb000,0x263eaf642ea78000,0x2c722a1fafd92da8
.quad 0xada83000ada88000,0x2da8b0002da88000,0x2fd9af642c728000,0xaea72a1f263eada8,0xaf642da8aa1f8000,0xaa1f2da8af643000,0x2c72aa1f263e8000,0x2fd9af642ea7ada8
.quad 0x8000800080008000,0x8000800080008000,0x2ea72f642fd93000,0x263e2a1f2c722da8,0x2f642da82a1f8000,0x2a1f2da82f643000,0x263eaa1faea7b000,0x2c722f642fd92da8
.quad 0xada8b000ada88000,0x2da830002da88000,0xafd9aa1f2c723000,0x2ea72f64263eada8,0xaa1f2da82f648000,0x2f642da8aa1fb000,0x2c722f64a63eb000,0x2fd92a1faea7ada8
.quad 0x30008000b0008000,0x30008000b0008000,0x2c72af64a63e3000,0x2fd9aa1faea72da8,0xaa1fada82f648000,0x2f64ada8aa1f3000,0xafd92a1f2c72b000,0x2ea7af64263e2da8
.quad 0xada83000ada88000,0x2da8b0002da88000,0x263e2a1faea73000,0x2c72af642fd9ada8,0x2f64ada82a1f8000,0x2a1fada82f64b000,0x2ea7af642fd9b000,0x263eaa1f2c72ada8
.quad 0x8000800080008000,0x8000800080008000,0x2c72aa1f263e8000,0x2fd9af642ea7ada8,0x2f64ada82a1f8000,0x2a1fada82f64b000,0x2fd9af642c728000,0xaea72a1f263eada8
.quad 0x2da8b0002da88000,0xada83000ada88000,0x263eaf642ea78000,0x2c722a1fafd92da8,0xaa1fada82f648000,0x2f64ada8aa1f3000,0xaea7aa1f2fd98000,0xa63eaf642c722da8
.quad 0xb000800030008000,0xb000800030008000,0xaea72a1f2fd98000,0xa63e2f642c72ada8,0xaa1f2da82f648000,0x2f642da8aa1fb000,0x263e2f642ea78000,0x2c72aa1fafd9ada8
.quad 0x2da830002da88000,0xada8b000ada88000,0x2fd92f642c728000,0xaea7aa1f263e2da8,0x2f642da82a1f8000,0x2a1f2da82f643000,0x2c722a1f263e8000,0x2fd92f642ea72da8
.quad 0x8000800080008000,0x8000800080008000,0x2ea7af642fd9b000,0x263eaa1f2c72ada8,0xaf642da8aa1f8000,0xaa1f2da8af643000,0x263e2a1faea73000,0x2c72af642fd9ada8
.quad 0x2da8b0002da88000,0xada83000ada88000,0xafd92a1f2c72b000,0x2ea7af64263e2da8,0x2a1f2da8af648000,0xaf642da82a1fb000,0x2c72af64a63e3000,0x2fd9aa1faea72da8
.quad 0xb000800030008000,0xb000800030008000,0x2c722f64a63eb000,0x2fd92a1faea7ada8,0x2a1fada8af648000,0xaf64ada82a1f3000,0xafd9aa1f2c723000,0x2ea72f64263eada8
.quad 0x2da830002da88000,0xada8b000ada88000,0x263eaa1faea7b000,0x2c722f642fd92da8,0xaf64ada8aa1f8000,0xaa1fada8af64b000,0x2ea72f642fd93000,0x263e2a1f2c722da8
.quad 0x8000800080008000,0x8000800080008000,0xac722a1fa63e8000,0xafd92f64aea72da8,0x2f64ada82a1f8000,0x2a1fada82f64b000,0xafd92f64ac728000,0x2ea7aa1fa63e2da8
.quad 0x2da8b0002da88000,0xada83000ada88000,0xa63e2f64aea78000,0xac72aa1f2fd9ada8,0xaa1fada82f648000,0x2f64ada8aa1f3000,0x2ea72a1fafd98000,0x263e2f64ac72ada8
.quad 0xb000800030008000,0xb000800030008000,0x2ea7aa1fafd98000,0x263eaf64ac722da8,0xaa1f2da82f648000,0x2f642da8aa1fb000,0xa63eaf64aea78000,0xac722a1f2fd92da8
.quad 0x2da830002da88000,0xada8b000ada88000,0xafd9af64ac728000,0x2ea72a1fa63eada8,0x2f642da82a1f8000,0x2a1f2da82f643000,0xac72aa1fa63e8000,0xafd9af64aea7ada8
.quad 0x8000800080008000,0x8000800080008000,0xaea72f64afd93000,0xa63e2a1fac722da8,0xaf642da8aa1f8000,0xaa1f2da8af643000,0xa63eaa1f2ea7b000,0xac722f64afd92da8
.quad 0x2da8b0002da88000,0xada83000ada88000,0x2fd9aa1fac723000,0xaea72f64a63eada8,0x2a1f2da8af648000,0xaf642da82a1fb000,0xac722f64263eb000,0xafd92a1f2ea7ada8
.quad 0xb000800030008000,0xb000800030008000,0xac72af64263e3000,0xafd9aa1f2ea72da8,0x2a1fada8af648000,0xaf64ada82a1f3000,0x2fd92a1fac72b000,0xaea7af64a63e2da8
.quad 0x2da830002da88000,0xada8b000ada88000,0xa63e2a1f2ea73000,0xac72af64afd9ada8,0xaf64ada8aa1f8000,0xaa1fada8af64b000,0xaea7af64afd9b000,0xa63eaa1fac72ada8
.quad 0x3000300030003000,0x3000300030003000,0x2fa82fd92ff63000,0x2e2f2ea72f0e2f64,0x2ea72f642fd93000,0x263e2a1f2c722da8,0x2d132ea72fa83000,0xab8ba63e22462a1f
.quad 0x2a1f2da82f643000,0xaf64ada8aa1f0000,0x22462c722f0e3000,0xafa8afd9ae2faa1f,0xa63e2a1f2ea73000,0xac72af64afd9ada8,0xab8b263e2e2f3000,0x2246ac72afa8af64
.quad 0xada800002da83000,0x2da88000ada8b000,0xaf0ea63e2d133000,0x2ff62c72a8a5af64,0xafd9aa1f2c723000,0x2ea72f64263eada8,0xaff6ac722b8b3000,0x28a52fd92d13aa1f
.quad 0xaf64ada82a1f3000,0xaa1f2da82f648000,0xae2faea728a53000,0xaf0e263e2ff62a1f,0xac72af64263e3000,0xafd9aa1f2ea72da8,0xa8a5afd922463000,0xad13aea72b8b2f64
.quad 0x3000300030003000,0x3000300030003000,0x2b8b2c722d132da8,0x2246263e28a52a1f,0xac72aa1fa63e0000,0xafd9af64aea7ada8,0xaff6afd9af0eada8,0xa8a5ac72ae2faf64
.quad 0xaa1fada8af64b000,0x2f642da82a1f8000,0x2d13263ea8a5ada8,0x2b8b2ea72ff62f64,0x2fd92f642c728000,0xaea7aa1f263e2da8,0x28a52ea72ff62da8,0xad13afd9af0eaa1f
.quad 0xada800002da83000,0x2da88000ada8b000,0xafa8aea7a2462da8,0x2e2f2fd92b8baa1f,0xa63eaf64aea70000,0xac722a1f2fd92da8,0x2e2fa63eafa8ada8,0xaf0eaea722462f64
.quad 0x2f642da8aa1fb000,0x2a1fada8af640000,0x22462fd92b8bada8,0x2fa82c72ad13af64,0xaea72a1f2fd98000,0xa63e2f642c72ada8,0xaf0eac722e2f2da8,0xaff6a63e2fa82a1f
.quad 0x3000300030003000,0x3000300030003000,0xa8a5a63ea2460000,0xad13ac72ab8baa1f,0xaea7af64afd9b000,0xa63eaa1fac72ada8,0x2e2f2c7228a58000,0x2f0e2fd92ff62f64
.quad 0x2a1f2da82f643000,0xaf64ada8aa1f0000,0xaff6aea7ab8b0000,0x28a5a63ead13af64,0x263eaa1faea7b000,0x2c722f642fd92da8,0x2f0e2fd92d138000,0xaff6aea7a8a52a1f
.quad 0xada800002da83000,0x2da88000ada8b000,0xab8bafd9ae2f0000,0x22462ea72fa82a1f,0x2fd92a1fac72b000,0xaea7af64a63e2da8,0xa2462ea72f0e8000,0x2fa8263eae2faf64
.quad 0xaf64ada82a1f3000,0xaa1f2da82f648000,0x2d13ac72afa80000,0xab8bafd9a2462f64,0x2c722f64a63eb000,0x2fd92a1faea7ada8,0xafa8263e2ff68000,0xae2f2c722f0eaa1f
.quad 0x3000300030003000,0x3000300030003000,0xaf0eaea7ae2fada8,0xaff6afd9afa8af64,0x2c722a1f263e8000,0x2fd92f642ea72da8,0xa246263e2b8b2da8,0xafa8aea7ad13aa1f
.quad 0xaa1fada8af64b000,0x2f642da82a1f8000,0x2e2f2fd92fa82da8,0xaf0eac72a2462a1f,0xafd9af64ac720000,0x2ea72a1fa63eada8,0x2fa82c72a246ada8,0xae2fa63e2b8b2f64
.quad 0xada800002da83000,0x2da88000ada8b000,0x28a5ac72aff6ada8,0xad13263e2f0e2f64,0x263e2f642ea78000,0x2c72aa1fafd9ada8,0xad13afd9a8a52da8,0xab8b2c722ff62a1f
.quad 0x2f642da8aa1fb000,0x2a1fada8af640000,0xaff6a63e2f0e2da8,0xa8a52ea72e2faa1f,0x2ea7aa1fafd90000,0x263eaf64ac722da8,0xab8b2ea72d13ada8,0xa2462fd928a5af64
.quad 0x3000300030003000,0x3000300030003000,0xafa8afd9aff6b000,0xae2faea7af0eaf64,0x2ea72f642fd93000,0x263e2a1f2c722da8,0xad13aea7afa8b000,0x2b8b263ea246aa1f
.quad 0x2a1f2da82f643000,0xaf64ada8aa1f0000,0xa246ac72af0eb000,0x2fa82fd92e2f2a1f,0xa63e2a1f2ea73000,0xac72af64afd9ada8,0x2b8ba63eae2fb000,0xa2462c722fa82f64
.quad 0xada800002da83000,0x2da88000ada8b000,0x2f0e263ead13b000,0xaff6ac7228a52f64,0xafd9aa1f2c723000,0x2ea72f64263eada8,0x2ff62c72ab8bb000,0xa8a5afd9ad132a1f
.quad 0xaf64ada82a1f3000,0xaa1f2da82f648000,0x2e2f2ea7a8a5b000,0x2f0ea63eaff6aa1f,0xac72af64263e3000,0xafd9aa1f2ea72da8,0x28a52fd9a246b000,0x2d132ea7ab8baf64
.quad 0x3000300030003000,0x3000300030003000,0xab8bac72ad13ada8,0xa246a63ea8a5aa1f,0xac72aa1fa63e0000,0xafd9af64aea7ada8,0x2ff62fd92f0e2da8,0x28a52c722e2f2f64
.quad 0xaa1fada8af64b000,0x2f642da82a1f8000,0xad13a63e28a52da8,0xab8baea7aff6af64,0x2fd92f642c728000,0xaea7aa1f263e2da8,0xa8a5aea7aff6ada8,0x2d132fd92f0e2a1f
.quad 0xada800002da83000,0x2da88000ada8b000,0x2fa82ea72246ada8,0xae2fafd9ab8b2a1f,0xa63eaf64aea70000,0xac722a1f2fd92da8,0xae2f263e2fa82da8,0x2f0e2ea7a246af64
.quad 0x2f642da8aa1fb000,0x2a1fada8af640000,0xa246afd9ab8b2da8,0xafa8ac722d132f64,0xaea72a1f2fd98000,0xa63e2f642c72ada8,0x2f0e2c72ae2fada8,0x2ff6263eafa8aa1f
.quad 0x3000300030003000,0x3000300030003000,0x28a5263e22468000,0x2d132c722b8b2a1f,0xaea7af64afd9b000,0xa63eaa1fac72ada8,0xae2fac72a8a50000,0xaf0eafd9aff6af64
.quad 0x2a1f2da82f643000,0xaf64ada8aa1f0000,0x2ff62ea72b8b8000,0xa8a5263e2d132f64,0x263eaa1faea7b000,0x2c722f642fd92da8,0xaf0eafd9ad130000,0x2ff62ea728a5aa1f
.quad 0xada800002da83000,0x2da88000ada8b000,0x2b8b2fd92e2f8000,0xa246aea7afa8aa1f,0x2fd92a1fac72b000,0xaea7af64a63e2da8,0x2246aea7af0e0000,0xafa8a63e2e2f2f64
.quad 0xaf64ada82a1f3000,0xaa1f2da82f648000,0xad132c722fa88000,0x2b8b2fd92246af64,0x2c722f64a63eb000,0x2fd92a1faea7ada8,0x2fa8a63eaff60000,0x2e2fac72af0e2a1f
.quad 0x3000300030003000,0x3000300030003000,0x2f0e2ea72e2f2da8,0x2ff62fd92fa82f64,0x2c722a1f263e8000,0x2fd92f642ea72da8,0x2246a63eab8bada8,0x2fa82ea72d132a1f
.quad 0xaa1fada8af64b000,0x2f642da82a1f8000,0xae2fafd9afa8ada8,0x2f0e2c722246aa1f,0xafd9af64ac720000,0x2ea72a1fa63eada8,0xafa8ac7222462da8,0x2e2f263eab8baf64
.quad 0xada800002da83000,0x2da88000ada8b000,0xa8a52c722ff62da8,0x2d13a63eaf0eaf64,0x263e2f642ea78000,0x2c72aa1fafd9ada8,0x2d132fd928a5ada8,0x2b8bac72aff6aa1f
.quad 0x2f642da8aa1fb000,0x2a1fada8af640000,0x2ff6263eaf0eada8,0x28a5aea7ae2f2a1f,0x2ea7aa1fafd90000,0x263eaf64ac722da8,0x2b8baea7ad132da8,0x2246afd9a8a52f64
.quad 0x8000800080008000,0x8000800080008000,0xa8a5a63ea2468000,0xad13ac72ab8baa1f,0xac72aa1fa63e8000,0xafd9af64aea7ada8,0xae2fac72a8a58000,0xaf0eafd9aff6af64
.quad 0xaf64ada8aa1f8000,0xaa1fada8af64b000,0xaff6aea7ab8b8000,0x28a5a63ead13af64,0xafd9af64ac728000,0x2ea72a1fa63eada8,0xaf0eafd9ad138000,0x2ff62ea728a5aa1f
.quad 0xada8b000ada88000,0x2da830002da88000,0xab8bafd9ae2f8000,0x22462ea72fa82a1f,0xa63eaf64aea78000,0xac722a1f2fd92da8,0x2246aea7af0e8000,0xafa8a63e2e2f2f64
.quad 0x2a1fada8af648000,0xaf64ada82a1f3000,0x2d13ac72afa88000,0xab8bafd9a2462f64,0x2ea7aa1fafd98000,0x263eaf64ac722da8,0x2fa8a63eaff68000,0x2e2fac72af0e2a1f
.quad 0x8000800080008000,0x8000800080008000,0xaf0eaea7ae2fada8,0xaff6afd9afa8af64,0xaea7af64afd9b000,0xa63eaa1fac72ada8,0x2246a63eab8bada8,0x2fa82ea72d132a1f
.quad 0x2f642da82a1f8000,0x2a1f2da82f643000,0x2e2f2fd92fa82da8,0xaf0eac72a2462a1f,0xa63e2a1f2ea73000,0xac72af64afd9ada8,0xafa8ac7222462da8,0x2e2f263eab8baf64
.quad 0xada8b000ada88000,0x2da830002da88000,0x28a5ac72aff6ada8,0xad13263e2f0e2f64,0x2fd92a1fac72b000,0xaea7af64a63e2da8,0x2d132fd928a5ada8,0x2b8bac72aff6aa1f
.quad 0xaa1f2da82f648000,0x2f642da8aa1fb000,0xaff6a63e2f0e2da8,0xa8a52ea72e2faa1f,0xac72af64263e3000,0xafd9aa1f2ea72da8,0x2b8baea7ad132da8,0x2246afd9a8a52f64
.quad 0x8000800080008000,0x8000800080008000,0xafa8afd9aff6b000,0xae2faea7af0eaf64,0x2c722a1f263e8000,0x2fd92f642ea72da8,0x2d132ea72fa83000,0xab8ba63e22462a1f
.quad 0xaf64ada8aa1f8000,0xaa1fada8af64b000,0xa246ac72af0eb000,0x2fa82fd92e2f2a1f,0x2fd92f642c728000,0xaea7aa1f263e2da8,0xab8b263e2e2f3000,0x2246ac72afa8af64
.quad 0xada8b000ada88000,0x2da830002da88000,0x2f0e263ead13b000,0xaff6ac7228a52f64,0x263e2f642ea78000,0x2c72aa1fafd9ada8,0xaff6ac722b8b3000,0x28a52fd92d13aa1f
.quad 0x2a1fada8af648000,0xaf64ada82a1f3000,0x2e2f2ea7a8a5b000,0x2f0ea63eaff6aa1f,0xaea72a1f2fd98000,0xa63e2f642c72ada8,0xa8a5afd922463000,0xad13aea72b8b2f64
.quad 0x8000800080008000,0x8000800080008000,0xab8bac72ad13ada8,0xa246a63ea8a5aa1f,0x2ea72f642fd93000,0x263e2a1f2c722da8,0xaff6afd9af0eada8,0xa8a5ac72ae2faf64
.quad 0x2f642da82a1f8000,0x2a1f2da82f643000,0xad13a63e28a52da8,0xab8baea7aff6af64,0x263eaa1faea7b000,0x2c722f642fd92da8,0x28a52ea72ff62da8,0xad13afd9af0eaa1f
.quad 0xada8b000ada88000,0x2da830002da88000,0x2fa82ea72246ada8,0xae2fafd9ab8b2a1f,0xafd9aa1f2c723000,0x2ea72f64263eada8,0x2e2fa63eafa8ada8,0xaf0eaea722462f64
.quad 0xaa1f2da82f648000,0x2f642da8aa1fb000,0xa246afd9ab8b2da8,0xafa8ac722d132f64,0x2c722f64a63eb000,0x2fd92a1faea7ada8,0xaf0eac722e2f2da8,0xaff6a63e2fa82a1f
.quad 0x8000800080008000,0x8000800080008000,0x28a5263e22468000,0x2d132c722b8b2a1f,0xac72aa1fa63e8000,0xafd9af64aea7ada8,0x2e2f2c7228a58000,0x2f0e2fd92ff62f64
.quad 0xaf64ada8aa1f8000,0xaa1fada8af64b000,0x2ff62ea72b8b8000,0xa8a5263e2d132f64,0xafd9af64ac728000,0x2ea72a1fa63eada8,0x2f0e2fd92d138000,0xaff6aea7a8a52a1f
.quad 0xada8b000ada88000,0x2da830002da88000,0x2b8b2fd92e2f8000,0xa246aea7afa8aa1f,0xa63eaf64aea78000,0xac722a1f2fd92da8,0xa2462ea72f0e8000,0x2fa8263eae2faf64
.quad 0x2a1fada8af648000,0xaf64ada82a1f3000,0xad132c722fa88000,0x2b8b2fd92246af64,0x2ea7aa1fafd98000,0x263eaf64ac722da8,0xafa8263e2ff68000,0xae2f2c722f0eaa1f
.quad 0x8000800080008000,0x8000800080008000,0x2f0e2ea72e2f2da8,0x2ff62fd92fa82f64,0xaea7af64afd9b000,0xa63eaa1fac72ada8,0xa246263e2b8b2da8,0xafa8aea7ad13aa1f
.quad 0x2f642da82a1f8000,0x2a1f2da82f643000,0xae2fafd9afa8ada8,0x2f0e2c722246aa1f,0xa63e2a1f2ea73000,0xac72af64afd9ada8,0x2fa82c72a246ada8,0xae2fa63e2b8b2f64
.quad 0xada8b000ada88000,0x2da830002da88000,0xa8a52c722ff62da8,0x2d13a63eaf0eaf64,0x2fd92a1fac72b000,0xaea7af64a63e2da8,0xad13afd9a8a52da8,0xab8b2c722ff62a1f
.quad 0xaa1f2da82f648000,0x2f642da8aa1fb000,0x2ff6263eaf0eada8,0x28a5aea7ae2f2a1f,0xac72af64263e3000,0xafd9aa1f2ea72da8,0xab8b2ea72d13ada8,0xa2462fd928a5af64
.quad 0x8000800080008000,0x8000800080008000,0x2fa82fd92ff63000,0x2e2f2ea72f0e2f64,0x2c722a1f263e8000,0x2fd92f642ea72da8,0xad13aea7afa8b000,0x2b8b263ea246aa1f
.quad 0xaf64ada8aa1f8000,0xaa1fada8af64b000,0x22462c722f0e3000,0xafa8afd9ae2faa1f,0x2fd92f642c728000,0xaea7aa1f263e2da8,0x2b8ba63eae2fb000,0xa2462c722fa82f64
.quad 0xada8b000ada88000,0x2da830002da88000,0xaf0ea63e2d133000,0x2ff62c72a8a5af64,0x263e2f642ea78000,0x2c72aa1fafd9ada8,0x2ff62c72ab8bb000,0xa8a5afd9ad132a1f
.quad 0x2a1fada8af648000,0xaf64ada82a1f3000,0xae2faea728a53000,0xaf0e263e2ff62a1f,0xaea72a1f2fd98000,0xa63e2f642c72ada8,0x28a52fd9a246b000,0x2d132ea7ab8baf64
.quad 0x8000800080008000,0x8000800080008000,0x2b8b2c722d132da8,0x2246263e28a52a1f,0x2ea72f642fd93000,0x263e2a1f2c722da8,0x2ff62fd92f0e2da8,0x28a52c722e2f2f64
.quad 0x2f642da82a1f8000,0x2a1f2da82f643000,0x2d13263ea8a5ada8,0x2b8b2ea72ff62f64,0x263eaa1faea7b000,0x2c722f642fd92da8,0xa8a5aea7aff6ada8,0x2d132fd92f0e2a1f
.quad 0xada8b000ada88000,0x2da830002da88000,0xafa8aea7a2462da8,0x2e2f2fd92b8baa1f,0xafd9aa1f2c723000,0x2ea72f64263eada8,0xae2f263e2fa82da8,0x2f0e2ea7a246af64
.quad 0xaa1f2da82f648000,0x2f642da8aa1fb000,0x22462fd92b8bada8,0x2fa82c72ad13af64,0x2c722f64a63eb000,0x2fd92a1faea7ada8,0x2f0e2c72ae2fada8,0x2ff6263eafa8aa1f
.quad 0x8000b00000003000,0x8000b00000003000,0x28a5afd9a2463000,0x2d13aea7ab8b2f64,0x2c72af64a63e3000,0x2fd9aa1faea72da8,0x2e2faea7a8a53000,0x2f0e263eaff62a1f
.quad 0x2f64ada8aa1f3000,0x2a1f2da8af640000,0x2ff6ac72ab8b3000,0xa8a52fd9ad13aa1f,0x2fd9aa1fac723000,0xaea72f64a63eada8,0x2f0ea63ead133000,0xaff62c7228a5af64
.quad 0x2da88000ada83000,0xada800002da8b000,0x2b8b263eae2f3000,0xa246ac722fa8af64,0x263e2a1faea73000,0x2c72af642fd9ada8,0xa2462c72af0e3000,0x2fa8afd92e2faa1f
.quad 0xaa1f2da8af643000,0x2f64ada82a1f8000,0xad132ea7afa83000,0x2b8ba63ea2462a1f,0xaea72f64afd93000,0xa63e2a1fac722da8,0xafa82fd9aff63000,0xae2f2ea7af0e2f64
.quad 0x8000b00000003000,0x8000b00000003000,0x2f0eac72ae2f2da8,0x2ff6a63eafa82a1f,0x2ea72a1fafd90000,0x263e2f64ac72ada8,0xa2462fd9ab8bada8,0xafa82c722d13af64
.quad 0xaf642da82a1fb000,0xaa1fada82f648000,0xae2fa63e2fa8ada8,0x2f0eaea7a2462f64,0x263eaf642ea78000,0x2c722a1fafd92da8,0x2fa8aea722462da8,0xae2f2fd9ab8baa1f
.quad 0x2da88000ada83000,0xada800002da8b000,0xa8a52ea7aff62da8,0x2d13afd92f0eaa1f,0xafd92f64ac720000,0x2ea7aa1fa63e2da8,0xad13263e28a5ada8,0xab8b2ea7aff62f64
.quad 0x2a1fada82f64b000,0xaf642da8aa1f0000,0x2ff6afd92f0eada8,0x28a5ac722e2faf64,0x2c72aa1f263e8000,0x2fd9af642ea7ada8,0xab8b2c72ad132da8,0xa246263ea8a52a1f
.quad 0x8000b00000003000,0x8000b00000003000,0x2fa8263eaff60000,0x2e2f2c72af0eaa1f,0xac722f64263eb000,0xafd92a1f2ea7ada8,0xad13ac722fa88000,0x2b8bafd922462f64
.quad 0x2f64ada8aa1f3000,0x2a1f2da8af640000,0x22462ea7af0e0000,0xafa8263e2e2faf64,0xafd92a1f2c72b000,0x2ea7af64263e2da8,0x2b8bafd92e2f8000,0xa2462ea7afa82a1f
.quad 0x2da88000ada83000,0xada800002da8b000,0xaf0e2fd9ad130000,0x2ff6aea728a52a1f,0xa63eaa1f2ea7b000,0xac722f64afd92da8,0x2ff6aea72b8b8000,0xa8a5a63e2d13af64
.quad 0xaa1f2da8af643000,0x2f64ada82a1f8000,0xae2f2c72a8a50000,0xaf0e2fd9aff62f64,0x2ea7af642fd9b000,0x263eaa1f2c72ada8,0x28a5a63e22468000,0x2d13ac722b8baa1f
.quad 0x8000b00000003000,0x8000b00000003000,0x2b8b2ea7ad13ada8,0x22462fd9a8a5af64,0xaea7aa1f2fd98000,0xa63eaf642c722da8,0x2ff6a63eaf0e2da8,0x28a52ea7ae2faa1f
.quad 0xaf642da82a1fb000,0xaa1fada82f648000,0x2d13afd928a52da8,0x2b8b2c72aff62a1f,0xa63e2f64aea70000,0xac72aa1f2fd9ada8,0xa8a5ac722ff6ada8,0x2d13263eaf0e2f64
.quad 0x2da88000ada83000,0xada800002da8b000,0xafa82c722246ada8,0x2e2fa63eab8b2f64,0x2fd9af642c728000,0xaea72a1f263eada8,0xae2f2fd9afa82da8,0x2f0eac7222462a1f
.quad 0x2a1fada82f64b000,0xaf642da8aa1f0000,0x2246263eab8b2da8,0x2fa8aea72d13aa1f,0xac722a1fa63e0000,0xafd92f64aea72da8,0x2f0eaea72e2fada8,0x2ff6afd92fa8af64
.quad 0x8000b00000003000,0x8000b00000003000,0xa8a52fd92246b000,0xad132ea72b8baf64,0x2c72af64a63e3000,0x2fd9aa1faea72da8,0xae2f2ea728a5b000,0xaf0ea63e2ff6aa1f
.quad 0x2f64ada8aa1f3000,0x2a1f2da8af640000,0xaff62c722b8bb000,0x28a5afd92d132a1f,0x2fd9aa1fac723000,0xaea72f64a63eada8,0xaf0e263e2d13b000,0x2ff6ac72a8a52f64
.quad 0x2da88000ada83000,0xada800002da8b000,0xab8ba63e2e2fb000,0x22462c72afa82f64,0x263e2a1faea73000,0x2c72af642fd9ada8,0x2246ac722f0eb000,0xafa82fd9ae2f2a1f
.quad 0xaa1f2da8af643000,0x2f64ada82a1f8000,0x2d13aea72fa8b000,0xab8b263e2246aa1f,0xaea72f64afd93000,0xa63e2a1fac722da8,0x2fa8afd92ff6b000,0x2e2faea72f0eaf64
.quad 0x8000b00000003000,0x8000b00000003000,0xaf0e2c722e2fada8,0xaff6263e2fa8aa1f,0x2ea72a1fafd90000,0x263e2f64ac72ada8,0x2246afd92b8b2da8,0x2fa8ac72ad132f64
.quad 0xaf642da82a1fb000,0xaa1fada82f648000,0x2e2f263eafa82da8,0xaf0e2ea72246af64,0x263eaf642ea78000,0x2c722a1fafd92da8,0xafa82ea7a246ada8,0x2e2fafd92b8b2a1f
.quad 0x2da88000ada83000,0xada800002da8b000,0x28a5aea72ff6ada8,0xad132fd9af0e2a1f,0xafd92f64ac720000,0x2ea7aa1fa63e2da8,0x2d13a63ea8a52da8,0x2b8baea72ff6af64
.quad 0x2a1fada82f64b000,0xaf642da8aa1f0000,0xaff62fd9af0e2da8,0xa8a52c72ae2f2f64,0x2c72aa1f263e8000,0x2fd9af642ea7ada8,0x2b8bac722d13ada8,0x2246a63e28a5aa1f
.quad 0x8000b00000003000,0x8000b00000003000,0xafa8a63e2ff68000,0xae2fac722f0e2a1f,0xac722f64263eb000,0xafd92a1f2ea7ada8,0x2d132c72afa80000,0xab8b2fd9a246af64
.quad 0x2f64ada8aa1f3000,0x2a1f2da8af640000,0xa246aea72f0e8000,0x2fa8a63eae2f2f64,0xafd92a1f2c72b000,0x2ea7af64263e2da8,0xab8b2fd9ae2f0000,0x2246aea72fa8aa1f
.quad 0x2da88000ada83000,0xada800002da8b000,0x2f0eafd92d138000,0xaff62ea7a8a5aa1f,0xa63eaa1f2ea7b000,0xac722f64afd92da8,0xaff62ea7ab8b0000,0x28a5263ead132f64
.quad 0xaa1f2da8af643000,0x2f64ada82a1f8000,0x2e2fac7228a58000,0x2f0eafd92ff6af64,0x2ea7af642fd9b000,0x263eaa1f2c72ada8,0xa8a5263ea2460000,0xad132c72ab8b2a1f
.quad 0x8000b00000003000,0x8000b00000003000,0xab8baea72d132da8,0xa246afd928a52f64,0xaea7aa1f2fd98000,0xa63eaf642c722da8,0xaff6263e2f0eada8,0xa8a5aea72e2f2a1f
.quad 0xaf642da82a1fb000,0xaa1fada82f648000,0xad132fd9a8a5ada8,0xab8bac722ff6aa1f,0xa63e2f64aea70000,0xac72aa1f2fd9ada8,0x28a52c72aff62da8,0xad13a63e2f0eaf64
.quad 0x2da88000ada83000,0xada800002da8b000,0x2fa8ac72a2462da8,0xae2f263e2b8baf64,0x2fd9af642c728000,0xaea72a1f263eada8,0x2e2fafd92fa8ada8,0xaf0e2c72a246aa1f
.quad 0x2a1fada82f64b000,0xaf642da8aa1f0000,0xa246a63e2b8bada8,0xafa82ea7ad132a1f,0xac722a1fa63e0000,0xafd92f64aea72da8,0xaf0e2ea7ae2f2da8,0xaff62fd9afa82f64
.quad 0x30008000b0008000,0x30008000b0008000,0x2fa8263eaff68000,0x2e2f2c72af0eaa1f,0x2ea72a1fafd98000,0x263e2f64ac72ada8,0x2d132c72afa88000,0xab8b2fd9a246af64
.quad 0x2a1f2da8af648000,0xaf642da82a1fb000,0x22462ea7af0e8000,0xafa8263e2e2faf64,0xa63e2f64aea78000,0xac72aa1f2fd9ada8,0xab8b2fd9ae2f8000,0x2246aea72fa8aa1f
.quad 0xada83000ada88000,0x2da8b0002da88000,0xaf0e2fd9ad138000,0x2ff6aea728a52a1f,0xafd92f64ac728000,0x2ea7aa1fa63e2da8,0xaff62ea7ab8b8000,0x28a5263ead132f64
.quad 0xaf642da8aa1f8000,0xaa1f2da8af643000,0xae2f2c72a8a58000,0xaf0e2fd9aff62f64,0xac722a1fa63e8000,0xafd92f64aea72da8,0xa8a5263ea2468000,0xad132c72ab8b2a1f
.quad 0x30008000b0008000,0x30008000b0008000,0x2b8b2ea7ad13ada8,0x22462fd9a8a5af64,0xac722f64263eb000,0xafd92a1f2ea7ada8,0xaff6263e2f0eada8,0xa8a5aea72e2f2a1f
.quad 0xaa1fada82f648000,0x2f64ada8aa1f3000,0x2d13afd928a52da8,0x2b8b2c72aff62a1f,0x2fd9aa1fac723000,0xaea72f64a63eada8,0x28a52c72aff62da8,0xad13a63e2f0eaf64
.quad 0xada83000ada88000,0x2da8b0002da88000,0xafa82c722246ada8,0x2e2fa63eab8b2f64,0xa63eaa1f2ea7b000,0xac722f64afd92da8,0x2e2fafd92fa8ada8,0xaf0e2c72a246aa1f
.quad 0x2f64ada82a1f8000,0x2a1fada82f64b000,0x2246263eab8b2da8,0x2fa8aea72d13aa1f,0xaea72f64afd93000,0xa63e2a1fac722da8,0xaf0e2ea7ae2f2da8,0xaff62fd9afa82f64
.quad 0x30008000b0008000,0x30008000b0008000,0xa8a52fd92246b000,0xad132ea72b8baf64,0xaea7aa1f2fd98000,0xa63eaf642c722da8,0x2e2faea7a8a53000,0x2f0e263eaff62a1f
.quad 0x2a1f2da8af648000,0xaf642da82a1fb000,0xaff62c722b8bb000,0x28a5afd92d132a1f,0x263eaf642ea78000,0x2c722a1fafd92da8,0x2f0ea63ead133000,0xaff62c7228a5af64
.quad 0xada83000ada88000,0x2da8b0002da88000,0xab8ba63e2e2fb000,0x22462c72afa82f64,0x2fd9af642c728000,0xaea72a1f263eada8,0xa2462c72af0e3000,0x2fa8afd92e2faa1f
.quad 0xaf642da8aa1f8000,0xaa1f2da8af643000,0x2d13aea72fa8b000,0xab8b263e2246aa1f,0x2c72aa1f263e8000,0x2fd9af642ea7ada8,0xafa82fd9aff63000,0xae2f2ea7af0e2f64
.quad 0x30008000b0008000,0x30008000b0008000,0xaf0e2c722e2fada8,0xaff6263e2fa8aa1f,0x2c72af64a63e3000,0x2fd9aa1faea72da8,0xa2462fd9ab8bada8,0xafa82c722d13af64
.quad 0xaa1fada82f648000,0x2f64ada8aa1f3000,0x2e2f263eafa82da8,0xaf0e2ea72246af64,0xafd92a1f2c72b000,0x2ea7af64263e2da8,0x2fa8aea722462da8,0xae2f2fd9ab8baa1f
.quad 0xada83000ada88000,0x2da8b0002da88000,0x28a5aea72ff6ada8,0xad132fd9af0e2a1f,0x263e2a1faea73000,0x2c72af642fd9ada8,0xad13263e28a5ada8,0xab8b2ea7aff62f64
.quad 0x2f64ada82a1f8000,0x2a1fada82f64b000,0xaff62fd9af0e2da8,0xa8a52c72ae2f2f64,0x2ea7af642fd9b000,0x263eaa1f2c72ada8,0xab8b2c72ad132da8,0xa246263ea8a52a1f
.quad 0x30008000b0008000,0x30008000b0008000,0xafa8a63e2ff68000,0xae2fac722f0e2a1f,0x2ea72a1fafd98000,0x263e2f64ac72ada8,0xad13ac722fa88000,0x2b8bafd922462f64
.quad 0x2a1f2da8af648000,0xaf642da82a1fb000,0xa246aea72f0e8000,0x2fa8a63eae2f2f64,0xa63e2f64aea78000,0xac72aa1f2fd9ada8,0x2b8bafd92e2f8000,0xa2462ea7afa82a1f
.quad 0xada83000ada88000,0x2da8b0002da88000,0x2f0eafd92d138000,0xaff62ea7a8a5aa1f,0xafd92f64ac728000,0x2ea7aa1fa63e2da8,0x2ff6aea72b8b8000,0xa8a5a63e2d13af64
.quad 0xaf642da8aa1f8000,0xaa1f2da8af643000,0x2e2fac7228a58000,0x2f0eafd92ff6af64,0xac722a1fa63e8000,0xafd92f64aea72da8,0x28a5a63e22468000,0x2d13ac722b8baa1f
.quad 0x30008000b0008000,0x30008000b0008000,0xab8baea72d132da8,0xa246afd928a52f64,0xac722f64263eb000,0xafd92a1f2ea7ada8,0x2ff6a63eaf0e2da8,0x28a52ea7ae2faa1f
.quad 0xaa1fada82f648000,0x2f64ada8aa1f3000,0xad132fd9a8a5ada8,0xab8bac722ff6aa1f,0x2fd9aa1fac723000,0xaea72f64a63eada8,0xa8a5ac722ff6ada8,0x2d13263eaf0e2f64
.quad 0xada83000ada88000,0x2da8b0002da88000,0x2fa8ac72a2462da8,0xae2f263e2b8baf64,0xa63eaa1f2ea7b000,0xac722f64afd92da8,0xae2f2fd9afa82da8,0x2f0eac7222462a1f
.quad 0x2f64ada82a1f8000,0x2a1fada82f64b000,0xa246a63e2b8bada8,0xafa82ea7ad132a1f,0xaea72f64afd93000,0xa63e2a1fac722da8,0x2f0eaea72e2fada8,0x2ff6afd92fa8af64
.quad 0x30008000b0008000,0x30008000b0008000,0x28a5afd9a2463000,0x2d13aea7ab8b2f64,0xaea7aa1f2fd98000,0xa63eaf642c722da8,0xae2f2ea728a5b000,0xaf0ea63e2ff6aa1f
.quad 0x2a1f2da8af648000,0xaf642da82a1fb000,0x2ff6ac72ab8b3000,0xa8a52fd9ad13aa1f,0x263eaf642ea78000,0x2c722a1fafd92da8,0xaf0e263e2d13b000,0x2ff6ac72a8a52f64
.quad 0xada83000ada88000,0x2da8b0002da88000,0x2b8b263eae2f3000,0xa246ac722fa8af64,0x2fd9af642c728000,0xaea72a1f263eada8,0x2246ac722f0eb000,0xafa82fd9ae2f2a1f
.quad 0xaf642da8aa1f8000,0xaa1f2da8af643000,0xad132ea7afa83000,0x2b8ba63ea2462a1f,0x2c72aa1f263e8000,0x2fd9af642ea7ada8,0x2fa8afd92ff6b000,0x2e2faea72f0eaf64
.quad 0x30008000b0008000,0x30008000b0008000,0x2f0eac72ae2f2da8,0x2ff6a63eafa82a1f,0x2c72af64a63e3000,0x2fd9aa1faea72da8,0x2246afd92b8b2da8,0x2fa8ac72ad132f64
.quad 0xaa1fada82f648000,0x2f64ada8aa1f3000,0xae2fa63e2fa8ada8,0x2f0eaea7a2462f64,0xafd92a1f2c72b000,0x2ea7af64263e2da8,0xafa82ea7a246ada8,0x2e2fafd92b8b2a1f
.quad 0xada83000ada88000,0x2da8b0002da88000,0xa8a52ea7aff62da8,0x2d13afd92f0eaa1f,0x263e2a1faea73000,0x2c72af642fd9ada8,0x2d13a63ea8a52da8,0x2b8baea72ff6af64
.quad 0x2f64ada82a1f8000,0x2a1fada82f64b000,0x2ff6afd92f0eada8,0x28a5ac722e2faf64,0x2ea7af642fd9b000,0x263eaa1f2c72ada8,0x2b8bac722d13ada8,0x2246a63e28a5aa1f
.quad 0xb0003000b0003000,0xb0003000b0003000,0xafa82fd9aff63000,0xae2f2ea7af0e2f64,0xaea72f64afd93000,0xa63e2a1fac722da8,0xad132ea7afa83000,0x2b8ba63ea2462a1f
.quad 0xaa1f2da8af643000,0x2f64ada82a1f0000,0xa2462c72af0e3000,0x2fa8afd92e2faa1f,0x263e2a1faea73000,0x2c72af642fd9ada8,0x2b8b263eae2f3000,0xa246ac722fa8af64
.quad 0x2da80000ada83000,0xada880002da8b000,0x2f0ea63ead133000,0xaff62c7228a5af64,0x2fd9aa1fac723000,0xaea72f64a63eada8,0x2ff6ac72ab8b3000,0xa8a52fd9ad13aa1f
.quad 0x2f64ada8aa1f3000,0x2a1f2da8af648000,0x2e2faea7a8a53000,0x2f0e263eaff62a1f,0x2c72af64a63e3000,0x2fd9aa1faea72da8,0x28a5afd9a2463000,0x2d13aea7ab8b2f64
.quad 0xb0003000b0003000,0xb0003000b0003000,0xab8b2c72ad132da8,0xa246263ea8a52a1f,0x2c72aa1f263e0000,0x2fd9af642ea7ada8,0x2ff6afd92f0eada8,0x28a5ac722e2faf64
.quad 0x2a1fada82f64b000,0xaf642da8aa1f8000,0xad13263e28a5ada8,0xab8b2ea7aff62f64,0xafd92f64ac728000,0x2ea7aa1fa63e2da8,0xa8a52ea7aff62da8,0x2d13afd92f0eaa1f
.quad 0x2da80000ada83000,0xada880002da8b000,0x2fa8aea722462da8,0xae2f2fd9ab8baa1f,0x263eaf642ea70000,0x2c722a1fafd92da8,0xae2fa63e2fa8ada8,0x2f0eaea7a2462f64
.quad 0xaf642da82a1fb000,0xaa1fada82f640000,0xa2462fd9ab8bada8,0xafa82c722d13af64,0x2ea72a1fafd98000,0x263e2f64ac72ada8,0x2f0eac72ae2f2da8,0x2ff6a63eafa82a1f
.quad 0xb0003000b0003000,0xb0003000b0003000,0x28a5a63e22460000,0x2d13ac722b8baa1f,0x2ea7af642fd9b000,0x263eaa1f2c72ada8,0xae2f2c72a8a58000,0xaf0e2fd9aff62f64
.quad 0xaa1f2da8af643000,0x2f64ada82a1f0000,0x2ff6aea72b8b0000,0xa8a5a63e2d13af64,0xa63eaa1f2ea7b000,0xac722f64afd92da8,0xaf0e2fd9ad138000,0x2ff6aea728a52a1f
.quad 0x2da80000ada83000,0xada880002da8b000,0x2b8bafd92e2f0000,0xa2462ea7afa82a1f,0xafd92a1f2c72b000,0x2ea7af64263e2da8,0x22462ea7af0e8000,0xafa8263e2e2faf64
.quad 0x2f64ada8aa1f3000,0x2a1f2da8af648000,0xad13ac722fa80000,0x2b8bafd922462f64,0xac722f64263eb000,0xafd92a1f2ea7ada8,0x2fa8263eaff68000,0x2e2f2c72af0eaa1f
.quad 0xb0003000b0003000,0xb0003000b0003000,0x2f0eaea72e2fada8,0x2ff6afd92fa8af64,0xac722a1fa63e8000,0xafd92f64aea72da8,0x2246263eab8b2da8,0x2fa8aea72d13aa1f
.quad 0x2a1fada82f64b000,0xaf642da8aa1f8000,0xae2f2fd9afa82da8,0x2f0eac7222462a1f,0x2fd9af642c720000,0xaea72a1f263eada8,0xafa82c722246ada8,0x2e2fa63eab8b2f64
.quad 0x2da80000ada83000,0xada880002da8b000,0xa8a5ac722ff6ada8,0x2d13263eaf0e2f64,0xa63e2f64aea78000,0xac72aa1f2fd9ada8,0x2d13afd928a52da8,0x2b8b2c72aff62a1f
.quad 0xaf642da82a1fb000,0xaa1fada82f640000,0x2ff6a63eaf0e2da8,0x28a52ea7ae2faa1f,0xaea7aa1f2fd90000,0xa63eaf642c722da8,0x2b8b2ea7ad13ada8,0x22462fd9a8a5af64
.quad 0xb0003000b0003000,0xb0003000b0003000,0x2fa8afd92ff6b000,0x2e2faea72f0eaf64,0xaea72f64afd93000,0xa63e2a1fac722da8,0x2d13aea72fa8b000,0xab8b263e2246aa1f
.quad 0xaa1f2da8af643000,0x2f64ada82a1f0000,0x2246ac722f0eb000,0xafa82fd9ae2f2a1f,0x263e2a1faea73000,0x2c72af642fd9ada8,0xab8ba63e2e2fb000,0x22462c72afa82f64
.quad 0x2da80000ada83000,0xada880002da8b000,0xaf0e263e2d13b000,0x2ff6ac72a8a52f64,0x2fd9aa1fac723000,0xaea72f64a63eada8,0xaff62c722b8bb000,0x28a5afd92d132a1f
.quad 0x2f64ada8aa1f3000,0x2a1f2da8af648000,0xae2f2ea728a5b000,0xaf0ea63e2ff6aa1f,0x2c72af64a63e3000,0x2fd9aa1faea72da8,0xa8a52fd92246b000,0xad132ea72b8baf64
.quad 0xb0003000b0003000,0xb0003000b0003000,0x2b8bac722d13ada8,0x2246a63e28a5aa1f,0x2c72aa1f263e0000,0x2fd9af642ea7ada8,0xaff62fd9af0e2da8,0xa8a52c72ae2f2f64
.quad 0x2a1fada82f64b000,0xaf642da8aa1f8000,0x2d13a63ea8a52da8,0x2b8baea72ff6af64,0xafd92f64ac728000,0x2ea7aa1fa63e2da8,0x28a5aea72ff6ada8,0xad132fd9af0e2a1f
.quad 0x2da80000ada83000,0xada880002da8b000,0xafa82ea7a246ada8,0x2e2fafd92b8b2a1f,0x263eaf642ea70000,0x2c722a1fafd92da8,0x2e2f263eafa82da8,0xaf0e2ea72246af64
.quad 0xaf642da82a1fb000,0xaa1fada82f640000,0x2246afd92b8b2da8,0x2fa8ac72ad132f64,0x2ea72a1fafd98000,0x263e2f64ac72ada8,0xaf0e2c722e2fada8,0xaff6263e2fa8aa1f
.quad 0xb0003000b0003000,0xb0003000b0003000,0xa8a5263ea2468000,0xad132c72ab8b2a1f,0x2ea7af642fd9b000,0x263eaa1f2c72ada8,0x2e2fac7228a50000,0x2f0eafd92ff6af64
.quad 0xaa1f2da8af643000,0x2f64ada82a1f0000,0xaff62ea7ab8b8000,0x28a5263ead132f64,0xa63eaa1f2ea7b000,0xac722f64afd92da8,0x2f0eafd92d130000,0xaff62ea7a8a5aa1f
.quad 0x2da80000ada83000,0xada880002da8b000,0xab8b2fd9ae2f8000,0x2246aea72fa8aa1f,0xafd92a1f2c72b000,0x2ea7af64263e2da8,0xa246aea72f0e0000,0x2fa8a63eae2f2f64
.quad 0x2f64ada8aa1f3000,0x2a1f2da8af648000,0x2d132c72afa88000,0xab8b2fd9a246af64,0xac722f64263eb000,0xafd92a1f2ea7ada8,0xafa8a63e2ff60000,0xae2fac722f0e2a1f
.quad 0xb0003000b0003000,0xb0003000b0003000,0xaf0e2ea7ae2f2da8,0xaff62fd9afa82f64,0xac722a1fa63e8000,0xafd92f64aea72da8,0xa246a63e2b8bada8,0xafa82ea7ad132a1f
.quad 0x2a1fada82f64b000,0xaf642da8aa1f8000,0x2e2fafd92fa8ada8,0xaf0e2c72a246aa1f,0x2fd9af642c720000,0xaea72a1f263eada8,0x2fa8ac72a2462da8,0xae2f263e2b8baf64
.quad 0x2da80000ada83000,0xada880002da8b000,0x28a52c72aff62da8,0xad13a63e2f0eaf64,0xa63e2f64aea78000,0xac72aa1f2fd9ada8,0xad132fd9a8a5ada8,0xab8bac722ff6aa1f
.quad 0xaf642da82a1fb000,0xaa1fada82f640000,0xaff6263e2f0eada8,0xa8a5aea72e2f2a1f,0xaea7aa1f2fd90000,0xa63eaf642c722da8,0xab8baea72d132da8,0xa246afd928a52f64
.quad 0x8000800080008000,0x8000800080008000,0x28a5a63e22468000,0x2d13ac722b8baa1f,0x2c72aa1f263e8000,0x2fd9af642ea7ada8,0x2e2fac7228a58000,0x2f0eafd92ff6af64
.quad 0x2f64ada82a1f8000,0x2a1fada82f64b000,0x2ff6aea72b8b8000,0xa8a5a63e2d13af64,0x2fd9af642c728000,0xaea72a1f263eada8,0x2f0eafd92d138000,0xaff62ea7a8a5aa1f
.quad 0x2da8b0002da88000,0xada83000ada88000,0x2b8bafd92e2f8000,0xa2462ea7afa82a1f,0x263eaf642ea78000,0x2c722a1fafd92da8,0xa246aea72f0e8000,0x2fa8a63eae2f2f64
.quad 0xaa1fada82f648000,0x2f64ada8aa1f3000,0xad13ac722fa88000,0x2b8bafd922462f64,0xaea7aa1f2fd98000,0xa63eaf642c722da8,0xafa8a63e2ff68000,0xae2fac722f0e2a1f
.quad 0x8000800080008000,0x8000800080008000,0x2f0eaea72e2fada8,0x2ff6afd92fa8af64,0x2ea7af642fd9b000,0x263eaa1f2c72ada8,0xa246a63e2b8bada8,0xafa82ea7ad132a1f
.quad 0xaf642da8aa1f8000,0xaa1f2da8af643000,0xae2f2fd9afa82da8,0x2f0eac7222462a1f,0x263e2a1faea73000,0x2c72af642fd9ada8,0x2fa8ac72a2462da8,0xae2f263e2b8baf64
.quad 0x2da8b0002da88000,0xada83000ada88000,0xa8a5ac722ff6ada8,0x2d13263eaf0e2f64,0xafd92a1f2c72b000,0x2ea7af64263e2da8,0xad132fd9a8a5ada8,0xab8bac722ff6aa1f
.quad 0x2a1f2da8af648000,0xaf642da82a1fb000,0x2ff6a63eaf0e2da8,0x28a52ea7ae2faa1f,0x2c72af64a63e3000,0x2fd9aa1faea72da8,0xab8baea72d132da8,0xa246afd928a52f64
.quad 0x8000800080008000,0x8000800080008000,0x2fa8afd92ff6b000,0x2e2faea72f0eaf64,0xac722a1fa63e8000,0xafd92f64aea72da8,0xad132ea7afa83000,0x2b8ba63ea2462a1f
.quad 0x2f64ada82a1f8000,0x2a1fada82f64b000,0x2246ac722f0eb000,0xafa82fd9ae2f2a1f,0xafd92f64ac728000,0x2ea7aa1fa63e2da8,0x2b8b263eae2f3000,0xa246ac722fa8af64
.quad 0x2da8b0002da88000,0xada83000ada88000,0xaf0e263e2d13b000,0x2ff6ac72a8a52f64,0xa63e2f64aea78000,0xac72aa1f2fd9ada8,0x2ff6ac72ab8b3000,0xa8a52fd9ad13aa1f
.quad 0xaa1fada82f648000,0x2f64ada8aa1f3000,0xae2f2ea728a5b000,0xaf0ea63e2ff6aa1f,0x2ea72a1fafd98000,0x263e2f64ac72ada8,0x28a5afd9a2463000,0x2d13aea7ab8b2f64
.quad 0x8000800080008000,0x8000800080008000,0x2b8bac722d13ada8,0x2246a63e28a5aa1f,0xaea72f64afd93000,0xa63e2a1fac722da8,0x2ff6afd92f0eada8,0x28a5ac722e2faf64
.quad 0xaf642da8aa1f8000,0xaa1f2da8af643000,0x2d13a63ea8a52da8,0x2b8baea72ff6af64,0xa63eaa1f2ea7b000,0xac722f64afd92da8,0xa8a52ea7aff62da8,0x2d13afd92f0eaa1f
.quad 0x2da8b0002da88000,0xada83000ada88000,0xafa82ea7a246ada8,0x2e2fafd92b8b2a1f,0x2fd9aa1fac723000,0xaea72f64a63eada8,0xae2fa63e2fa8ada8,0x2f0eaea7a2462f64
.quad 0x2a1f2da8af648000,0xaf642da82a1fb000,0x2246afd92b8b2da8,0x2fa8ac72ad132f64,0xac722f64263eb000,0xafd92a1f2ea7ada8,0x2f0eac72ae2f2da8,0x2ff6a63eafa82a1f
.quad 0x8000800080008000,0x8000800080008000,0xa8a5263ea2468000,0xad132c72ab8b2a1f,0x2c72aa1f263e8000,0x2fd9af642ea7ada8,0xae2f2c72a8a58000,0xaf0e2fd9aff62f64
.quad 0x2f64ada82a1f8000,0x2a1fada82f64b000,0xaff62ea7ab8b8000,0x28a5263ead132f64,0x2fd9af642c728000,0xaea72a1f263eada8,0xaf0e2fd9ad138000,0x2ff6aea728a52a1f
.quad 0x2da8b0002da88000,0xada83000ada88000,0xab8b2fd9ae2f8000,0x2246aea72fa8aa1f,0x263eaf642ea78000,0x2c722a1fafd92da8,0x22462ea7af0e8000,0xafa8263e2e2faf64
.quad 0xaa1fada82f648000,0x2f64ada8aa1f3000,0x2d132c72afa88000,0xab8b2fd9a246af64,0xaea7aa1f2fd98000,0xa63eaf642c722da8,0x2fa8263eaff68000,0x2e2f2c72af0eaa1f
.quad 0x8000800080008000,0x8000800080008000,0xaf0e2ea7ae2f2da8,0xaff62fd9afa82f64,0x2ea7af642fd9b000,0x263eaa1f2c72ada8,0x2246263eab8b2da8,0x2fa8aea72d13aa1f
.quad 0xaf642da8aa1f8000,0xaa1f2da8af643000,0x2e2fafd92fa8ada8,0xaf0e2c72a246aa1f,0x263e2a1faea73000,0x2c72af642fd9ada8,0xafa82c722246ada8,0x2e2fa63eab8b2f64
.quad 0x2da8b0002da88000,0xada83000ada88000,0x28a52c72aff62da8,0xad13a63e2f0eaf64,0xafd92a1f2c72b000,0x2ea7af64263e2da8,0x2d13afd928a52da8,0x2b8b2c72aff62a1f
.quad 0x2a1f2da8af648000,0xaf642da82a1fb000,0xaff6263e2f0eada8,0xa8a5aea72e2f2a1f,0x2c72af64a63e3000,0x2fd9aa1faea72da8,0x2b8b2ea7ad13ada8,0x22462fd9a8a5af64
.quad 0x8000800080008000,0x8000800080008000,0xafa82fd9aff63000,0xae2f2ea7af0e2f64,0xac722a1fa63e8000,0xafd92f64aea72da8,0x2d13aea72fa8b000,0xab8b263e2246aa1f
.quad 0x2f64ada82a1f8000,0x2a1fada82f64b000,0xa2462c72af0e3000,0x2fa8afd92e2faa1f,0xafd92f64ac728000,0x2ea7aa1fa63e2da8,0xab8ba63e2e2fb000,0x22462c72afa82f64
.quad 0x2da8b0002da88000,0xada83000ada88000,0x2f0ea63ead133000,0xaff62c7228a5af64,0xa63e2f64aea78000,0xac72aa1f2fd9ada8,0xaff62c722b8bb000,0x28a5afd92d132a1f
.quad 0xaa1fada82f648000,0x2f64ada8aa1f3000,0x2e2faea7a8a53000,0x2f0e263eaff62a1f,0x2ea72a1fafd98000,0x263e2f64ac72ada8,0xa8a52fd92246b000,0xad132ea72b8baf64
.quad 0x8000800080008000,0x8000800080008000,0xab8b2c72ad132da8,0xa246263ea8a52a1f,0xaea72f64afd93000,0xa63e2a1fac722da8,0xaff62fd9af0e2da8,0xa8a52c72ae2f2f64
.quad 0xaf642da8aa1f8000,0xaa1f2da8af643000,0xad13263e28a5ada8,0xab8b2ea7aff62f64,0xa63eaa1f2ea7b000,0xac722f64afd92da8,0x28a5aea72ff6ada8,0xad132fd9af0e2a1f
.quad 0x2da8b0002da88000,0xada83000ada88000,0x2fa8aea722462da8,0xae2f2fd9ab8baa1f,0x2fd9aa1fac723000,0xaea72f64a63eada8,0x2e2f263eafa82da8,0xaf0e2ea72246af64
.quad 0x2a1f2da8af648000,0xaf642da82a1fb000,0xa2462fd9ab8bada8,0xafa82c722d13af64,0xac722f64263eb000,0xafd92a1f2ea7ada8,0xaf0e2c722e2fada8,0xaff6263e2fa8aa1f
.quad 0xb00080003000,0xb00080003000,0xa8a5afd922463000,0xad13aea72b8b2f64,0xac72af64263e3000,0xafd9aa1f2ea72da8,0xae2faea728a53000,0xaf0e263e2ff62a1f
.quad 0xaf64ada82a1f3000,0xaa1f2da82f640000,0xaff6ac722b8b3000,0x28a52fd92d13aa1f,0xafd9aa1f2c723000,0x2ea72f64263eada8,0xaf0ea63e2d133000,0x2ff62c72a8a5af64
.quad 0xada880002da83000,0x2da80000ada8b000,0xab8b263e2e2f3000,0x2246ac72afa8af64,0xa63e2a1f2ea73000,0xac72af64afd9ada8,0x22462c722f0e3000,0xafa8afd9ae2faa1f
.quad 0x2a1f2da82f643000,0xaf64ada8aa1f8000,0x2d132ea72fa83000,0xab8ba63e22462a1f,0x2ea72f642fd93000,0x263e2a1f2c722da8,0x2fa82fd92ff63000,0x2e2f2ea72f0e2f64
.quad 0xb00080003000,0xb00080003000,0xaf0eac722e2f2da8,0xaff6a63e2fa82a1f,0xaea72a1f2fd90000,0xa63e2f642c72ada8,0x22462fd92b8bada8,0x2fa82c72ad13af64
.quad 0x2f642da8aa1fb000,0x2a1fada8af648000,0x2e2fa63eafa8ada8,0xaf0eaea722462f64,0xa63eaf64aea78000,0xac722a1f2fd92da8,0xafa8aea7a2462da8,0x2e2f2fd92b8baa1f
.quad 0xada880002da83000,0x2da80000ada8b000,0x28a52ea72ff62da8,0xad13afd9af0eaa1f,0x2fd92f642c720000,0xaea7aa1f263e2da8,0x2d13263ea8a5ada8,0x2b8b2ea72ff62f64
.quad 0xaa1fada8af64b000,0x2f642da82a1f0000,0xaff6afd9af0eada8,0xa8a5ac72ae2faf64,0xac72aa1fa63e8000,0xafd9af64aea7ada8,0x2b8b2c722d132da8,0x2246263e28a52a1f
.quad 0xb00080003000,0xb00080003000,0xafa8263e2ff60000,0xae2f2c722f0eaa1f,0x2c722f64a63eb000,0x2fd92a1faea7ada8,0x2d13ac72afa88000,0xab8bafd9a2462f64
.quad 0xaf64ada82a1f3000,0xaa1f2da82f640000,0xa2462ea72f0e0000,0x2fa8263eae2faf64,0x2fd92a1fac72b000,0xaea7af64a63e2da8,0xab8bafd9ae2f8000,0x22462ea72fa82a1f
.quad 0xada880002da83000,0x2da80000ada8b000,0x2f0e2fd92d130000,0xaff6aea7a8a52a1f,0x263eaa1faea7b000,0x2c722f642fd92da8,0xaff6aea7ab8b8000,0x28a5a63ead13af64
.quad 0x2a1f2da82f643000,0xaf64ada8aa1f8000,0x2e2f2c7228a50000,0x2f0e2fd92ff62f64,0xaea7af64afd9b000,0xa63eaa1fac72ada8,0xa8a5a63ea2468000,0xad13ac72ab8baa1f
.quad 0xb00080003000,0xb00080003000,0xab8b2ea72d13ada8,0xa2462fd928a5af64,0x2ea7aa1fafd98000,0x263eaf64ac722da8,0xaff6a63e2f0e2da8,0xa8a52ea72e2faa1f
.quad 0x2f642da8aa1fb000,0x2a1fada8af648000,0xad13afd9a8a52da8,0xab8b2c722ff62a1f,0x263e2f642ea70000,0x2c72aa1fafd9ada8,0x28a5ac72aff6ada8,0xad13263e2f0e2f64
.quad 0xada880002da83000,0x2da80000ada8b000,0x2fa82c72a246ada8,0xae2fa63e2b8b2f64,0xafd9af64ac728000,0x2ea72a1fa63eada8,0x2e2f2fd92fa82da8,0xaf0eac72a2462a1f
.quad 0xaa1fada8af64b000,0x2f642da82a1f0000,0xa246263e2b8b2da8,0xafa8aea7ad13aa1f,0x2c722a1f263e0000,0x2fd92f642ea72da8,0xaf0eaea7ae2fada8,0xaff6afd9afa8af64
.quad 0xb00080003000,0xb00080003000,0x28a52fd9a246b000,0x2d132ea7ab8baf64,0xac72af64263e3000,0xafd9aa1f2ea72da8,0x2e2f2ea7a8a5b000,0x2f0ea63eaff6aa1f
.quad 0xaf64ada82a1f3000,0xaa1f2da82f640000,0x2ff62c72ab8bb000,0xa8a5afd9ad132a1f,0xafd9aa1f2c723000,0x2ea72f64263eada8,0x2f0e263ead13b000,0xaff6ac7228a52f64
.quad 0xada880002da83000,0x2da80000ada8b000,0x2b8ba63eae2fb000,0xa2462c722fa82f64,0xa63e2a1f2ea73000,0xac72af64afd9ada8,0xa246ac72af0eb000,0x2fa82fd92e2f2a1f
.quad 0x2a1f2da82f643000,0xaf64ada8aa1f8000,0xad13aea7afa8b000,0x2b8b263ea246aa1f,0x2ea72f642fd93000,0x263e2a1f2c722da8,0xafa8afd9aff6b000,0xae2faea7af0eaf64
.quad 0xb00080003000,0xb00080003000,0x2f0e2c72ae2fada8,0x2ff6263eafa8aa1f,0xaea72a1f2fd90000,0xa63e2f642c72ada8,0xa246afd9ab8b2da8,0xafa8ac722d132f64
.quad 0x2f642da8aa1fb000,0x2a1fada8af648000,0xae2f263e2fa82da8,0x2f0e2ea7a246af64,0xa63eaf64aea78000,0xac722a1f2fd92da8,0x2fa82ea72246ada8,0xae2fafd9ab8b2a1f
.quad 0xada880002da83000,0x2da80000ada8b000,0xa8a5aea7aff6ada8,0x2d132fd92f0e2a1f,0x2fd92f642c720000,0xaea7aa1f263e2da8,0xad13a63e28a52da8,0xab8baea7aff6af64
.quad 0xaa1fada8af64b000,0x2f642da82a1f0000,0x2ff62fd92f0e2da8,0x28a52c722e2f2f64,0xac72aa1fa63e8000,0xafd9af64aea7ada8,0xab8bac72ad13ada8,0xa246a63ea8a5aa1f
.quad 0xb00080003000,0xb00080003000,0x2fa8a63eaff68000,0x2e2fac72af0e2a1f,0x2c722f64a63eb000,0x2fd92a1faea7ada8,0xad132c722fa80000,0x2b8b2fd92246af64
.quad 0xaf64ada82a1f3000,0xaa1f2da82f640000,0x2246aea7af0e8000,0xafa8a63e2e2f2f64,0x2fd92a1fac72b000,0xaea7af64a63e2da8,0x2b8b2fd92e2f0000,0xa246aea7afa8aa1f
.quad 0xada880002da83000,0x2da80000ada8b000,0xaf0eafd9ad138000,0x2ff62ea728a5aa1f,0x263eaa1faea7b000,0x2c722f642fd92da8,0x2ff62ea72b8b0000,0xa8a5263e2d132f64
.quad 0x2a1f2da82f643000,0xaf64ada8aa1f8000,0xae2fac72a8a58000,0xaf0eafd9aff6af64,0xaea7af64afd9b000,0xa63eaa1fac72ada8,0x28a5263e22460000,0x2d132c722b8b2a1f
.quad 0xb00080003000,0xb00080003000,0x2b8baea7ad132da8,0x2246afd9a8a52f64,0x2ea7aa1fafd98000,0x263eaf64ac722da8,0x2ff6263eaf0eada8,0x28a5aea7ae2f2a1f
.quad 0x2f642da8aa1fb000,0x2a1fada8af648000,0x2d132fd928a5ada8,0x2b8bac72aff6aa1f,0x263e2f642ea70000,0x2c72aa1fafd9ada8,0xa8a52c722ff62da8,0x2d13a63eaf0eaf64
.quad 0xada880002da83000,0x2da80000ada8b000,0xafa8ac7222462da8,0x2e2f263eab8baf64,0xafd9af64ac728000,0x2ea72a1fa63eada8,0xae2fafd9afa8ada8,0x2f0e2c722246aa1f
.quad 0xaa1fada8af64b000,0x2f642da82a1f0000,0x2246a63eab8bada8,0x2fa82ea72d132a1f,0x2c722a1f263e0000,0x2fd92f642ea72da8,0x2f0e2ea72e2f2da8,0x2ff62fd92fa82f64
.quad 0xb000800030008000,0xb000800030008000,0xafa8263e2ff68000,0xae2f2c722f0eaa1f,0xaea72a1f2fd98000,0xa63e2f642c72ada8,0xad132c722fa88000,0x2b8b2fd92246af64
.quad 0xaa1f2da82f648000,0x2f642da8aa1fb000,0xa2462ea72f0e8000,0x2fa8263eae2faf64,0x263e2f642ea78000,0x2c72aa1fafd9ada8,0x2b8b2fd92e2f8000,0xa246aea7afa8aa1f
.quad 0x2da830002da88000,0xada8b000ada88000,0x2f0e2fd92d138000,0xaff6aea7a8a52a1f,0x2fd92f642c728000,0xaea7aa1f263e2da8,0x2ff62ea72b8b8000,0xa8a5263e2d132f64
.quad 0x2f642da82a1f8000,0x2a1f2da82f643000,0x2e2f2c7228a58000,0x2f0e2fd92ff62f64,0x2c722a1f263e8000,0x2fd92f642ea72da8,0x28a5263e22468000,0x2d132c722b8b2a1f
.quad 0xb000800030008000,0xb000800030008000,0xab8b2ea72d13ada8,0xa2462fd928a5af64,0x2c722f64a63eb000,0x2fd92a1faea7ada8,0x2ff6263eaf0eada8,0x28a5aea7ae2f2a1f
.quad 0x2a1fada8af648000,0xaf64ada82a1f3000,0xad13afd9a8a52da8,0xab8b2c722ff62a1f,0xafd9aa1f2c723000,0x2ea72f64263eada8,0xa8a52c722ff62da8,0x2d13a63eaf0eaf64
.quad 0x2da830002da88000,0xada8b000ada88000,0x2fa82c72a246ada8,0xae2fa63e2b8b2f64,0x263eaa1faea7b000,0x2c722f642fd92da8,0xae2fafd9afa8ada8,0x2f0e2c722246aa1f
.quad 0xaf64ada8aa1f8000,0xaa1fada8af64b000,0xa246263e2b8b2da8,0xafa8aea7ad13aa1f,0x2ea72f642fd93000,0x263e2a1f2c722da8,0x2f0e2ea72e2f2da8,0x2ff62fd92fa82f64
.quad 0xb000800030008000,0xb000800030008000,0x28a52fd9a246b000,0x2d132ea7ab8baf64,0x2ea7aa1fafd98000,0x263eaf64ac722da8,0xae2faea728a53000,0xaf0e263e2ff62a1f
.quad 0xaa1f2da82f648000,0x2f642da8aa1fb000,0x2ff62c72ab8bb000,0xa8a5afd9ad132a1f,0xa63eaf64aea78000,0xac722a1f2fd92da8,0xaf0ea63e2d133000,0x2ff62c72a8a5af64
.quad 0x2da830002da88000,0xada8b000ada88000,0x2b8ba63eae2fb000,0xa2462c722fa82f64,0xafd9af64ac728000,0x2ea72a1fa63eada8,0x22462c722f0e3000,0xafa8afd9ae2faa1f
.quad 0x2f642da82a1f8000,0x2a1f2da82f643000,0xad13aea7afa8b000,0x2b8b263ea246aa1f,0xac72aa1fa63e8000,0xafd9af64aea7ada8,0x2fa82fd92ff63000,0x2e2f2ea72f0e2f64
.quad 0xb000800030008000,0xb000800030008000,0x2f0e2c72ae2fada8,0x2ff6263eafa8aa1f,0xac72af64263e3000,0xafd9aa1f2ea72da8,0x22462fd92b8bada8,0x2fa82c72ad13af64
.quad 0x2a1fada8af648000,0xaf64ada82a1f3000,0xae2f263e2fa82da8,0x2f0e2ea7a246af64,0x2fd92a1fac72b000,0xaea7af64a63e2da8,0xafa8aea7a2462da8,0x2e2f2fd92b8baa1f
.quad 0x2da830002da88000,0xada8b000ada88000,0xa8a5aea7aff6ada8,0x2d132fd92f0e2a1f,0xa63e2a1f2ea73000,0xac72af64afd9ada8,0x2d13263ea8a5ada8,0x2b8b2ea72ff62f64
.quad 0xaf64ada8aa1f8000,0xaa1fada8af64b000,0x2ff62fd92f0e2da8,0x28a52c722e2f2f64,0xaea7af64afd9b000,0xa63eaa1fac72ada8,0x2b8b2c722d132da8,0x2246263e28a52a1f
.quad 0xb000800030008000,0xb000800030008000,0x2fa8a63eaff68000,0x2e2fac72af0e2a1f,0xaea72a1f2fd98000,0xa63e2f642c72ada8,0x2d13ac72afa88000,0xab8bafd9a2462f64
.quad 0xaa1f2da82f648000,0x2f642da8aa1fb000,0x2246aea7af0e8000,0xafa8a63e2e2f2f64,0x263e2f642ea78000,0x2c72aa1fafd9ada8,0xab8bafd9ae2f8000,0x22462ea72fa82a1f
.quad 0x2da830002da88000,0xada8b000ada88000,0xaf0eafd9ad138000,0x2ff62ea728a5aa1f,0x2fd92f642c728000,0xaea7aa1f263e2da8,0xaff6aea7ab8b8000,0x28a5a63ead13af64
.quad 0x2f642da82a1f8000,0x2a1f2da82f643000,0xae2fac72a8a58000,0xaf0eafd9aff6af64,0x2c722a1f263e8000,0x2fd92f642ea72da8,0xa8a5a63ea2468000,0xad13ac72ab8baa1f
.quad 0xb000800030008000,0xb000800030008000,0x2b8baea7ad132da8,0x2246afd9a8a52f64,0x2c722f64a63eb000,0x2fd92a1faea7ada8,0xaff6a63e2f0e2da8,0xa8a52ea72e2faa1f
.quad 0x2a1fada8af648000,0xaf64ada82a1f3000,0x2d132fd928a5ada8,0x2b8bac72aff6aa1f,0xafd9aa1f2c723000,0x2ea72f64263eada8,0x28a5ac72aff6ada8,0xad13263e2f0e2f64
.quad 0x2da830002da88000,0xada8b000ada88000,0xafa8ac7222462da8,0x2e2f263eab8baf64,0x263eaa1faea7b000,0x2c722f642fd92da8,0x2e2f2fd92fa82da8,0xaf0eac72a2462a1f
.quad 0xaf64ada8aa1f8000,0xaa1fada8af64b000,0x2246a63eab8bada8,0x2fa82ea72d132a1f,0x2ea72f642fd93000,0x263e2a1f2c722da8,0xaf0eaea7ae2fada8,0xaff6afd9afa8af64
.quad 0xb000800030008000,0xb000800030008000,0xa8a5afd922463000,0xad13aea72b8b2f64,0x2ea7aa1fafd98000,0x263eaf64ac722da8,0x2e2f2ea7a8a5b000,0x2f0ea63eaff6aa1f
.quad 0xaa1f2da82f648000,0x2f642da8aa1fb000,0xaff6ac722b8b3000,0x28a52fd92d13aa1f,0xa63eaf64aea78000,0xac722a1f2fd92da8,0x2f0e263ead13b000,0xaff6ac7228a52f64
.quad 0x2da830002da88000,0xada8b000ada88000,0xab8b263e2e2f3000,0x2246ac72afa8af64,0xafd9af64ac728000,0x2ea72a1fa63eada8,0xa246ac72af0eb000,0x2fa82fd92e2f2a1f
.quad 0x2f642da82a1f8000,0x2a1f2da82f643000,0x2d132ea72fa83000,0xab8ba63e22462a1f,0xac72aa1fa63e8000,0xafd9af64aea7ada8,0xafa8afd9aff6b000,0xae2faea7af0eaf64
.quad 0xb000800030008000,0xb000800030008000,0xaf0eac722e2f2da8,0xaff6a63e2fa82a1f,0xac72af64263e3000,0xafd9aa1f2ea72da8,0xa246afd9ab8b2da8,0xafa8ac722d132f64
.quad 0x2a1fada8af648000,0xaf64ada82a1f3000,0x2e2fa63eafa8ada8,0xaf0eaea722462f64,0x2fd92a1fac72b000,0xaea7af64a63e2da8,0x2fa82ea72246ada8,0xae2fafd9ab8b2a1f
.quad 0x2da830002da88000,0xada8b000ada88000,0x28a52ea72ff62da8,0xad13afd9af0eaa1f,0xa63e2a1f2ea73000,0xac72af64afd9ada8,0xad13a63e28a52da8,0xab8baea7aff6af64
.quad 0xaf64ada8aa1f8000,0xaa1fada8af64b000,0xaff6afd9af0eada8,0xa8a5ac72ae2faf64,0xaea7af64afd9b000,0xa63eaa1fac72ada8,0xab8bac72ad13ada8,0xa246a63ea8a5aa1f
.quad 0x3e003e003e003e00,0x3e003e003e003e00,0x3df53dfb3dff3e00,0x3dc63dd53de23ded,0x3dd53ded3dfb3e00,0x3cc83d443d8e3db5,0x3da23dd53df53e00,0xbd71bcc83c493d44
.quad 0x3d443db53ded3e00,0xbdedbdb5bd44230d,0x3c493d8e3de23e00,0xbdf5bdfbbdc6bd44,0xbcc83d443dd53e00,0xbd8ebdedbdfbbdb5,0xbd713cc83dc63e00,0x3c49bd8ebdf5bded
.quad 0xbdb5230d3db53e00,0x3db5a3d4bdb5be00,0xbde2bcc83da23e00,0x3dff3d8ebd15bded,0xbdfbbd443d8e3e00,0x3dd53ded3cc8bdb5,0xbdffbd8e3d713e00,0x3d153dfb3da2bd44
.quad 0xbdedbdb53d443e00,0xbd443db53deda3d4,0xbdc6bdd53d153e00,0xbde23cc83dff3d44,0xbd8ebded3cc83e00,0xbdfbbd443dd53db5,0xbd15bdfb3c493e00,0xbda2bdd53d713ded
.quad 0x3e003e003e003e00,0x3e003e003e003e00,0x3d713d8e3da23db5,0x3c493cc83d153d44,0xbd8ebd44bcc8230d,0xbdfbbdedbdd5bdb5,0xbdffbdfbbde2bdb5,0xbd15bd8ebdc6bded
.quad 0xbd44bdb5bdedbe00,0x3ded3db53d44a3d4,0x3da23cc8bd15bdb5,0x3d713dd53dff3ded,0x3dfb3ded3d8ea3d4,0xbdd5bd443cc83db5,0x3d153dd53dff3db5,0xbda2bdfbbde2bd44
.quad 0xbdb5230d3db53e00,0x3db5a3d4bdb5be00,0xbdf5bdd5bc493db5,0x3dc63dfb3d71bd44,0xbcc8bdedbdd5230d,0xbd8e3d443dfb3db5,0x3dc6bcc8bdf5bdb5,0xbde2bdd53c493ded
.quad 0x3ded3db5bd44be00,0x3d44bdb5bded230d,0x3c493dfb3d71bdb5,0x3df53d8ebda2bded,0xbdd53d443dfba3d4,0xbcc83ded3d8ebdb5,0xbde2bd8e3dc63db5,0xbdffbcc83df53d44
.quad 0x3e003e003e003e00,0x3e003e003e003e00,0xbd15bcc8bc49230d,0xbda2bd8ebd71bd44,0xbdd5bdedbdfbbe00,0xbcc8bd44bd8ebdb5,0x3dc63d8e3d15a3d4,0x3de23dfb3dff3ded
.quad 0x3d443db53ded3e00,0xbdedbdb5bd44230d,0xbdffbdd5bd71230d,0x3d15bcc8bda2bded,0x3cc8bd44bdd5be00,0x3d8e3ded3dfb3db5,0x3de23dfb3da2a3d4,0xbdffbdd5bd153d44
.quad 0xbdb5230d3db53e00,0x3db5a3d4bdb5be00,0xbd71bdfbbdc6230d,0x3c493dd53df53d44,0x3dfb3d44bd8ebe00,0xbdd5bdedbcc83db5,0xbc493dd53de2a3d4,0x3df53cc8bdc6bded
.quad 0xbdedbdb53d443e00,0xbd443db53deda3d4,0x3da2bd8ebdf5230d,0xbd71bdfbbc493ded,0x3d8e3dedbcc8be00,0x3dfb3d44bdd5bdb5,0xbdf53cc83dffa3d4,0xbdc63d8e3de2bd44
.quad 0x3e003e003e003e00,0x3e003e003e003e00,0xbde2bdd5bdc6bdb5,0xbdffbdfbbdf5bded,0x3d8e3d443cc8a3d4,0x3dfb3ded3dd53db5,0xbc493cc83d713db5,0xbdf5bdd5bda2bd44
.quad 0xbd44bdb5bdedbe00,0x3ded3db53d44a3d4,0x3dc63dfb3df53db5,0xbde2bd8ebc493d44,0xbdfbbdedbd8e230d,0x3dd53d44bcc8bdb5,0x3df53d8ebc49bdb5,0xbdc6bcc83d713ded
.quad 0xbdb5230d3db53e00,0x3db5a3d4bdb5be00,0x3d15bd8ebdffbdb5,0xbda23cc83de23ded,0x3cc83ded3dd5a3d4,0x3d8ebd44bdfbbdb5,0xbda2bdfbbd153db5,0xbd713d8e3dff3d44
.quad 0x3ded3db5bd44be00,0x3d44bdb5bded230d,0xbdffbcc83de23db5,0xbd153dd53dc6bd44,0x3dd5bd44bdfb230d,0x3cc8bdedbd8e3db5,0xbd713dd53da2bdb5,0xbc493dfb3d15bded
.quad 0x3e003e003e003e00,0x3e003e003e003e00,0xbdf5bdfbbdffbe00,0xbdc6bdd5bde2bded,0x3dd53ded3dfb3e00,0x3cc83d443d8e3db5,0xbda2bdd5bdf5be00,0x3d713cc8bc49bd44
.quad 0x3d443db53ded3e00,0xbdedbdb5bd44230d,0xbc49bd8ebde2be00,0x3df53dfb3dc63d44,0xbcc83d443dd53e00,0xbd8ebdedbdfbbdb5,0x3d71bcc8bdc6be00,0xbc493d8e3df53ded
.quad 0xbdb5230d3db53e00,0x3db5a3d4bdb5be00,0x3de23cc8bda2be00,0xbdffbd8e3d153ded,0xbdfbbd443d8e3e00,0x3dd53ded3cc8bdb5,0x3dff3d8ebd71be00,0xbd15bdfbbda23d44
.quad 0xbdedbdb53d443e00,0xbd443db53deda3d4,0x3dc63dd5bd15be00,0x3de2bcc8bdffbd44,0xbd8ebded3cc83e00,0xbdfbbd443dd53db5,0x3d153dfbbc49be00,0x3da23dd5bd71bded
.quad 0x3e003e003e003e00,0x3e003e003e003e00,0xbd71bd8ebda2bdb5,0xbc49bcc8bd15bd44,0xbd8ebd44bcc8230d,0xbdfbbdedbdd5bdb5,0x3dff3dfb3de23db5,0x3d153d8e3dc63ded
.quad 0xbd44bdb5bdedbe00,0x3ded3db53d44a3d4,0xbda2bcc83d153db5,0xbd71bdd5bdffbded,0x3dfb3ded3d8ea3d4,0xbdd5bd443cc83db5,0xbd15bdd5bdffbdb5,0x3da23dfb3de23d44
.quad 0xbdb5230d3db53e00,0x3db5a3d4bdb5be00,0x3df53dd53c49bdb5,0xbdc6bdfbbd713d44,0xbcc8bdedbdd5230d,0xbd8e3d443dfb3db5,0xbdc63cc83df53db5,0x3de23dd5bc49bded
.quad 0x3ded3db5bd44be00,0x3d44bdb5bded230d,0xbc49bdfbbd713db5,0xbdf5bd8e3da23ded,0xbdd53d443dfba3d4,0xbcc83ded3d8ebdb5,0x3de23d8ebdc6bdb5,0x3dff3cc8bdf5bd44
.quad 0x3e003e003e003e00,0x3e003e003e003e00,0x3d153cc83c49a3d4,0x3da23d8e3d713d44,0xbdd5bdedbdfbbe00,0xbcc8bd44bd8ebdb5,0xbdc6bd8ebd15230d,0xbde2bdfbbdffbded
.quad 0x3d443db53ded3e00,0xbdedbdb5bd44230d,0x3dff3dd53d71a3d4,0xbd153cc83da23ded,0x3cc8bd44bdd5be00,0x3d8e3ded3dfb3db5,0xbde2bdfbbda2230d,0x3dff3dd53d15bd44
.quad 0xbdb5230d3db53e00,0x3db5a3d4bdb5be00,0x3d713dfb3dc6a3d4,0xbc49bdd5bdf5bd44,0x3dfb3d44bd8ebe00,0xbdd5bdedbcc83db5,0x3c49bdd5bde2230d,0xbdf5bcc83dc63ded
.quad 0xbdedbdb53d443e00,0xbd443db53deda3d4,0xbda23d8e3df5a3d4,0x3d713dfb3c49bded,0x3d8e3dedbcc8be00,0x3dfb3d44bdd5bdb5,0x3df5bcc8bdff230d,0x3dc6bd8ebde23d44
.quad 0x3e003e003e003e00,0x3e003e003e003e00,0x3de23dd53dc63db5,0x3dff3dfb3df53ded,0x3d8e3d443cc8a3d4,0x3dfb3ded3dd53db5,0x3c49bcc8bd71bdb5,0x3df53dd53da23d44
.quad 0xbd44bdb5bdedbe00,0x3ded3db53d44a3d4,0xbdc6bdfbbdf5bdb5,0x3de23d8e3c49bd44,0xbdfbbdedbd8e230d,0x3dd53d44bcc8bdb5,0xbdf5bd8e3c493db5,0x3dc63cc8bd71bded
.quad 0xbdb5230d3db53e00,0x3db5a3d4bdb5be00,0xbd153d8e3dff3db5,0x3da2bcc8bde2bded,0x3cc83ded3dd5a3d4,0x3d8ebd44bdfbbdb5,0x3da23dfb3d15bdb5,0x3d71bd8ebdffbd44
.quad 0x3ded3db5bd44be00,0x3d44bdb5bded230d,0x3dff3cc8bde2bdb5,0x3d15bdd5bdc63d44,0x3dd5bd44bdfb230d,0x3cc8bdedbd8e3db5,0x3d71bdd5bda23db5,0x3c49bdfbbd153ded
.quad 0x0,0x0,0x3d153cc83c490000,0x3da23d8e3d713d44,0x3d8e3d443cc80000,0x3dfb3ded3dd53db5,0x3dc63d8e3d150000,0x3de23dfb3dff3ded
.quad 0x3ded3db53d440000,0x3d443db53ded3e00,0x3dff3dd53d710000,0xbd153cc83da23ded,0x3dfb3ded3d8e0000,0xbdd5bd443cc83db5,0x3de23dfb3da20000,0xbdffbdd5bd153d44
.quad 0x3db53e003db50000,0xbdb5be00bdb5238d,0x3d713dfb3dc60000,0xbc49bdd5bdf5bd44,0x3cc83ded3dd50000,0x3d8ebd44bdfbbdb5,0xbc493dd53de20000,0x3df53cc8bdc6bded
.quad 0xbd443db53ded0000,0x3ded3db5bd44be00,0xbda23d8e3df50000,0x3d713dfb3c49bded,0xbdd53d443dfb0000,0xbcc83ded3d8ebdb5,0xbdf53cc83dff0000,0xbdc63d8e3de2bd44
.quad 0x0,0x0,0x3de23dd53dc63db5,0x3dff3dfb3df53ded,0x3dd53ded3dfb3e00,0x3cc83d443d8e3db5,0xbc493cc83d713db5,0xbdf5bdd5bda2bd44
.quad 0xbdedbdb5bd44238d,0xbd44bdb5bdedbe00,0xbdc6bdfbbdf5bdb5,0x3de23d8e3c49bd44,0x3cc8bd44bdd5be00,0x3d8e3ded3dfb3db5,0x3df53d8ebc49bdb5,0xbdc6bcc83d713ded
.quad 0x3db53e003db50000,0xbdb5be00bdb5238d,0xbd153d8e3dff3db5,0x3da2bcc8bde2bded,0xbdfbbd443d8e3e00,0x3dd53ded3cc8bdb5,0xbda2bdfbbd153db5,0xbd713d8e3dff3d44
.quad 0x3d44bdb5bded238d,0xbdedbdb53d443e00,0x3dff3cc8bde2bdb5,0x3d15bdd5bdc63d44,0x3d8e3dedbcc8be00,0x3dfb3d44bdd5bdb5,0xbd713dd53da2bdb5,0xbc493dfb3d15bded
.quad 0x0,0x0,0x3df53dfb3dff3e00,0x3dc63dd53de23ded,0xbd8ebd44bcc8238d,0xbdfbbdedbdd5bdb5,0xbda2bdd5bdf5be00,0x3d713cc8bc49bd44
.quad 0x3ded3db53d440000,0x3d443db53ded3e00,0x3c493d8e3de23e00,0xbdf5bdfbbdc6bd44,0xbdfbbdedbd8e238d,0x3dd53d44bcc8bdb5,0x3d71bcc8bdc6be00,0xbc493d8e3df53ded
.quad 0x3db53e003db50000,0xbdb5be00bdb5238d,0xbde2bcc83da23e00,0x3dff3d8ebd15bded,0xbcc8bdedbdd5238d,0xbd8e3d443dfb3db5,0x3dff3d8ebd71be00,0xbd15bdfbbda23d44
.quad 0xbd443db53ded0000,0x3ded3db5bd44be00,0xbdc6bdd53d153e00,0xbde23cc83dff3d44,0x3dd5bd44bdfb238d,0x3cc8bdedbd8e3db5,0x3d153dfbbc49be00,0x3da23dd5bd71bded
.quad 0x0,0x0,0x3d713d8e3da23db5,0x3c493cc83d153d44,0xbdd5bdedbdfbbe00,0xbcc8bd44bd8ebdb5,0x3dff3dfb3de23db5,0x3d153d8e3dc63ded
.quad 0xbdedbdb5bd44238d,0xbd44bdb5bdedbe00,0x3da23cc8bd15bdb5,0x3d713dd53dff3ded,0xbcc83d443dd53e00,0xbd8ebdedbdfbbdb5,0xbd15bdd5bdffbdb5,0x3da23dfb3de23d44
.quad 0x3db53e003db50000,0xbdb5be00bdb5238d,0xbdf5bdd5bc493db5,0x3dc63dfb3d71bd44,0x3dfb3d44bd8ebe00,0xbdd5bdedbcc83db5,0xbdc63cc83df53db5,0x3de23dd5bc49bded
.quad 0x3d44bdb5bded238d,0xbdedbdb53d443e00,0x3c493dfb3d71bdb5,0x3df53d8ebda2bded,0xbd8ebded3cc83e00,0xbdfbbd443dd53db5,0x3de23d8ebdc6bdb5,0x3dff3cc8bdf5bd44
.quad 0x0,0x0,0xbd15bcc8bc49238d,0xbda2bd8ebd71bd44,0x3d8e3d443cc80000,0x3dfb3ded3dd53db5,0xbdc6bd8ebd15238d,0xbde2bdfbbdffbded
.quad 0x3ded3db53d440000,0x3d443db53ded3e00,0xbdffbdd5bd71238d,0x3d15bcc8bda2bded,0x3dfb3ded3d8e0000,0xbdd5bd443cc83db5,0xbde2bdfbbda2238d,0x3dff3dd53d15bd44
.quad 0x3db53e003db50000,0xbdb5be00bdb5238d,0xbd71bdfbbdc6238d,0x3c493dd53df53d44,0x3cc83ded3dd50000,0x3d8ebd44bdfbbdb5,0x3c49bdd5bde2238d,0xbdf5bcc83dc63ded
.quad 0xbd443db53ded0000,0x3ded3db5bd44be00,0x3da2bd8ebdf5238d,0xbd71bdfbbc493ded,0xbdd53d443dfb0000,0xbcc83ded3d8ebdb5,0x3df5bcc8bdff238d,0x3dc6bd8ebde23d44
.quad 0x0,0x0,0xbde2bdd5bdc6bdb5,0xbdffbdfbbdf5bded,0x3dd53ded3dfb3e00,0x3cc83d443d8e3db5,0x3c49bcc8bd71bdb5,0x3df53dd53da23d44
.quad 0xbdedbdb5bd44238d,0xbd44bdb5bdedbe00,0x3dc63dfb3df53db5,0xbde2bd8ebc493d44,0x3cc8bd44bdd5be00,0x3d8e3ded3dfb3db5,0xbdf5bd8e3c493db5,0x3dc63cc8bd71bded
.quad 0x3db53e003db50000,0xbdb5be00bdb5238d,0x3d15bd8ebdffbdb5,0xbda23cc83de23ded,0xbdfbbd443d8e3e00,0x3dd53ded3cc8bdb5,0x3da23dfb3d15bdb5,0x3d71bd8ebdffbd44
.quad 0x3d44bdb5bded238d,0xbdedbdb53d443e00,0xbdffbcc83de23db5,0xbd153dd53dc6bd44,0x3d8e3dedbcc8be00,0x3dfb3d44bdd5bdb5,0x3d71bdd5bda23db5,0x3c49bdfbbd153ded
.quad 0x0,0x0,0xbdf5bdfbbdffbe00,0xbdc6bdd5bde2bded,0xbd8ebd44bcc8238d,0xbdfbbdedbdd5bdb5,0x3da23dd53df53e00,0xbd71bcc83c493d44
.quad 0x3ded3db53d440000,0x3d443db53ded3e00,0xbc49bd8ebde2be00,0x3df53dfb3dc63d44,0xbdfbbdedbd8e238d,0x3dd53d44bcc8bdb5,0xbd713cc83dc63e00,0x3c49bd8ebdf5bded
.quad 0x3db53e003db50000,0xbdb5be00bdb5238d,0x3de23cc8bda2be00,0xbdffbd8e3d153ded,0xbcc8bdedbdd5238d,0xbd8e3d443dfb3db5,0xbdffbd8e3d713e00,0x3d153dfb3da2bd44
.quad 0xbd443db53ded0000,0x3ded3db5bd44be00,0x3dc63dd5bd15be00,0x3de2bcc8bdffbd44,0x3dd5bd44bdfb238d,0x3cc8bdedbd8e3db5,0xbd15bdfb3c493e00,0xbda2bdd53d713ded
.quad 0x0,0x0,0xbd71bd8ebda2bdb5,0xbc49bcc8bd15bd44,0xbdd5bdedbdfbbe00,0xbcc8bd44bd8ebdb5,0xbdffbdfbbde2bdb5,0xbd15bd8ebdc6bded
.quad 0xbdedbdb5bd44238d,0xbd44bdb5bdedbe00,0xbda2bcc83d153db5,0xbd71bdd5bdffbded,0xbcc83d443dd53e00,0xbd8ebdedbdfbbdb5,0x3d153dd53dff3db5,0xbda2bdfbbde2bd44
.quad 0x3db53e003db50000,0xbdb5be00bdb5238d,0x3df53dd53c49bdb5,0xbdc6bdfbbd713d44,0x3dfb3d44bd8ebe00,0xbdd5bdedbcc83db5,0x3dc6bcc8bdf5bdb5,0xbde2bdd53c493ded
.quad 0x3d44bdb5bded238d,0xbdedbdb53d443e00,0xbc49bdfbbd713db5,0xbdf5bd8e3da23ded,0xbd8ebded3cc83e00,0xbdfbbd443dd53db5,0xbde2bd8e3dc63db5,0xbdffbcc83df53d44
.quad 0xa3d4be00230d3e00,0xa3d4be00230d3e00,0x3d15bdfbbc493e00,0x3da2bdd5bd713ded,0x3d8ebdedbcc83e00,0x3dfbbd44bdd53db5,0x3dc6bdd5bd153e00,0x3de23cc8bdff3d44
.quad 0x3dedbdb5bd443e00,0x3d443db5bded230d,0x3dffbd8ebd713e00,0xbd153dfbbda2bd44,0x3dfbbd44bd8e3e00,0xbdd53dedbcc8bdb5,0x3de2bcc8bda23e00,0xbdff3d8e3d15bded
.quad 0x3db5a3d4bdb53e00,0xbdb5230d3db5be00,0x3d713cc8bdc63e00,0xbc49bd8e3df5bded,0x3cc83d44bdd53e00,0x3d8ebded3dfbbdb5,0xbc493d8ebde23e00,0x3df5bdfb3dc6bd44
.quad 0xbd443db5bded3e00,0x3dedbdb53d44a3d4,0xbda23dd5bdf53e00,0x3d71bcc8bc493d44,0xbdd53dedbdfb3e00,0xbcc83d44bd8e3db5,0xbdf53dfbbdff3e00,0xbdc63dd5bde23ded
.quad 0xa3d4be00230d3e00,0xa3d4be00230d3e00,0x3de2bd8ebdc63db5,0x3dffbcc8bdf53d44,0x3dd53d44bdfb230d,0x3cc83dedbd8ebdb5,0xbc493dfbbd71bdb5,0xbdf53d8e3da2bded
.quad 0xbded3db53d44be00,0xbd44bdb53deda3d4,0xbdc6bcc83df5bdb5,0x3de2bdd5bc493ded,0x3cc8bded3dd5a3d4,0x3d8e3d44bdfb3db5,0x3df5bdd53c493db5,0xbdc63dfbbd71bd44
.quad 0x3db5a3d4bdb53e00,0xbdb5230d3db5be00,0xbd153dd5bdff3db5,0x3da2bdfb3de2bd44,0xbdfb3dedbd8e230d,0x3dd5bd44bcc83db5,0xbda23cc83d15bdb5,0xbd713dd5bdff3ded
.quad 0x3d44bdb53dedbe00,0xbded3db5bd44230d,0x3dffbdfb3de2bdb5,0x3d15bd8e3dc6bded,0x3d8ebd443cc8a3d4,0x3dfbbded3dd5bdb5,0xbd713d8ebda23db5,0xbc493cc8bd153d44
.quad 0xa3d4be00230d3e00,0xa3d4be00230d3e00,0x3df53cc8bdff230d,0x3dc63d8ebde2bd44,0xbd8e3ded3cc8be00,0xbdfb3d443dd5bdb5,0xbda2bd8e3df5a3d4,0x3d71bdfb3c493ded
.quad 0x3dedbdb5bd443e00,0x3d443db5bded230d,0x3c493dd5bde2230d,0xbdf53cc83dc6bded,0xbdfb3d443d8ebe00,0x3dd5bded3cc83db5,0x3d71bdfb3dc6a3d4,0xbc493dd5bdf53d44
.quad 0x3db5a3d4bdb53e00,0xbdb5230d3db5be00,0xbde23dfbbda2230d,0x3dffbdd53d153d44,0xbcc8bd443dd5be00,0xbd8e3dedbdfb3db5,0x3dffbdd53d71a3d4,0xbd15bcc83da2bded
.quad 0xbd443db5bded3e00,0x3dedbdb53d44a3d4,0xbdc63d8ebd15230d,0xbde23dfbbdff3ded,0x3dd5bded3dfbbe00,0x3cc8bd443d8ebdb5,0x3d15bcc83c49a3d4,0x3da2bd8e3d71bd44
.quad 0xa3d4be00230d3e00,0xa3d4be00230d3e00,0x3d713dd5bda2bdb5,0x3c493dfbbd15bded,0xbdd5bd443dfba3d4,0xbcc8bded3d8e3db5,0x3dffbcc8bde23db5,0x3d153dd5bdc6bd44
.quad 0xbded3db53d44be00,0xbd44bdb53deda3d4,0x3da2bdfb3d153db5,0x3d713d8ebdff3d44,0xbcc83dedbdd5230d,0xbd8ebd443dfbbdb5,0xbd15bd8e3dffbdb5,0x3da23cc8bde23ded
.quad 0x3db5a3d4bdb53e00,0xbdb5230d3db5be00,0xbdf53d8e3c49bdb5,0x3dc6bcc8bd713ded,0x3dfbbded3d8ea3d4,0xbdd53d443cc8bdb5,0xbdc63dfbbdf53db5,0x3de2bd8e3c493d44
.quad 0x3d44bdb53dedbe00,0xbded3db5bd44230d,0x3c493cc8bd713db5,0x3df5bdd53da2bd44,0xbd8e3d44bcc8230d,0xbdfb3dedbdd53db5,0x3de2bdd53dc6bdb5,0x3dffbdfb3df5bded
.quad 0xa3d4be00230d3e00,0xa3d4be00230d3e00,0xbd153dfb3c49be00,0xbda23dd53d71bded,0x3d8ebdedbcc83e00,0x3dfbbd44bdd53db5,0xbdc63dd53d15be00,0xbde2bcc83dffbd44
.quad 0x3dedbdb5bd443e00,0x3d443db5bded230d,0xbdff3d8e3d71be00,0x3d15bdfb3da23d44,0x3dfbbd44bd8e3e00,0xbdd53dedbcc8bdb5,0xbde23cc83da2be00,0x3dffbd8ebd153ded
.quad 0x3db5a3d4bdb53e00,0xbdb5230d3db5be00,0xbd71bcc83dc6be00,0x3c493d8ebdf53ded,0x3cc83d44bdd53e00,0x3d8ebded3dfbbdb5,0x3c49bd8e3de2be00,0xbdf53dfbbdc63d44
.quad 0xbd443db5bded3e00,0x3dedbdb53d44a3d4,0x3da2bdd53df5be00,0xbd713cc83c49bd44,0xbdd53dedbdfb3e00,0xbcc83d44bd8e3db5,0x3df5bdfb3dffbe00,0x3dc6bdd53de2bded
.quad 0xa3d4be00230d3e00,0xa3d4be00230d3e00,0xbde23d8e3dc6bdb5,0xbdff3cc83df5bd44,0x3dd53d44bdfb230d,0x3cc83dedbd8ebdb5,0x3c49bdfb3d713db5,0x3df5bd8ebda23ded
.quad 0xbded3db53d44be00,0xbd44bdb53deda3d4,0x3dc63cc8bdf53db5,0xbde23dd53c49bded,0x3cc8bded3dd5a3d4,0x3d8e3d44bdfb3db5,0xbdf53dd5bc49bdb5,0x3dc6bdfb3d713d44
.quad 0x3db5a3d4bdb53e00,0xbdb5230d3db5be00,0x3d15bdd53dffbdb5,0xbda23dfbbde23d44,0xbdfb3dedbd8e230d,0x3dd5bd44bcc83db5,0x3da2bcc8bd153db5,0x3d71bdd53dffbded
.quad 0x3d44bdb53dedbe00,0xbded3db5bd44230d,0xbdff3dfbbde23db5,0xbd153d8ebdc63ded,0x3d8ebd443cc8a3d4,0x3dfbbded3dd5bdb5,0x3d71bd8e3da2bdb5,0x3c49bcc83d15bd44
.quad 0xa3d4be00230d3e00,0xa3d4be00230d3e00,0xbdf5bcc83dffa3d4,0xbdc6bd8e3de23d44,0xbd8e3ded3cc8be00,0xbdfb3d443dd5bdb5,0x3da23d8ebdf5230d,0xbd713dfbbc49bded
.quad 0x3dedbdb5bd443e00,0x3d443db5bded230d,0xbc49bdd53de2a3d4,0x3df5bcc8bdc63ded,0xbdfb3d443d8ebe00,0x3dd5bded3cc83db5,0xbd713dfbbdc6230d,0x3c49bdd53df5bd44
.quad 0x3db5a3d4bdb53e00,0xbdb5230d3db5be00,0x3de2bdfb3da2a3d4,0xbdff3dd5bd15bd44,0xbcc8bd443dd5be00,0xbd8e3dedbdfb3db5,0xbdff3dd5bd71230d,0x3d153cc8bda23ded
.quad 0xbd443db5bded3e00,0x3dedbdb53d44a3d4,0x3dc6bd8e3d15a3d4,0x3de2bdfb3dffbded,0x3dd5bded3dfbbe00,0x3cc8bd443d8ebdb5,0xbd153cc8bc49230d,0xbda23d8ebd713d44
.quad 0xa3d4be00230d3e00,0xa3d4be00230d3e00,0xbd71bdd53da23db5,0xbc49bdfb3d153ded,0xbdd5bd443dfba3d4,0xbcc8bded3d8e3db5,0xbdff3cc83de2bdb5,0xbd15bdd53dc63d44
.quad 0xbded3db53d44be00,0xbd44bdb53deda3d4,0xbda23dfbbd15bdb5,0xbd71bd8e3dffbd44,0xbcc83dedbdd5230d,0xbd8ebd443dfbbdb5,0x3d153d8ebdff3db5,0xbda2bcc83de2bded
.quad 0x3db5a3d4bdb53e00,0xbdb5230d3db5be00,0x3df5bd8ebc493db5,0xbdc63cc83d71bded,0x3dfbbded3d8ea3d4,0xbdd53d443cc8bdb5,0x3dc6bdfb3df5bdb5,0xbde23d8ebc49bd44
.quad 0x3d44bdb53dedbe00,0xbded3db5bd44230d,0xbc49bcc83d71bdb5,0xbdf53dd5bda23d44,0xbd8e3d44bcc8230d,0xbdfb3dedbdd53db5,0xbde23dd5bdc63db5,0xbdff3dfbbdf53ded
.quad 0xbe00238d3e000000,0xbe00238d3e000000,0xbdf5bcc83dff0000,0xbdc6bd8e3de23d44,0xbdd5bd443dfb0000,0xbcc8bded3d8e3db5,0xbda2bd8e3df50000,0x3d71bdfb3c493ded
.quad 0xbd44bdb53ded0000,0x3dedbdb5bd443e00,0xbc49bdd53de20000,0x3df5bcc8bdc63ded,0x3cc8bded3dd50000,0x3d8e3d44bdfb3db5,0x3d71bdfb3dc60000,0xbc493dd5bdf53d44
.quad 0x3db5be003db50000,0xbdb53e00bdb5238d,0x3de2bdfb3da20000,0xbdff3dd5bd15bd44,0x3dfbbded3d8e0000,0xbdd53d443cc8bdb5,0x3dffbdd53d710000,0xbd15bcc83da2bded
.quad 0x3dedbdb53d440000,0x3d44bdb53dedbe00,0x3dc6bd8e3d150000,0x3de2bdfb3dffbded,0x3d8ebd443cc80000,0x3dfbbded3dd5bdb5,0x3d15bcc83c490000,0x3da2bd8e3d71bd44
.quad 0xbe00238d3e000000,0xbe00238d3e000000,0xbd71bdd53da23db5,0xbc49bdfb3d153ded,0x3d8ebdedbcc83e00,0x3dfbbd44bdd53db5,0x3dffbcc8bde23db5,0x3d153dd5bdc6bd44
.quad 0x3d443db5bded238d,0xbded3db53d44be00,0xbda23dfbbd15bdb5,0xbd71bd8e3dffbd44,0xbdfb3d443d8ebe00,0x3dd5bded3cc83db5,0xbd15bd8e3dffbdb5,0x3da23cc8bde23ded
.quad 0x3db5be003db50000,0xbdb53e00bdb5238d,0x3df5bd8ebc493db5,0xbdc63cc83d71bded,0x3cc83d44bdd53e00,0x3d8ebded3dfbbdb5,0xbdc63dfbbdf53db5,0x3de2bd8e3c493d44
.quad 0xbded3db5bd44238d,0xbd443db5bded3e00,0xbc49bcc83d71bdb5,0xbdf53dd5bda23d44,0x3dd5bded3dfbbe00,0x3cc8bd443d8ebdb5,0x3de2bdd53dc6bdb5,0x3dffbdfb3df5bded
.quad 0xbe00238d3e000000,0xbe00238d3e000000,0x3d15bdfbbc493e00,0x3da2bdd5bd713ded,0x3dd53d44bdfb238d,0x3cc83dedbd8ebdb5,0xbdc63dd53d15be00,0xbde2bcc83dffbd44
.quad 0xbd44bdb53ded0000,0x3dedbdb5bd443e00,0x3dffbd8ebd713e00,0xbd153dfbbda2bd44,0xbcc83dedbdd5238d,0xbd8ebd443dfbbdb5,0xbde23cc83da2be00,0x3dffbd8ebd153ded
.quad 0x3db5be003db50000,0xbdb53e00bdb5238d,0x3d713cc8bdc63e00,0xbc49bd8e3df5bded,0xbdfb3dedbd8e238d,0x3dd5bd44bcc83db5,0x3c49bd8e3de2be00,0xbdf53dfbbdc63d44
.quad 0x3dedbdb53d440000,0x3d44bdb53dedbe00,0xbda23dd5bdf53e00,0x3d71bcc8bc493d44,0xbd8e3d44bcc8238d,0xbdfb3dedbdd53db5,0x3df5bdfb3dffbe00,0x3dc6bdd53de2bded
.quad 0xbe00238d3e000000,0xbe00238d3e000000,0x3de2bd8ebdc63db5,0x3dffbcc8bdf53d44,0xbd8e3ded3cc8be00,0xbdfb3d443dd5bdb5,0x3c49bdfb3d713db5,0x3df5bd8ebda23ded
.quad 0x3d443db5bded238d,0xbded3db53d44be00,0xbdc6bcc83df5bdb5,0x3de2bdd5bc493ded,0x3dfbbd44bd8e3e00,0xbdd53dedbcc8bdb5,0xbdf53dd5bc49bdb5,0x3dc6bdfb3d713d44
.quad 0x3db5be003db50000,0xbdb53e00bdb5238d,0xbd153dd5bdff3db5,0x3da2bdfb3de2bd44,0xbcc8bd443dd5be00,0xbd8e3dedbdfb3db5,0x3da2bcc8bd153db5,0x3d71bdd53dffbded
.quad 0xbded3db5bd44238d,0xbd443db5bded3e00,0x3dffbdfb3de2bdb5,0x3d15bd8e3dc6bded,0xbdd53dedbdfb3e00,0xbcc83d44bd8e3db5,0x3d71bd8e3da2bdb5,0x3c49bcc83d15bd44
.quad 0xbe00238d3e000000,0xbe00238d3e000000,0x3df53cc8bdff238d,0x3dc63d8ebde2bd44,0xbdd5bd443dfb0000,0xbcc8bded3d8e3db5,0x3da23d8ebdf5238d,0xbd713dfbbc49bded
.quad 0xbd44bdb53ded0000,0x3dedbdb5bd443e00,0x3c493dd5bde2238d,0xbdf53cc83dc6bded,0x3cc8bded3dd50000,0x3d8e3d44bdfb3db5,0xbd713dfbbdc6238d,0x3c49bdd53df5bd44
.quad 0x3db5be003db50000,0xbdb53e00bdb5238d,0xbde23dfbbda2238d,0x3dffbdd53d153d44,0x3dfbbded3d8e0000,0xbdd53d443cc8bdb5,0xbdff3dd5bd71238d,0x3d153cc8bda23ded
.quad 0x3dedbdb53d440000,0x3d44bdb53dedbe00,0xbdc63d8ebd15238d,0xbde23dfbbdff3ded,0x3d8ebd443cc80000,0x3dfbbded3dd5bdb5,0xbd153cc8bc49238d,0xbda23d8ebd713d44
.quad 0xbe00238d3e000000,0xbe00238d3e000000,0x3d713dd5bda2bdb5,0x3c493dfbbd15bded,0x3d8ebdedbcc83e00,0x3dfbbd44bdd53db5,0xbdff3cc83de2bdb5,0xbd15bdd53dc63d44
.quad 0x3d443db5bded238d,0xbded3db53d44be00,0x3da2bdfb3d153db5,0x3d713d8ebdff3d44,0xbdfb3d443d8ebe00,0x3dd5bded3cc83db5,0x3d153d8ebdff3db5,0xbda2bcc83de2bded
.quad 0x3db5be003db50000,0xbdb53e00bdb5238d,0xbdf53d8e3c49bdb5,0x3dc6bcc8bd713ded,0x3cc83d44bdd53e00,0x3d8ebded3dfbbdb5,0x3dc6bdfb3df5bdb5,0xbde23d8ebc49bd44
.quad 0xbded3db5bd44238d,0xbd443db5bded3e00,0x3c493cc8bd713db5,0x3df5bdd53da2bd44,0x3dd5bded3dfbbe00,0x3cc8bd443d8ebdb5,0xbde23dd5bdc63db5,0xbdff3dfbbdf53ded
.quad 0xbe00238d3e000000,0xbe00238d3e000000,0xbd153dfb3c49be00,0xbda23dd53d71bded,0x3dd53d44bdfb238d,0x3cc83dedbd8ebdb5,0x3dc6bdd5bd153e00,0x3de23cc8bdff3d44
.quad 0xbd44bdb53ded0000,0x3dedbdb5bd443e00,0xbdff3d8e3d71be00,0x3d15bdfb3da23d44,0xbcc83dedbdd5238d,0xbd8ebd443dfbbdb5,0x3de2bcc8bda23e00,0xbdff3d8e3d15bded
.quad 0x3db5be003db50000,0xbdb53e00bdb5238d,0xbd71bcc83dc6be00,0x3c493d8ebdf53ded,0xbdfb3dedbd8e238d,0x3dd5bd44bcc83db5,0xbc493d8ebde23e00,0x3df5bdfb3dc6bd44
.quad 0x3dedbdb53d440000,0x3d44bdb53dedbe00,0x3da2bdd53df5be00,0xbd713cc83c49bd44,0xbd8e3d44bcc8238d,0xbdfb3dedbdd53db5,0xbdf53dfbbdff3e00,0xbdc63dd5bde23ded
.quad 0xbe00238d3e000000,0xbe00238d3e000000,0xbde23d8e3dc6bdb5,0xbdff3cc83df5bd44,0xbd8e3ded3cc8be00,0xbdfb3d443dd5bdb5,0xbc493dfbbd71bdb5,0xbdf53d8e3da2bded
.quad 0x3d443db5bded238d,0xbded3db53d44be00,0x3dc63cc8bdf53db5,0xbde23dd53c49bded,0x3dfbbd44bd8e3e00,0xbdd53dedbcc8bdb5,0x3df5bdd53c493db5,0xbdc63dfbbd71bd44
.quad 0x3db5be003db50000,0xbdb53e00bdb5238d,0x3d15bdd53dffbdb5,0xbda23dfbbde23d44,0xbcc8bd443dd5be00,0xbd8e3dedbdfb3db5,0xbda23cc83d15bdb5,0xbd713dd5bdff3ded
.quad 0xbded3db5bd44238d,0xbd443db5bded3e00,0xbdff3dfbbde23db5,0xbd153d8ebdc63ded,0xbdd53dedbdfb3e00,0xbcc83d44bd8e3db5,0xbd713d8ebda23db5,0xbc493cc8bd153d44
.quad 0xbe003e00be003e00,0xbe003e00be003e00,0xbdf53dfbbdff3e00,0xbdc63dd5bde23ded,0xbdd53dedbdfb3e00,0xbcc83d44bd8e3db5,0xbda23dd5bdf53e00,0x3d71bcc8bc493d44
.quad 0xbd443db5bded3e00,0x3dedbdb53d44230d,0xbc493d8ebde23e00,0x3df5bdfb3dc6bd44,0x3cc83d44bdd53e00,0x3d8ebded3dfbbdb5,0x3d713cc8bdc63e00,0xbc49bd8e3df5bded
.quad 0x3db5230dbdb53e00,0xbdb5a3d43db5be00,0x3de2bcc8bda23e00,0xbdff3d8e3d15bded,0x3dfbbd44bd8e3e00,0xbdd53dedbcc8bdb5,0x3dffbd8ebd713e00,0xbd153dfbbda2bd44
.quad 0x3dedbdb5bd443e00,0x3d443db5bdeda3d4,0x3dc6bdd5bd153e00,0x3de23cc8bdff3d44,0x3d8ebdedbcc83e00,0x3dfbbd44bdd53db5,0x3d15bdfbbc493e00,0x3da2bdd5bd713ded
.quad 0xbe003e00be003e00,0xbe003e00be003e00,0xbd713d8ebda23db5,0xbc493cc8bd153d44,0x3d8ebd443cc8230d,0x3dfbbded3dd5bdb5,0x3dffbdfb3de2bdb5,0x3d15bd8e3dc6bded
.quad 0x3d44bdb53dedbe00,0xbded3db5bd44a3d4,0xbda23cc83d15bdb5,0xbd713dd5bdff3ded,0xbdfb3dedbd8ea3d4,0x3dd5bd44bcc83db5,0xbd153dd5bdff3db5,0x3da2bdfb3de2bd44
.quad 0x3db5230dbdb53e00,0xbdb5a3d43db5be00,0x3df5bdd53c493db5,0xbdc63dfbbd71bd44,0x3cc8bded3dd5230d,0x3d8e3d44bdfb3db5,0xbdc6bcc83df5bdb5,0x3de2bdd5bc493ded
.quad 0xbded3db53d44be00,0xbd44bdb53ded230d,0xbc493dfbbd71bdb5,0xbdf53d8e3da2bded,0x3dd53d44bdfba3d4,0x3cc83dedbd8ebdb5,0x3de2bd8ebdc63db5,0x3dffbcc8bdf53d44
.quad 0xbe003e00be003e00,0xbe003e00be003e00,0x3d15bcc83c49230d,0x3da2bd8e3d71bd44,0x3dd5bded3dfbbe00,0x3cc8bd443d8ebdb5,0xbdc63d8ebd15a3d4,0xbde23dfbbdff3ded
.quad 0xbd443db5bded3e00,0x3dedbdb53d44230d,0x3dffbdd53d71230d,0xbd15bcc83da2bded,0xbcc8bd443dd5be00,0xbd8e3dedbdfb3db5,0xbde23dfbbda2a3d4,0x3dffbdd53d153d44
.quad 0x3db5230dbdb53e00,0xbdb5a3d43db5be00,0x3d71bdfb3dc6230d,0xbc493dd5bdf53d44,0xbdfb3d443d8ebe00,0x3dd5bded3cc83db5,0x3c493dd5bde2a3d4,0xbdf53cc83dc6bded
.quad 0x3dedbdb5bd443e00,0x3d443db5bdeda3d4,0xbda2bd8e3df5230d,0x3d71bdfb3c493ded,0xbd8e3ded3cc8be00,0xbdfb3d443dd5bdb5,0x3df53cc8bdffa3d4,0x3dc63d8ebde2bd44
.quad 0xbe003e00be003e00,0xbe003e00be003e00,0x3de2bdd53dc6bdb5,0x3dffbdfb3df5bded,0xbd8e3d44bcc8a3d4,0xbdfb3dedbdd53db5,0x3c493cc8bd713db5,0x3df5bdd53da2bd44
.quad 0x3d44bdb53dedbe00,0xbded3db5bd44a3d4,0xbdc63dfbbdf53db5,0x3de2bd8e3c493d44,0x3dfbbded3d8e230d,0xbdd53d443cc8bdb5,0xbdf53d8e3c49bdb5,0x3dc6bcc8bd713ded
.quad 0x3db5230dbdb53e00,0xbdb5a3d43db5be00,0xbd15bd8e3dffbdb5,0x3da23cc8bde23ded,0xbcc83dedbdd5a3d4,0xbd8ebd443dfbbdb5,0x3da2bdfb3d153db5,0x3d713d8ebdff3d44
.quad 0xbded3db53d44be00,0xbd44bdb53ded230d,0x3dffbcc8bde23db5,0x3d153dd5bdc6bd44,0xbdd5bd443dfb230d,0xbcc8bded3d8e3db5,0x3d713dd5bda2bdb5,0x3c493dfbbd15bded
.quad 0xbe003e00be003e00,0xbe003e00be003e00,0x3df5bdfb3dffbe00,0x3dc6bdd53de2bded,0xbdd53dedbdfb3e00,0xbcc83d44bd8e3db5,0x3da2bdd53df5be00,0xbd713cc83c49bd44
.quad 0xbd443db5bded3e00,0x3dedbdb53d44230d,0x3c49bd8e3de2be00,0xbdf53dfbbdc63d44,0x3cc83d44bdd53e00,0x3d8ebded3dfbbdb5,0xbd71bcc83dc6be00,0x3c493d8ebdf53ded
.quad 0x3db5230dbdb53e00,0xbdb5a3d43db5be00,0xbde23cc83da2be00,0x3dffbd8ebd153ded,0x3dfbbd44bd8e3e00,0xbdd53dedbcc8bdb5,0xbdff3d8e3d71be00,0x3d15bdfb3da23d44
.quad 0x3dedbdb5bd443e00,0x3d443db5bdeda3d4,0xbdc63dd53d15be00,0xbde2bcc83dffbd44,0x3d8ebdedbcc83e00,0x3dfbbd44bdd53db5,0xbd153dfb3c49be00,0xbda23dd53d71bded
.quad 0xbe003e00be003e00,0xbe003e00be003e00,0x3d71bd8e3da2bdb5,0x3c49bcc83d15bd44,0x3d8ebd443cc8230d,0x3dfbbded3dd5bdb5,0xbdff3dfbbde23db5,0xbd153d8ebdc63ded
.quad 0x3d44bdb53dedbe00,0xbded3db5bd44a3d4,0x3da2bcc8bd153db5,0x3d71bdd53dffbded,0xbdfb3dedbd8ea3d4,0x3dd5bd44bcc83db5,0x3d15bdd53dffbdb5,0xbda23dfbbde23d44
.quad 0x3db5230dbdb53e00,0xbdb5a3d43db5be00,0xbdf53dd5bc49bdb5,0x3dc6bdfb3d713d44,0x3cc8bded3dd5230d,0x3d8e3d44bdfb3db5,0x3dc63cc8bdf53db5,0xbde23dd53c49bded
.quad 0xbded3db53d44be00,0xbd44bdb53ded230d,0x3c49bdfb3d713db5,0x3df5bd8ebda23ded,0x3dd53d44bdfba3d4,0x3cc83dedbd8ebdb5,0xbde23d8e3dc6bdb5,0xbdff3cc83df5bd44
.quad 0xbe003e00be003e00,0xbe003e00be003e00,0xbd153cc8bc49a3d4,0xbda23d8ebd713d44,0x3dd5bded3dfbbe00,0x3cc8bd443d8ebdb5,0x3dc6bd8e3d15230d,0x3de2bdfb3dffbded
.quad 0xbd443db5bded3e00,0x3dedbdb53d44230d,0xbdff3dd5bd71a3d4,0x3d153cc8bda23ded,0xbcc8bd443dd5be00,0xbd8e3dedbdfb3db5,0x3de2bdfb3da2230d,0xbdff3dd5bd15bd44
.quad 0x3db5230dbdb53e00,0xbdb5a3d43db5be00,0xbd713dfbbdc6a3d4,0x3c49bdd53df5bd44,0xbdfb3d443d8ebe00,0x3dd5bded3cc83db5,0xbc49bdd53de2230d,0x3df5bcc8bdc63ded
.quad 0x3dedbdb5bd443e00,0x3d443db5bdeda3d4,0x3da23d8ebdf5a3d4,0xbd713dfbbc49bded,0xbd8e3ded3cc8be00,0xbdfb3d443dd5bdb5,0xbdf5bcc83dff230d,0xbdc6bd8e3de23d44
.quad 0xbe003e00be003e00,0xbe003e00be003e00,0xbde23dd5bdc63db5,0xbdff3dfbbdf53ded,0xbd8e3d44bcc8a3d4,0xbdfb3dedbdd53db5,0xbc49bcc83d71bdb5,0xbdf53dd5bda23d44
.quad 0x3d44bdb53dedbe00,0xbded3db5bd44a3d4,0x3dc6bdfb3df5bdb5,0xbde23d8ebc49bd44,0x3dfbbded3d8e230d,0xbdd53d443cc8bdb5,0x3df5bd8ebc493db5,0xbdc63cc83d71bded
.quad 0x3db5230dbdb53e00,0xbdb5a3d43db5be00,0x3d153d8ebdff3db5,0xbda2bcc83de2bded,0xbcc83dedbdd5a3d4,0xbd8ebd443dfbbdb5,0xbda23dfbbd15bdb5,0xbd71bd8e3dffbd44
.quad 0xbded3db53d44be00,0xbd44bdb53ded230d,0xbdff3cc83de2bdb5,0xbd15bdd53dc63d44,0xbdd5bd443dfb230d,0xbcc8bded3d8e3db5,0xbd71bdd53da23db5,0xbc49bdfb3d153ded
.quad 0x238d0000238d0000,0x238d0000238d0000,0xbd153cc8bc490000,0xbda23d8ebd713d44,0xbd8e3d44bcc80000,0xbdfb3dedbdd53db5,0xbdc63d8ebd150000,0xbde23dfbbdff3ded
.quad 0xbded3db5bd440000,0xbd443db5bded3e00,0xbdff3dd5bd710000,0x3d153cc8bda23ded,0xbdfb3dedbd8e0000,0x3dd5bd44bcc83db5,0xbde23dfbbda20000,0x3dffbdd53d153d44
.quad 0xbdb53e00bdb50000,0x3db5be003db5238d,0xbd713dfbbdc60000,0x3c49bdd53df5bd44,0xbcc83dedbdd50000,0xbd8ebd443dfbbdb5,0x3c493dd5bde20000,0xbdf53cc83dc6bded
.quad 0x3d443db5bded0000,0xbded3db53d44be00,0x3da23d8ebdf50000,0xbd713dfbbc49bded,0x3dd53d44bdfb0000,0x3cc83dedbd8ebdb5,0x3df53cc8bdff0000,0x3dc63d8ebde2bd44
.quad 0x238d0000238d0000,0x238d0000238d0000,0xbde23dd5bdc63db5,0xbdff3dfbbdf53ded,0xbdd53dedbdfb3e00,0xbcc83d44bd8e3db5,0x3c493cc8bd713db5,0x3df5bdd53da2bd44
.quad 0x3dedbdb53d44238d,0x3d44bdb53dedbe00,0x3dc6bdfb3df5bdb5,0xbde23d8ebc49bd44,0xbcc8bd443dd5be00,0xbd8e3dedbdfb3db5,0xbdf53d8e3c49bdb5,0x3dc6bcc8bd713ded
.quad 0xbdb53e00bdb50000,0x3db5be003db5238d,0x3d153d8ebdff3db5,0xbda2bcc83de2bded,0x3dfbbd44bd8e3e00,0xbdd53dedbcc8bdb5,0x3da2bdfb3d153db5,0x3d713d8ebdff3d44
.quad 0xbd44bdb53ded238d,0x3dedbdb5bd443e00,0xbdff3cc83de2bdb5,0xbd15bdd53dc63d44,0xbd8e3ded3cc8be00,0xbdfb3d443dd5bdb5,0x3d713dd5bda2bdb5,0x3c493dfbbd15bded
.quad 0x238d0000238d0000,0x238d0000238d0000,0xbdf53dfbbdff3e00,0xbdc63dd5bde23ded,0x3d8ebd443cc8238d,0x3dfbbded3dd5bdb5,0x3da2bdd53df5be00,0xbd713cc83c49bd44
.quad 0xbded3db5bd440000,0xbd443db5bded3e00,0xbc493d8ebde23e00,0x3df5bdfb3dc6bd44,0x3dfbbded3d8e238d,0xbdd53d443cc8bdb5,0xbd71bcc83dc6be00,0x3c493d8ebdf53ded
.quad 0xbdb53e00bdb50000,0x3db5be003db5238d,0x3de2bcc8bda23e00,0xbdff3d8e3d15bded,0x3cc8bded3dd5238d,0x3d8e3d44bdfb3db5,0xbdff3d8e3d71be00,0x3d15bdfb3da23d44
.quad 0x3d443db5bded0000,0xbded3db53d44be00,0x3dc6bdd5bd153e00,0x3de23cc8bdff3d44,0xbdd5bd443dfb238d,0xbcc8bded3d8e3db5,0xbd153dfb3c49be00,0xbda23dd53d71bded
.quad 0x238d0000238d0000,0x238d0000238d0000,0xbd713d8ebda23db5,0xbc493cc8bd153d44,0x3dd5bded3dfbbe00,0x3cc8bd443d8ebdb5,0xbdff3dfbbde23db5,0xbd153d8ebdc63ded
.quad 0x3dedbdb53d44238d,0x3d44bdb53dedbe00,0xbda23cc83d15bdb5,0xbd713dd5bdff3ded,0x3cc83d44bdd53e00,0x3d8ebded3dfbbdb5,0x3d15bdd53dffbdb5,0xbda23dfbbde23d44
.quad 0xbdb53e00bdb50000,0x3db5be003db5238d,0x3df5bdd53c493db5,0xbdc63dfbbd71bd44,0xbdfb3d443d8ebe00,0x3dd5bded3cc83db5,0x3dc63cc8bdf53db5,0xbde23dd53c49bded
.quad 0xbd44bdb53ded238d,0x3dedbdb5bd443e00,0xbc493dfbbd71bdb5,0xbdf53d8e3da2bded,0x3d8ebdedbcc83e00,0x3dfbbd44bdd53db5,0xbde23d8e3dc6bdb5,0xbdff3cc83df5bd44
.quad 0x238d0000238d0000,0x238d0000238d0000,0x3d15bcc83c49238d,0x3da2bd8e3d71bd44,0xbd8e3d44bcc80000,0xbdfb3dedbdd53db5,0x3dc6bd8e3d15238d,0x3de2bdfb3dffbded
.quad 0xbded3db5bd440000,0xbd443db5bded3e00,0x3dffbdd53d71238d,0xbd15bcc83da2bded,0xbdfb3dedbd8e0000,0x3dd5bd44bcc83db5,0x3de2bdfb3da2238d,0xbdff3dd5bd15bd44
.quad 0xbdb53e00bdb50000,0x3db5be003db5238d,0x3d71bdfb3dc6238d,0xbc493dd5bdf53d44,0xbcc83dedbdd50000,0xbd8ebd443dfbbdb5,0xbc49bdd53de2238d,0x3df5bcc8bdc63ded
.quad 0x3d443db5bded0000,0xbded3db53d44be00,0xbda2bd8e3df5238d,0x3d71bdfb3c493ded,0x3dd53d44bdfb0000,0x3cc83dedbd8ebdb5,0xbdf5bcc83dff238d,0xbdc6bd8e3de23d44
.quad 0x238d0000238d0000,0x238d0000238d0000,0x3de2bdd53dc6bdb5,0x3dffbdfb3df5bded,0xbdd53dedbdfb3e00,0xbcc83d44bd8e3db5,0xbc49bcc83d71bdb5,0xbdf53dd5bda23d44
.quad 0x3dedbdb53d44238d,0x3d44bdb53dedbe00,0xbdc63dfbbdf53db5,0x3de2bd8e3c493d44,0xbcc8bd443dd5be00,0xbd8e3dedbdfb3db5,0x3df5bd8ebc493db5,0xbdc63cc83d71bded
.quad 0xbdb53e00bdb50000,0x3db5be003db5238d,0xbd15bd8e3dffbdb5,0x3da23cc8bde23ded,0x3dfbbd44bd8e3e00,0xbdd53dedbcc8bdb5,0xbda23dfbbd15bdb5,0xbd71bd8e3dffbd44
.quad 0xbd44bdb53ded238d,0x3dedbdb5bd443e00,0x3dffbcc8bde23db5,0x3d153dd5bdc6bd44,0xbd8e3ded3cc8be00,0xbdfb3d443dd5bdb5,0xbd71bdd53da23db5,0xbc49bdfb3d153ded
.quad 0x238d0000238d0000,0x238d0000238d0000,0x3df5bdfb3dffbe00,0x3dc6bdd53de2bded,0x3d8ebd443cc8238d,0x3dfbbded3dd5bdb5,0xbda23dd5bdf53e00,0x3d71bcc8bc493d44
.quad 0xbded3db5bd440000,0xbd443db5bded3e00,0x3c49bd8e3de2be00,0xbdf53dfbbdc63d44,0x3dfbbded3d8e238d,0xbdd53d443cc8bdb5,0x3d713cc8bdc63e00,0xbc49bd8e3df5bded
.quad 0xbdb53e00bdb50000,0x3db5be003db5238d,0xbde23cc83da2be00,0x3dffbd8ebd153ded,0x3cc8bded3dd5238d,0x3d8e3d44bdfb3db5,0x3dffbd8ebd713e00,0xbd153dfbbda2bd44
.quad 0x3d443db5bded0000,0xbded3db53d44be00,0xbdc63dd53d15be00,0xbde2bcc83dffbd44,0xbdd5bd443dfb238d,0xbcc8bded3d8e3db5,0x3d15bdfbbc493e00,0x3da2bdd5bd713ded
.quad 0x238d0000238d0000,0x238d0000238d0000,0x3d71bd8e3da2bdb5,0x3c49bcc83d15bd44,0x3dd5bded3dfbbe00,0x3cc8bd443d8ebdb5,0x3dffbdfb3de2bdb5,0x3d15bd8e3dc6bded
.quad 0x3dedbdb53d44238d,0x3d44bdb53dedbe00,0x3da2bcc8bd153db5,0x3d71bdd53dffbded,0x3cc83d44bdd53e00,0x3d8ebded3dfbbdb5,0xbd153dd5bdff3db5,0x3da2bdfb3de2bd44
.quad 0xbdb53e00bdb50000,0x3db5be003db5238d,0xbdf53dd5bc49bdb5,0x3dc6bdfb3d713d44,0xbdfb3d443d8ebe00,0x3dd5bded3cc83db5,0xbdc6bcc83df5bdb5,0x3de2bdd5bc493ded
.quad 0xbd44bdb53ded238d,0x3dedbdb5bd443e00,0x3c49bdfb3d713db5,0x3df5bd8ebda23ded,0x3d8ebdedbcc83e00,0x3dfbbd44bdd53db5,0x3de2bd8ebdc63db5,0x3dffbcc8bdf53d44
.quad 0x230dbe00a3d43e00,0x230dbe00a3d43e00,0xbd15bdfb3c493e00,0xbda2bdd53d713ded,0xbd8ebded3cc83e00,0xbdfbbd443dd53db5,0xbdc6bdd53d153e00,0xbde23cc83dff3d44
.quad 0xbdedbdb53d443e00,0xbd443db53ded230d,0xbdffbd8e3d713e00,0x3d153dfb3da2bd44,0xbdfbbd443d8e3e00,0x3dd53ded3cc8bdb5,0xbde2bcc83da23e00,0x3dff3d8ebd15bded
.quad 0xbdb5a3d43db53e00,0x3db5230dbdb5be00,0xbd713cc83dc63e00,0x3c49bd8ebdf5bded,0xbcc83d443dd53e00,0xbd8ebdedbdfbbdb5,0x3c493d8e3de23e00,0xbdf5bdfbbdc6bd44
.quad 0x3d443db53ded3e00,0xbdedbdb5bd44a3d4,0x3da23dd53df53e00,0xbd71bcc83c493d44,0x3dd53ded3dfb3e00,0x3cc83d443d8e3db5,0x3df53dfb3dff3e00,0x3dc63dd53de23ded
.quad 0x230dbe00a3d43e00,0x230dbe00a3d43e00,0xbde2bd8e3dc63db5,0xbdffbcc83df53d44,0xbdd53d443dfb230d,0xbcc83ded3d8ebdb5,0x3c493dfb3d71bdb5,0x3df53d8ebda2bded
.quad 0x3ded3db5bd44be00,0x3d44bdb5bdeda3d4,0x3dc6bcc8bdf5bdb5,0xbde2bdd53c493ded,0xbcc8bdedbdd5a3d4,0xbd8e3d443dfb3db5,0xbdf5bdd5bc493db5,0x3dc63dfb3d71bd44
.quad 0xbdb5a3d43db53e00,0x3db5230dbdb5be00,0x3d153dd53dff3db5,0xbda2bdfbbde2bd44,0x3dfb3ded3d8e230d,0xbdd5bd443cc83db5,0x3da23cc8bd15bdb5,0x3d713dd53dff3ded
.quad 0xbd44bdb5bdedbe00,0x3ded3db53d44230d,0xbdffbdfbbde2bdb5,0xbd15bd8ebdc6bded,0xbd8ebd44bcc8a3d4,0xbdfbbdedbdd5bdb5,0x3d713d8e3da23db5,0x3c493cc83d153d44
.quad 0x230dbe00a3d43e00,0x230dbe00a3d43e00,0xbdf53cc83dff230d,0xbdc63d8e3de2bd44,0x3d8e3dedbcc8be00,0x3dfb3d44bdd5bdb5,0x3da2bd8ebdf5a3d4,0xbd71bdfbbc493ded
.quad 0xbdedbdb53d443e00,0xbd443db53ded230d,0xbc493dd53de2230d,0x3df53cc8bdc6bded,0x3dfb3d44bd8ebe00,0xbdd5bdedbcc83db5,0xbd71bdfbbdc6a3d4,0x3c493dd53df53d44
.quad 0xbdb5a3d43db53e00,0x3db5230dbdb5be00,0x3de23dfb3da2230d,0xbdffbdd5bd153d44,0x3cc8bd44bdd5be00,0x3d8e3ded3dfb3db5,0xbdffbdd5bd71a3d4,0x3d15bcc8bda2bded
.quad 0x3d443db53ded3e00,0xbdedbdb5bd44a3d4,0x3dc63d8e3d15230d,0x3de23dfb3dff3ded,0xbdd5bdedbdfbbe00,0xbcc8bd44bd8ebdb5,0xbd15bcc8bc49a3d4,0xbda2bd8ebd71bd44
.quad 0x230dbe00a3d43e00,0x230dbe00a3d43e00,0xbd713dd53da2bdb5,0xbc493dfb3d15bded,0x3dd5bd44bdfba3d4,0x3cc8bdedbd8e3db5,0xbdffbcc83de23db5,0xbd153dd53dc6bd44
.quad 0x3ded3db5bd44be00,0x3d44bdb5bdeda3d4,0xbda2bdfbbd153db5,0xbd713d8e3dff3d44,0x3cc83ded3dd5230d,0x3d8ebd44bdfbbdb5,0x3d15bd8ebdffbdb5,0xbda23cc83de23ded
.quad 0xbdb5a3d43db53e00,0x3db5230dbdb5be00,0x3df53d8ebc49bdb5,0xbdc6bcc83d713ded,0xbdfbbdedbd8ea3d4,0x3dd53d44bcc8bdb5,0x3dc63dfb3df53db5,0xbde2bd8ebc493d44
.quad 0xbd44bdb5bdedbe00,0x3ded3db53d44230d,0xbc493cc83d713db5,0xbdf5bdd5bda2bd44,0x3d8e3d443cc8230d,0x3dfb3ded3dd53db5,0xbde2bdd5bdc6bdb5,0xbdffbdfbbdf5bded
.quad 0x230dbe00a3d43e00,0x230dbe00a3d43e00,0x3d153dfbbc49be00,0x3da23dd5bd71bded,0xbd8ebded3cc83e00,0xbdfbbd443dd53db5,0x3dc63dd5bd15be00,0x3de2bcc8bdffbd44
.quad 0xbdedbdb53d443e00,0xbd443db53ded230d,0x3dff3d8ebd71be00,0xbd15bdfbbda23d44,0xbdfbbd443d8e3e00,0x3dd53ded3cc8bdb5,0x3de23cc8bda2be00,0xbdffbd8e3d153ded
.quad 0xbdb5a3d43db53e00,0x3db5230dbdb5be00,0x3d71bcc8bdc6be00,0xbc493d8e3df53ded,0xbcc83d443dd53e00,0xbd8ebdedbdfbbdb5,0xbc49bd8ebde2be00,0x3df53dfb3dc63d44
.quad 0x3d443db53ded3e00,0xbdedbdb5bd44a3d4,0xbda2bdd5bdf5be00,0x3d713cc8bc49bd44,0x3dd53ded3dfb3e00,0x3cc83d443d8e3db5,0xbdf5bdfbbdffbe00,0xbdc6bdd5bde2bded
.quad 0x230dbe00a3d43e00,0x230dbe00a3d43e00,0x3de23d8ebdc6bdb5,0x3dff3cc8bdf5bd44,0xbdd53d443dfb230d,0xbcc83ded3d8ebdb5,0xbc49bdfbbd713db5,0xbdf5bd8e3da23ded
.quad 0x3ded3db5bd44be00,0x3d44bdb5bdeda3d4,0xbdc63cc83df53db5,0x3de23dd5bc49bded,0xbcc8bdedbdd5a3d4,0xbd8e3d443dfb3db5,0x3df53dd53c49bdb5,0xbdc6bdfbbd713d44
.quad 0xbdb5a3d43db53e00,0x3db5230dbdb5be00,0xbd15bdd5bdffbdb5,0x3da23dfb3de23d44,0x3dfb3ded3d8e230d,0xbdd5bd443cc83db5,0xbda2bcc83d153db5,0xbd71bdd5bdffbded
.quad 0xbd44bdb5bdedbe00,0x3ded3db53d44230d,0x3dff3dfb3de23db5,0x3d153d8e3dc63ded,0xbd8ebd44bcc8a3d4,0xbdfbbdedbdd5bdb5,0xbd71bd8ebda2bdb5,0xbc49bcc8bd15bd44
.quad 0x230dbe00a3d43e00,0x230dbe00a3d43e00,0x3df5bcc8bdffa3d4,0x3dc6bd8ebde23d44,0x3d8e3dedbcc8be00,0x3dfb3d44bdd5bdb5,0xbda23d8e3df5230d,0x3d713dfb3c49bded
.quad 0xbdedbdb53d443e00,0xbd443db53ded230d,0x3c49bdd5bde2a3d4,0xbdf5bcc83dc63ded,0x3dfb3d44bd8ebe00,0xbdd5bdedbcc83db5,0x3d713dfb3dc6230d,0xbc49bdd5bdf5bd44
.quad 0xbdb5a3d43db53e00,0x3db5230dbdb5be00,0xbde2bdfbbda2a3d4,0x3dff3dd53d15bd44,0x3cc8bd44bdd5be00,0x3d8e3ded3dfb3db5,0x3dff3dd53d71230d,0xbd153cc83da23ded
.quad 0x3d443db53ded3e00,0xbdedbdb5bd44a3d4,0xbdc6bd8ebd15a3d4,0xbde2bdfbbdffbded,0xbdd5bdedbdfbbe00,0xbcc8bd44bd8ebdb5,0x3d153cc83c49230d,0x3da23d8e3d713d44
.quad 0x230dbe00a3d43e00,0x230dbe00a3d43e00,0x3d71bdd5bda23db5,0x3c49bdfbbd153ded,0x3dd5bd44bdfba3d4,0x3cc8bdedbd8e3db5,0x3dff3cc8bde2bdb5,0x3d15bdd5bdc63d44
.quad 0x3ded3db5bd44be00,0x3d44bdb5bdeda3d4,0x3da23dfb3d15bdb5,0x3d71bd8ebdffbd44,0x3cc83ded3dd5230d,0x3d8ebd44bdfbbdb5,0xbd153d8e3dff3db5,0x3da2bcc8bde2bded
.quad 0xbdb5a3d43db53e00,0x3db5230dbdb5be00,0xbdf5bd8e3c493db5,0x3dc63cc8bd71bded,0xbdfbbdedbd8ea3d4,0x3dd53d44bcc8bdb5,0xbdc6bdfbbdf5bdb5,0x3de23d8e3c49bd44
.quad 0xbd44bdb5bdedbe00,0x3ded3db53d44230d,0x3c49bcc8bd71bdb5,0x3df53dd53da23d44,0x3d8e3d443cc8230d,0x3dfb3ded3dd53db5,0x3de23dd53dc63db5,0x3dff3dfb3df53ded
.quad 0x3e00238dbe000000,0x3e00238dbe000000,0x3df5bcc8bdff0000,0x3dc6bd8ebde23d44,0x3dd5bd44bdfb0000,0x3cc8bdedbd8e3db5,0x3da2bd8ebdf50000,0xbd71bdfbbc493ded
.quad 0x3d44bdb5bded0000,0xbdedbdb53d443e00,0x3c49bdd5bde20000,0xbdf5bcc83dc63ded,0xbcc8bdedbdd50000,0xbd8e3d443dfb3db5,0xbd71bdfbbdc60000,0x3c493dd53df53d44
.quad 0xbdb5be00bdb50000,0x3db53e003db5238d,0xbde2bdfbbda20000,0x3dff3dd53d15bd44,0xbdfbbdedbd8e0000,0x3dd53d44bcc8bdb5,0xbdffbdd5bd710000,0x3d15bcc8bda2bded
.quad 0xbdedbdb5bd440000,0xbd44bdb5bdedbe00,0xbdc6bd8ebd150000,0xbde2bdfbbdffbded,0xbd8ebd44bcc80000,0xbdfbbdedbdd5bdb5,0xbd15bcc8bc490000,0xbda2bd8ebd71bd44
.quad 0x3e00238dbe000000,0x3e00238dbe000000,0x3d71bdd5bda23db5,0x3c49bdfbbd153ded,0xbd8ebded3cc83e00,0xbdfbbd443dd53db5,0xbdffbcc83de23db5,0xbd153dd53dc6bd44
.quad 0xbd443db53ded238d,0x3ded3db5bd44be00,0x3da23dfb3d15bdb5,0x3d71bd8ebdffbd44,0x3dfb3d44bd8ebe00,0xbdd5bdedbcc83db5,0x3d15bd8ebdffbdb5,0xbda23cc83de23ded
.quad 0xbdb5be00bdb50000,0x3db53e003db5238d,0xbdf5bd8e3c493db5,0x3dc63cc8bd71bded,0xbcc83d443dd53e00,0xbd8ebdedbdfbbdb5,0x3dc63dfb3df53db5,0xbde2bd8ebc493d44
.quad 0x3ded3db53d44238d,0x3d443db53ded3e00,0x3c49bcc8bd71bdb5,0x3df53dd53da23d44,0xbdd5bdedbdfbbe00,0xbcc8bd44bd8ebdb5,0xbde2bdd5bdc6bdb5,0xbdffbdfbbdf5bded
.quad 0x3e00238dbe000000,0x3e00238dbe000000,0xbd15bdfb3c493e00,0xbda2bdd53d713ded,0xbdd53d443dfb238d,0xbcc83ded3d8ebdb5,0x3dc63dd5bd15be00,0x3de2bcc8bdffbd44
.quad 0x3d44bdb5bded0000,0xbdedbdb53d443e00,0xbdffbd8e3d713e00,0x3d153dfb3da2bd44,0x3cc83ded3dd5238d,0x3d8ebd44bdfbbdb5,0x3de23cc8bda2be00,0xbdffbd8e3d153ded
.quad 0xbdb5be00bdb50000,0x3db53e003db5238d,0xbd713cc83dc63e00,0x3c49bd8ebdf5bded,0x3dfb3ded3d8e238d,0xbdd5bd443cc83db5,0xbc49bd8ebde2be00,0x3df53dfb3dc63d44
.quad 0xbdedbdb5bd440000,0xbd44bdb5bdedbe00,0x3da23dd53df53e00,0xbd71bcc83c493d44,0x3d8e3d443cc8238d,0x3dfb3ded3dd53db5,0xbdf5bdfbbdffbe00,0xbdc6bdd5bde2bded
.quad 0x3e00238dbe000000,0x3e00238dbe000000,0xbde2bd8e3dc63db5,0xbdffbcc83df53d44,0x3d8e3dedbcc8be00,0x3dfb3d44bdd5bdb5,0xbc49bdfbbd713db5,0xbdf5bd8e3da23ded
.quad 0xbd443db53ded238d,0x3ded3db5bd44be00,0x3dc6bcc8bdf5bdb5,0xbde2bdd53c493ded,0xbdfbbd443d8e3e00,0x3dd53ded3cc8bdb5,0x3df53dd53c49bdb5,0xbdc6bdfbbd713d44
.quad 0xbdb5be00bdb50000,0x3db53e003db5238d,0x3d153dd53dff3db5,0xbda2bdfbbde2bd44,0x3cc8bd44bdd5be00,0x3d8e3ded3dfb3db5,0xbda2bcc83d153db5,0xbd71bdd5bdffbded
.quad 0x3ded3db53d44238d,0x3d443db53ded3e00,0xbdffbdfbbde2bdb5,0xbd15bd8ebdc6bded,0x3dd53ded3dfb3e00,0x3cc83d443d8e3db5,0xbd71bd8ebda2bdb5,0xbc49bcc8bd15bd44
.quad 0x3e00238dbe000000,0x3e00238dbe000000,0xbdf53cc83dff238d,0xbdc63d8e3de2bd44,0x3dd5bd44bdfb0000,0x3cc8bdedbd8e3db5,0xbda23d8e3df5238d,0x3d713dfb3c49bded
.quad 0x3d44bdb5bded0000,0xbdedbdb53d443e00,0xbc493dd53de2238d,0x3df53cc8bdc6bded,0xbcc8bdedbdd50000,0xbd8e3d443dfb3db5,0x3d713dfb3dc6238d,0xbc49bdd5bdf5bd44
.quad 0xbdb5be00bdb50000,0x3db53e003db5238d,0x3de23dfb3da2238d,0xbdffbdd5bd153d44,0xbdfbbdedbd8e0000,0x3dd53d44bcc8bdb5,0x3dff3dd53d71238d,0xbd153cc83da23ded
.quad 0xbdedbdb5bd440000,0xbd44bdb5bdedbe00,0x3dc63d8e3d15238d,0x3de23dfb3dff3ded,0xbd8ebd44bcc80000,0xbdfbbdedbdd5bdb5,0x3d153cc83c49238d,0x3da23d8e3d713d44
.quad 0x3e00238dbe000000,0x3e00238dbe000000,0xbd713dd53da2bdb5,0xbc493dfb3d15bded,0xbd8ebded3cc83e00,0xbdfbbd443dd53db5,0x3dff3cc8bde2bdb5,0x3d15bdd5bdc63d44
.quad 0xbd443db53ded238d,0x3ded3db5bd44be00,0xbda2bdfbbd153db5,0xbd713d8e3dff3d44,0x3dfb3d44bd8ebe00,0xbdd5bdedbcc83db5,0xbd153d8e3dff3db5,0x3da2bcc8bde2bded
.quad 0xbdb5be00bdb50000,0x3db53e003db5238d,0x3df53d8ebc49bdb5,0xbdc6bcc83d713ded,0xbcc83d443dd53e00,0xbd8ebdedbdfbbdb5,0xbdc6bdfbbdf5bdb5,0x3de23d8e3c49bd44
.quad 0x3ded3db53d44238d,0x3d443db53ded3e00,0xbc493cc83d713db5,0xbdf5bdd5bda2bd44,0xbdd5bdedbdfbbe00,0xbcc8bd44bd8ebdb5,0x3de23dd53dc63db5,0x3dff3dfb3df53ded
.quad 0x3e00238dbe000000,0x3e00238dbe000000,0x3d153dfbbc49be00,0x3da23dd5bd71bded,0xbdd53d443dfb238d,0xbcc83ded3d8ebdb5,0xbdc6bdd53d153e00,0xbde23cc83dff3d44
.quad 0x3d44bdb5bded0000,0xbdedbdb53d443e00,0x3dff3d8ebd71be00,0xbd15bdfbbda23d44,0x3cc83ded3dd5238d,0x3d8ebd44bdfbbdb5,0xbde2bcc83da23e00,0x3dff3d8ebd15bded
.quad 0xbdb5be00bdb50000,0x3db53e003db5238d,0x3d71bcc8bdc6be00,0xbc493d8e3df53ded,0x3dfb3ded3d8e238d,0xbdd5bd443cc83db5,0x3c493d8e3de23e00,0xbdf5bdfbbdc6bd44
.quad 0xbdedbdb5bd440000,0xbd44bdb5bdedbe00,0xbda2bdd5bdf5be00,0x3d713cc8bc49bd44,0x3d8e3d443cc8238d,0x3dfb3ded3dd53db5,0x3df53dfb3dff3e00,0x3dc63dd53de23ded
.quad 0x3e00238dbe000000,0x3e00238dbe000000,0x3de23d8ebdc6bdb5,0x3dff3cc8bdf5bd44,0x3d8e3dedbcc8be00,0x3dfb3d44bdd5bdb5,0x3c493dfb3d71bdb5,0x3df53d8ebda2bded
.quad 0xbd443db53ded238d,0x3ded3db5bd44be00,0xbdc63cc83df53db5,0x3de23dd5bc49bded,0xbdfbbd443d8e3e00,0x3dd53ded3cc8bdb5,0xbdf5bdd5bc493db5,0x3dc63dfb3d71bd44
.quad 0xbdb5be00bdb50000,0x3db53e003db5238d,0xbd15bdd5bdffbdb5,0x3da23dfb3de23d44,0x3cc8bd44bdd5be00,0x3d8e3ded3dfb3db5,0x3da23cc8bd15bdb5,0x3d713dd53dff3ded
.quad 0x3ded3db53d44238d,0x3d443db53ded3e00,0x3dff3dfb3de23db5,0x3d153d8e3dc63ded,0x3dd53ded3dfb3e00,0x3cc83d443d8e3db5,0x3d713d8e3da23db5,0x3c493cc83d153d44
.quad 0x3e003e003e003e00,0x3e003e003e003e00,0x3dd53ded3dfb3e00,0xbdd5bdedbdfbbe00,0x3d443db53ded3e00,0x3d443db53ded3e00,0xbcc83d443dd53e00,0x3cc8bd44bdd5be00
.quad 0xbdb5230d3db53e00,0xbdb5230d3db53e00,0xbdfbbd443d8e3e00,0x3dfb3d44bd8ebe00,0xbdedbdb53d443e00,0xbdedbdb53d443e00,0xbd8ebded3cc83e00,0x3d8e3dedbcc8be00
.quad 0xa3d4be00230d3e00,0xa3d4be00230d3e00,0x3d8ebdedbcc83e00,0xbd8e3ded3cc8be00,0x3dedbdb5bd443e00,0x3dedbdb5bd443e00,0x3dfbbd44bd8e3e00,0xbdfb3d443d8ebe00
.quad 0x3db5a3d4bdb53e00,0x3db5a3d4bdb53e00,0x3cc83d44bdd53e00,0xbcc8bd443dd5be00,0xbd443db5bded3e00,0xbd443db5bded3e00,0xbdd53dedbdfb3e00,0x3dd5bded3dfbbe00
.quad 0x3e003e003e003e00,0x3e003e003e003e00,0x3cc83d443d8e3db5,0xbcc8bd44bd8ebdb5,0xbdedbdb5bd44230d,0xbdedbdb5bd44230d,0xbd8ebdedbdfbbdb5,0x3d8e3ded3dfb3db5
.quad 0x3db5a3d4bdb5be00,0x3db5a3d4bdb5be00,0x3dd53ded3cc8bdb5,0xbdd5bdedbcc83db5,0xbd443db53deda3d4,0xbd443db53deda3d4,0xbdfbbd443dd53db5,0x3dfb3d44bdd5bdb5
.quad 0xa3d4be00230d3e00,0xa3d4be00230d3e00,0x3dfbbd44bdd53db5,0xbdfb3d443dd5bdb5,0x3d443db5bded230d,0x3d443db5bded230d,0xbdd53dedbcc8bdb5,0x3dd5bded3cc83db5
.quad 0xbdb5230d3db5be00,0xbdb5230d3db5be00,0x3d8ebded3dfbbdb5,0xbd8e3dedbdfb3db5,0x3dedbdb53d44a3d4,0x3dedbdb53d44a3d4,0xbcc83d44bd8e3db5,0x3cc8bd443d8ebdb5
.quad 0x3e003e003e003e00,0x3e003e003e003e00,0xbd8ebd44bcc8230d,0x3d8e3d443cc8a3d4,0xbd44bdb5bdedbe00,0xbd44bdb5bdedbe00,0x3dfb3ded3d8ea3d4,0xbdfbbdedbd8e230d
.quad 0xbdb5230d3db53e00,0xbdb5230d3db53e00,0xbcc8bdedbdd5230d,0x3cc83ded3dd5a3d4,0x3ded3db5bd44be00,0x3ded3db5bd44be00,0xbdd53d443dfba3d4,0x3dd5bd44bdfb230d
.quad 0xa3d4be00230d3e00,0xa3d4be00230d3e00,0x3dd53d44bdfb230d,0xbdd5bd443dfba3d4,0xbded3db53d44be00,0xbded3db53d44be00,0x3cc8bded3dd5a3d4,0xbcc83dedbdd5230d
.quad 0x3db5a3d4bdb53e00,0x3db5a3d4bdb53e00,0xbdfb3dedbd8e230d,0x3dfbbded3d8ea3d4,0x3d44bdb53dedbe00,0x3d44bdb53dedbe00,0x3d8ebd443cc8a3d4,0xbd8e3d44bcc8230d
.quad 0x3e003e003e003e00,0x3e003e003e003e00,0xbdfbbdedbdd5bdb5,0x3dfb3ded3dd53db5,0x3ded3db53d44a3d4,0x3ded3db53d44a3d4,0xbdd5bd443cc83db5,0x3dd53d44bcc8bdb5
.quad 0x3db5a3d4bdb5be00,0x3db5a3d4bdb5be00,0xbd8e3d443dfb3db5,0x3d8ebd44bdfbbdb5,0x3d44bdb5bded230d,0x3d44bdb5bded230d,0xbcc83ded3d8ebdb5,0x3cc8bdedbd8e3db5
.quad 0xa3d4be00230d3e00,0xa3d4be00230d3e00,0x3cc83dedbd8ebdb5,0xbcc8bded3d8e3db5,0xbd44bdb53deda3d4,0xbd44bdb53deda3d4,0x3d8e3d44bdfb3db5,0xbd8ebd443dfbbdb5
.quad 0xbdb5230d3db5be00,0xbdb5230d3db5be00,0x3dd5bd44bcc83db5,0xbdd53d443cc8bdb5,0xbded3db5bd44230d,0xbded3db5bd44230d,0x3dfbbded3dd5bdb5,0xbdfb3dedbdd53db5
.quad 0xbe003e00be003e00,0xbe003e00be003e00,0xbdd53dedbdfb3e00,0x3dd5bded3dfbbe00,0xbd443db5bded3e00,0xbd443db5bded3e00,0x3cc83d44bdd53e00,0xbcc8bd443dd5be00
.quad 0x3db5230dbdb53e00,0x3db5230dbdb53e00,0x3dfbbd44bd8e3e00,0xbdfb3d443d8ebe00,0x3dedbdb5bd443e00,0x3dedbdb5bd443e00,0x3d8ebdedbcc83e00,0xbd8e3ded3cc8be00
.quad 0x230dbe00a3d43e00,0x230dbe00a3d43e00,0xbd8ebded3cc83e00,0x3d8e3dedbcc8be00,0xbdedbdb53d443e00,0xbdedbdb53d443e00,0xbdfbbd443d8e3e00,0x3dfb3d44bd8ebe00
.quad 0xbdb5a3d43db53e00,0xbdb5a3d43db53e00,0xbcc83d443dd53e00,0x3cc8bd44bdd5be00,0x3d443db53ded3e00,0x3d443db53ded3e00,0x3dd53ded3dfb3e00,0xbdd5bdedbdfbbe00
.quad 0xbe003e00be003e00,0xbe003e00be003e00,0xbcc83d44bd8e3db5,0x3cc8bd443d8ebdb5,0x3dedbdb53d44230d,0x3dedbdb53d44230d,0x3d8ebded3dfbbdb5,0xbd8e3dedbdfb3db5
.quad 0xbdb5a3d43db5be00,0xbdb5a3d43db5be00,0xbdd53dedbcc8bdb5,0x3dd5bded3cc83db5,0x3d443db5bdeda3d4,0x3d443db5bdeda3d4,0x3dfbbd44bdd53db5,0xbdfb3d443dd5bdb5
.quad 0x230dbe00a3d43e00,0x230dbe00a3d43e00,0xbdfbbd443dd53db5,0x3dfb3d44bdd5bdb5,0xbd443db53ded230d,0xbd443db53ded230d,0x3dd53ded3cc8bdb5,0xbdd5bdedbcc83db5
.quad 0x3db5230dbdb5be00,0x3db5230dbdb5be00,0xbd8ebdedbdfbbdb5,0x3d8e3ded3dfb3db5,0xbdedbdb5bd44a3d4,0xbdedbdb5bd44a3d4,0x3cc83d443d8e3db5,0xbcc8bd44bd8ebdb5
.quad 0xbe003e00be003e00,0xbe003e00be003e00,0x3d8ebd443cc8230d,0xbd8e3d44bcc8a3d4,0x3d44bdb53dedbe00,0x3d44bdb53dedbe00,0xbdfb3dedbd8ea3d4,0x3dfbbded3d8e230d
.quad 0x3db5230dbdb53e00,0x3db5230dbdb53e00,0x3cc8bded3dd5230d,0xbcc83dedbdd5a3d4,0xbded3db53d44be00,0xbded3db53d44be00,0x3dd53d44bdfba3d4,0xbdd5bd443dfb230d
.quad 0x230dbe00a3d43e00,0x230dbe00a3d43e00,0xbdd53d443dfb230d,0x3dd5bd44bdfba3d4,0x3ded3db5bd44be00,0x3ded3db5bd44be00,0xbcc8bdedbdd5a3d4,0x3cc83ded3dd5230d
.quad 0xbdb5a3d43db53e00,0xbdb5a3d43db53e00,0x3dfb3ded3d8e230d,0xbdfbbdedbd8ea3d4,0xbd44bdb5bdedbe00,0xbd44bdb5bdedbe00,0xbd8ebd44bcc8a3d4,0x3d8e3d443cc8230d
.quad 0xbe003e00be003e00,0xbe003e00be003e00,0x3dfbbded3dd5bdb5,0xbdfb3dedbdd53db5,0xbded3db5bd44a3d4,0xbded3db5bd44a3d4,0x3dd5bd44bcc83db5,0xbdd53d443cc8bdb5
.quad 0xbdb5a3d43db5be00,0xbdb5a3d43db5be00,0x3d8e3d44bdfb3db5,0xbd8ebd443dfbbdb5,0xbd44bdb53ded230d,0xbd44bdb53ded230d,0x3cc83dedbd8ebdb5,0xbcc8bded3d8e3db5
.quad 0x230dbe00a3d43e00,0x230dbe00a3d43e00,0xbcc83ded3d8ebdb5,0x3cc8bdedbd8e3db5,0x3d44bdb5bdeda3d4,0x3d44bdb5bdeda3d4,0xbd8e3d443dfb3db5,0x3d8ebd44bdfbbdb5
.quad 0x3db5230dbdb5be00,0x3db5230dbdb5be00,0xbdd5bd443cc83db5,0x3dd53d44bcc8bdb5,0x3ded3db53d44230d,0x3ded3db53d44230d,0xbdfbbdedbdd5bdb5,0x3dfb3ded3dd53db5
.quad 0x0,0x0,0x3d8e3d443cc80000,0xbd8ebd44bcc8238d,0x3ded3db53d440000,0x3ded3db53d440000,0x3dfb3ded3d8e0000,0xbdfbbdedbd8e238d
.quad 0x3db53e003db50000,0x3db53e003db50000,0x3cc83ded3dd50000,0xbcc8bdedbdd5238d,0xbd443db53ded0000,0xbd443db53ded0000,0xbdd53d443dfb0000,0x3dd5bd44bdfb238d
.quad 0xbe00238d3e000000,0xbe00238d3e000000,0xbdd5bd443dfb0000,0x3dd53d44bdfb238d,0xbd44bdb53ded0000,0xbd44bdb53ded0000,0x3cc8bded3dd50000,0xbcc83dedbdd5238d
.quad 0x3db5be003db50000,0x3db5be003db50000,0x3dfbbded3d8e0000,0xbdfb3dedbd8e238d,0x3dedbdb53d440000,0x3dedbdb53d440000,0x3d8ebd443cc80000,0xbd8e3d44bcc8238d
.quad 0x0,0x0,0x3dfb3ded3dd53db5,0xbdfbbdedbdd5bdb5,0x3d443db53ded3e00,0x3d443db53ded3e00,0xbdd5bd443cc83db5,0x3dd53d44bcc8bdb5
.quad 0xbdb5be00bdb5238d,0xbdb5be00bdb5238d,0x3d8ebd44bdfbbdb5,0xbd8e3d443dfb3db5,0x3ded3db5bd44be00,0x3ded3db5bd44be00,0xbcc83ded3d8ebdb5,0x3cc8bdedbd8e3db5
.quad 0xbe00238d3e000000,0xbe00238d3e000000,0xbcc8bded3d8e3db5,0x3cc83dedbd8ebdb5,0x3dedbdb5bd443e00,0x3dedbdb5bd443e00,0x3d8e3d44bdfb3db5,0xbd8ebd443dfbbdb5
.quad 0xbdb53e00bdb5238d,0xbdb53e00bdb5238d,0xbdd53d443cc8bdb5,0x3dd5bd44bcc83db5,0x3d44bdb53dedbe00,0x3d44bdb53dedbe00,0x3dfbbded3dd5bdb5,0xbdfb3dedbdd53db5
.quad 0x0,0x0,0x3dd53ded3dfb3e00,0xbdd5bdedbdfbbe00,0xbdedbdb5bd44238d,0xbdedbdb5bd44238d,0x3cc8bd44bdd5be00,0xbcc83d443dd53e00
.quad 0x3db53e003db50000,0x3db53e003db50000,0xbdfbbd443d8e3e00,0x3dfb3d44bd8ebe00,0x3d44bdb5bded238d,0x3d44bdb5bded238d,0x3d8e3dedbcc8be00,0xbd8ebded3cc83e00
.quad 0xbe00238d3e000000,0xbe00238d3e000000,0x3d8ebdedbcc83e00,0xbd8e3ded3cc8be00,0x3d443db5bded238d,0x3d443db5bded238d,0xbdfb3d443d8ebe00,0x3dfbbd44bd8e3e00
.quad 0x3db5be003db50000,0x3db5be003db50000,0x3cc83d44bdd53e00,0xbcc8bd443dd5be00,0xbded3db5bd44238d,0xbded3db5bd44238d,0x3dd5bded3dfbbe00,0xbdd53dedbdfb3e00
.quad 0x0,0x0,0x3cc83d443d8e3db5,0xbcc8bd44bd8ebdb5,0xbd44bdb5bdedbe00,0xbd44bdb5bdedbe00,0x3d8e3ded3dfb3db5,0xbd8ebdedbdfbbdb5
.quad 0xbdb5be00bdb5238d,0xbdb5be00bdb5238d,0x3dd53ded3cc8bdb5,0xbdd5bdedbcc83db5,0xbdedbdb53d443e00,0xbdedbdb53d443e00,0x3dfb3d44bdd5bdb5,0xbdfbbd443dd53db5
.quad 0xbe00238d3e000000,0xbe00238d3e000000,0x3dfbbd44bdd53db5,0xbdfb3d443dd5bdb5,0xbded3db53d44be00,0xbded3db53d44be00,0x3dd5bded3cc83db5,0xbdd53dedbcc8bdb5
.quad 0xbdb53e00bdb5238d,0xbdb53e00bdb5238d,0x3d8ebded3dfbbdb5,0xbd8e3dedbdfb3db5,0xbd443db5bded3e00,0xbd443db5bded3e00,0x3cc8bd443d8ebdb5,0xbcc83d44bd8e3db5
.quad 0x238d0000238d0000,0x238d0000238d0000,0xbd8e3d44bcc80000,0x3d8ebd443cc8238d,0xbded3db5bd440000,0xbded3db5bd440000,0xbdfb3dedbd8e0000,0x3dfbbded3d8e238d
.quad 0xbdb53e00bdb50000,0xbdb53e00bdb50000,0xbcc83dedbdd50000,0x3cc8bded3dd5238d,0x3d443db5bded0000,0x3d443db5bded0000,0x3dd53d44bdfb0000,0xbdd5bd443dfb238d
.quad 0x3e00238dbe000000,0x3e00238dbe000000,0x3dd5bd44bdfb0000,0xbdd53d443dfb238d,0x3d44bdb5bded0000,0x3d44bdb5bded0000,0xbcc8bdedbdd50000,0x3cc83ded3dd5238d
.quad 0xbdb5be00bdb50000,0xbdb5be00bdb50000,0xbdfbbdedbd8e0000,0x3dfb3ded3d8e238d,0xbdedbdb5bd440000,0xbdedbdb5bd440000,0xbd8ebd44bcc80000,0x3d8e3d443cc8238d
.quad 0x238d0000238d0000,0x238d0000238d0000,0xbdfb3dedbdd53db5,0x3dfbbded3dd5bdb5,0xbd443db5bded3e00,0xbd443db5bded3e00,0x3dd5bd44bcc83db5,0xbdd53d443cc8bdb5
.quad 0x3db5be003db5238d,0x3db5be003db5238d,0xbd8ebd443dfbbdb5,0x3d8e3d44bdfb3db5,0xbded3db53d44be00,0xbded3db53d44be00,0x3cc83dedbd8ebdb5,0xbcc8bded3d8e3db5
.quad 0x3e00238dbe000000,0x3e00238dbe000000,0x3cc8bdedbd8e3db5,0xbcc83ded3d8ebdb5,0xbdedbdb53d443e00,0xbdedbdb53d443e00,0xbd8e3d443dfb3db5,0x3d8ebd44bdfbbdb5
.quad 0x3db53e003db5238d,0x3db53e003db5238d,0x3dd53d44bcc8bdb5,0xbdd5bd443cc83db5,0xbd44bdb5bdedbe00,0xbd44bdb5bdedbe00,0xbdfbbdedbdd5bdb5,0x3dfb3ded3dd53db5
.quad 0x238d0000238d0000,0x238d0000238d0000,0xbdd53dedbdfb3e00,0x3dd5bded3dfbbe00,0x3dedbdb53d44238d,0x3dedbdb53d44238d,0xbcc8bd443dd5be00,0x3cc83d44bdd53e00
.quad 0xbdb53e00bdb50000,0xbdb53e00bdb50000,0x3dfbbd44bd8e3e00,0xbdfb3d443d8ebe00,0xbd44bdb53ded238d,0xbd44bdb53ded238d,0xbd8e3ded3cc8be00,0x3d8ebdedbcc83e00
.quad 0x3e00238dbe000000,0x3e00238dbe000000,0xbd8ebded3cc83e00,0x3d8e3dedbcc8be00,0xbd443db53ded238d,0xbd443db53ded238d,0x3dfb3d44bd8ebe00,0xbdfbbd443d8e3e00
.quad 0xbdb5be00bdb50000,0xbdb5be00bdb50000,0xbcc83d443dd53e00,0x3cc8bd44bdd5be00,0x3ded3db53d44238d,0x3ded3db53d44238d,0xbdd5bdedbdfbbe00,0x3dd53ded3dfb3e00
.quad 0x238d0000238d0000,0x238d0000238d0000,0xbcc83d44bd8e3db5,0x3cc8bd443d8ebdb5,0x3d44bdb53dedbe00,0x3d44bdb53dedbe00,0xbd8e3dedbdfb3db5,0x3d8ebded3dfbbdb5
.quad 0x3db5be003db5238d,0x3db5be003db5238d,0xbdd53dedbcc8bdb5,0x3dd5bded3cc83db5,0x3dedbdb5bd443e00,0x3dedbdb5bd443e00,0xbdfb3d443dd5bdb5,0x3dfbbd44bdd53db5
.quad 0x3e00238dbe000000,0x3e00238dbe000000,0xbdfbbd443dd53db5,0x3dfb3d44bdd5bdb5,0x3ded3db5bd44be00,0x3ded3db5bd44be00,0xbdd5bdedbcc83db5,0x3dd53ded3cc8bdb5
.quad 0x3db53e003db5238d,0x3db53e003db5238d,0xbd8ebdedbdfbbdb5,0x3d8e3ded3dfb3db5,0x3d443db53ded3e00,0x3d443db53ded3e00,0xbcc8bd44bd8ebdb5,0x3cc83d443d8e3db5
.quad 0x80003c0080003c00,0x80003c0080003c00,0x9a483c0080003c00,0xa0b63c009e483c00,0x9e483c0080003c00,0xa4b63c00a2483c00,0xa0b63c0080003c00,0xa7113bffa4b63c00
.quad 0xa2483c0080003c00,0xa8b63bffa6483bff,0xa3db3c0080003c00,0xa9e33bfea7da3bff,0xa4b63c0080003c00,0xab113bfda8b63bff,0xa57f3c0080003c00,0xac1f3bfca97f3bfe
.quad 0xa6483bff80003c00,0xacb53bfaaa483bfe,0xa7113bff80003c00,0xad4c3bf9ab113bfd,0xa7da3bff80003c00,0xade23bf7abd93bfc,0xa8523bff80003c00,0xae783bf6ac513bfb
.quad 0xa8b63bff80003c00,0xaf0e3bf4acb53bfa,0xa91b3bfe80003c00,0xafa43bf1ad1a3bf9,0xa97f3bfe80003c00,0xb01d3befad7e3bf8,0xa9e33bfe80003c00,0xb0673bedade23bf7
.quad 0x80003c0080003c00,0x80003c0080003c00,0xa3db3c00a2483c00,0xa57f3c00a4b63c00,0xa7da3bffa6483bff,0xa97f3bfea8b63bff,0xa9e33bfea8b63bff,0xac1f3bfcab113bfd
.quad 0xabd93bfcaa483bfe,0xad7e3bf8acb53bfa,0xace73bfaabd93bfc,0xaedc3bf4ade23bf7,0xade23bf7acb53bfa,0xb01d3befaf0e3bf4,0xaedc3bf4ad7e3bf8,0xb0cb3be9b01d3bef
.quad 0xafd63bf1ae463bf6,0xb1793be2b0b23bea,0xb0673bedaf0e3bf4,0xb2263bdab1473be4,0xb0e43be8afd63bf1,0xb2d23bd1b1db3bdd,0xb1603be3b04e3bed,0xb37d3bc7b26f3bd6
.quad 0xb1db3bddb0b23bea,0xb4143bbcb3033bce,0xb2573bd7b1153be6,0xb4693bb1b3963bc6,0xb2d23bd1b1793be2,0xb4bd3ba4b4143bbc,0xb34c3bcab1db3bdd,0xb5113b97b45d3bb2
.quad 0x80003c0080003c00,0x80003c0080003c00,0xa7113bffa6483bff,0xa8523bffa7da3bff,0xab113bfdaa483bfe,0xac513bfbabd93bfc,0xad4c3bf9acb53bfa,0xae783bf6ade23bf7
.quad 0xaf0e3bf4ae463bf6,0xb04e3bedafd63bf1,0xb0673bedafd63bf1,0xb1603be3b0e43be8,0xb1473be4b0b23bea,0xb26f3bd6b1db3bdd,0xb2263bdab1793be2,0xb37d3bc7b2d23bd1
.quad 0xb3033bceb23e3bd9,0xb4443bb6b3c63bc3,0xb3df3bc1b3033bce,0xb4c93ba2b45d3bb2,0xb45d3bb2b3c63bc3,0xb54c3b8cb4d53ba0,0xb4c93ba2b4443bb6,0xb5ce3b74b54c3b8c
.quad 0xb5343b91b4a53ba8,0xb64e3b5ab5c23b77,0xb59f3b7db5053b99,0xb6cc3b3eb6373b5f,0xb6083b69b5643b88,0xb7483b20b6aa3b46,0xb6703b53b5c23b77,0xb7c23affb71b3b2b
.quad 0x80003c0080003c00,0x80003c0080003c00,0xa91b3bfea8b63bff,0xa9e33bfea97f3bfe,0xad1a3bf9acb53bfa,0xade23bf7ad7e3bf8,0xafa43bf1af0e3bf4,0xb0673bedb01d3bef
.quad 0xb1153be6b0b23bea,0xb1db3bddb1793be2,0xb2573bd7b1db3bdd,0xb34c3bcab2d23bd1,0xb3963bc6b3033bce,0xb45d3bb2b4143bbc,0xb4693bb1b4143bbc,0xb5113b97b4bd3ba4
.quad 0xb5053b99b4a53ba8,0xb5c23b77b5643b88,0xb59f3b7db5343b91,0xb6703b53b6083b69,0xb6373b5fb5c23b77,0xb71b3b2bb6aa3b46,0xb6cc3b3eb64e3b5a,0xb7c23affb7483b20
.quad 0xb75e3b1ab6d73b3b,0xb8323ad0b7e33af6,0xb7ee3af3b75e3b1a,0xb8813a9cb83d3ac9,0xb83d3ac9b7e33af6,0xb8ce3a65b8873a99,0xb8813a9cb8323ad0,0xb9183a2bb8ce3a65
.quad 0xaa483bfe80003c00,0xb0b23beaae463bf6,0xaaac3bfd80003c00,0xb0fd3be7aeaa3bf5,0xab113bfd80003c00,0xb1473be4af0e3bf4,0xab753bfd80003c00,0xb1913be1af723bf2
.quad 0xabd93bfc80003c00,0xb1db3bddafd63bf1,0xac1f3bfc80003c00,0xb2263bdab01d3bef,0xac513bfb80003c00,0xb26f3bd6b04e3bed,0xac833bfb80003c00,0xb2b93bd2b0803bec
.quad 0xacb53bfa80003c00,0xb3033bceb0b23bea,0xace73bfa80003c00,0xb34c3bcab0e43be8,0xad1a3bf980003c00,0xb3963bc6b1153be6,0xad4c3bf980003c00,0xb3df3bc1b1473be4
.quad 0xad7e3bf880003c00,0xb4143bbcb1793be2,0xadb03bf880003c00,0xb4383bb7b1aa3be0,0xade23bf780003c00,0xb45d3bb2b1db3bdd,0xae143bf780003c00,0xb4813badb20d3bdb
.quad 0xb3c63bc3b23e3bd9,0xb5643b88b4a53ba8,0xb4203bbbb2a13bd4,0xb5b63b79b4ed3b9d,0xb45d3bb2b3033bce,0xb6083b69b5343b91,0xb4993baab3653bc9,0xb6593b58b57c3b84
.quad 0xb4d53ba0b3c63bc3,0xb6aa3b46b5c23b77,0xb5113b97b4143bbc,0xb6f93b33b6083b69,0xb54c3b8cb4443bb6,0xb7483b20b64e3b5a,0xb5873b82b4753baf,0xb7963b0bb6933b4b
.quad 0xb5c23b77b4a53ba8,0xb7e33af6b6d73b3b,0xb5fd3b6bb4d53ba0,0xb8173ae0b71b3b2b,0xb6373b5fb5053b99,0xb83d3ac9b75e3b1a,0xb6703b53b5343b91,0xb8623ab1b7a13b08
.quad 0xb6aa3b46b5643b88,0xb8873a99b7e33af6,0xb6e33b39b5933b80,0xb8ab3a7fb8123ae3,0xb71b3b2bb5c23b77,0xb8ce3a65b8323ad0,0xb7533b1db5f13b6e,0xb8f13a4bb8523abc
.quad 0xb6d73b3bb61f3b64,0xb81d3addb78b3b0e,0xb73d3b22b67c3b50,0xb8583ab8b7f93af0,0xb7a13b08b6d73b3b,0xb8913a92b8323ad0,0xb8023aedb7323b25,0xb8c93a69b8673aae
.quad 0xb8323ad0b78b3b0e,0xb9003a3fb89b3a8a,0xb8623ab1b7e33af6,0xb9353a13b8ce3a65,0xb8913a92b81d3add,0xb96939e5b9003a3f,0xb8bf3a71b8483ac2,0xb99b39b5b9303a17
.quad 0xb8ec3a4fb8723aa7,0xb9cb3984b95f39ed,0xb9183a2bb89b3a8a,0xb9fa3951b98d39c3,0xb9433a07b8c43a6d,0xba27391db9ba3996,0xb96d39e1b8ec3a4f,0xba5238e7b9e53969
.quad 0xb99639bab9133a2f,0xba7c38b0ba0f393a,0xb9be3992b93a3a0f,0xbaa33877ba373909,0xb9e53969b95f39ed,0xbac9383dba5e38d8,0xba0b393eb98439cb,0xbaed3802ba8338a6
.quad 0xb8c43a6db8723aa7,0xb95f39edb9133a2f,0xb9053a3bb8b03a7c,0xb9a439adb95639f6,0xb9433a07b8ec3a4f,0xb9e53969b99639ba,0xb98039d0b9273a1f,0xba233922b9d4397b
.quad 0xb9ba3996b95f39ed,0xba5e38d8ba0f393a,0xb9f2395bb99639ba,0xba95388cba4738f6,0xba27391db9cb3984,0xbac9383dba7c38b0,0xba5a38ddb9fe394d,0xbaf937d8baae3867
.quad 0xba8a389bba2f3913,0xbb253732badd381d,0xbab83858ba5e38d8,0xbb4e3687bb0837a1,0xbae33812ba8a389b,0xbb7235dabb303705,0xbb0b3796bab5385d,0xbb933529bb553665
.quad 0xbb303705badd381d,0xbbaf3475bb7735c2,0xbb533670bb0237b7,0xbbc7337dbb95351d,0xbb7235dabb253732,0xbbdb320dbbaf3475,0xbb8f3540bb4636aa,0xbbeb3099bbc63396
.quad 0x80003c0080003c00,0x80003c0080003c00,0xaaac3bfdaa483bfe,0xab753bfdab113bfd,0xaeaa3bf5ae463bf6,0xaf723bf2af0e3bf4,0xb0fd3be7b0b23bea,0xb1913be1b1473be4
.quad 0xb2a13bd4b23e3bd9,0xb3653bc9b3033bce,0xb4203bbbb3c63bc3,0xb4993baab45d3bb2,0xb4ed3b9db4a53ba8,0xb57c3b84b5343b91,0xb5b63b79b5643b88,0xb6593b58b6083b69
.quad 0xb67c3b50b61f3b64,0xb7323b25b6d73b3b,0xb73d3b22b6d73b3b,0xb8023aedb7a13b08,0xb7f93af0b78b3b0e,0xb8673aaeb8323ad0,0xb8583ab8b81d3add,0xb8c93a69b8913a92
.quad 0xb8b03a7cb8723aa7,0xb9273a1fb8ec3a4f,0xb9053a3bb8c43a6d,0xb98039d0b9433a07,0xb95639f6b9133a2f,0xb9d4397bb99639ba,0xb9a439adb95f39ed,0xba233922b9e53969
.quad 0x80003c0080003c00,0x80003c0080003c00,0xac1f3bfcabd93bfc,0xac833bfbac513bfb,0xb01d3befafd63bf1,0xb0803becb04e3bed,0xb2263bdab1db3bdd,0xb2b93bd2b26f3bd6
.quad 0xb4143bbcb3c63bc3,0xb4753bafb4443bb6,0xb5113b97b4d53ba0,0xb5873b82b54c3b8c,0xb6083b69b5c23b77,0xb6933b4bb64e3b5a,0xb6f93b33b6aa3b46,0xb7963b0bb7483b20
.quad 0xb7e33af6b78b3b0e,0xb8483ac2b81d3add,0xb8623ab1b8323ad0,0xb8bf3a71b8913a92,0xb8ce3a65b89b3a8a,0xb9303a17b9003a3f,0xb9353a13b9003a3f,0xb99b39b5b96939e5
.quad 0xb99639bab95f39ed,0xb9fe394db9cb3984,0xb9f2395bb9ba3996,0xba5a38ddba27391d,0xba4738f6ba0f393a,0xbaae3867ba7c38b0,0xba95388cba5e38d8,0xbaf937d8bac9383d
.quad 0x80003c0080003c00,0x80003c0080003c00,0xace73bfaacb53bfa,0xad4c3bf9ad1a3bf9,0xb0e43be8b0b23bea,0xb1473be4b1153be6,0xb34c3bcab3033bce,0xb3df3bc1b3963bc6
.quad 0xb4d53ba0b4a53ba8,0xb5343b91b5053b99,0xb5fd3b6bb5c23b77,0xb6703b53b6373b5f,0xb71b3b2bb6d73b3b,0xb7a13b08b75e3b1a,0xb8173ae0b7e33af6,0xb8623ab1b83d3ac9
.quad 0xb89b3a8ab8723aa7,0xb8ec3a4fb8c43a6d,0xb9183a2bb8ec3a4f,0xb96d39e1b9433a07,0xb98d39c3b95f39ed,0xb9e53969b9ba3996,0xb9fa3951b9cb3984,0xba5238e7ba27391d
.quad 0xba5e38d8ba2f3913,0xbab5385dba8a389b,0xbab83858ba8a389b,0xbb0b3796bae33812,0xbb0837a1badd381d,0xbb553665bb303705,0xbb4e3687bb253732,0xbb933529bb7235da
.quad 0x80003c0080003c00,0x80003c0080003c00,0xadb03bf8ad7e3bf8,0xae143bf7ade23bf7,0xb1aa3be0b1793be2,0xb20d3bdbb1db3bdd,0xb4383bb7b4143bbc,0xb4813badb45d3bb2
.quad 0xb5933b80b5643b88,0xb5f13b6eb5c23b77,0xb6e33b39b6aa3b46,0xb7533b1db71b3b2b,0xb8123ae3b7e33af6,0xb8523abcb8323ad0,0xb8ab3a7fb8873a99,0xb8f13a4bb8ce3a65
.quad 0xb93a3a0fb9133a2f,0xb98439cbb95f39ed,0xb9be3992b99639ba,0xba0b393eb9e53969,0xba373909ba0f393a,0xba8338a6ba5e38d8,0xbaa33877ba7c38b0,0xbaed3802bac9383d
.quad 0xbb0237b7badd381d,0xbb4636aabb253732,0xbb533670bb303705,0xbb8f3540bb7235da,0xbb95351dbb7735c2,0xbbc63396bbaf3475,0xbbc7337dbbaf3475,0xbbeb3099bbdb320d
.quad 0xb9ed395fb9a839a8,0xba6d38c4ba2f3913,0xba33390eb9ed395f,0xbab13862ba7438ba,0xba7438baba2f3913,0xbaf037f9bab5385d,0xbab13862ba6d38c4,0xbb283726baf037f9
.quad 0xbae93807baa73872,0xbb5a364ebb253732,0xbb1d3753badd381d,0xbb863570bb553665,0xbb4b3693bb0e378b,0xbbab348dbb803593,0xbb7435cebb3b36d7,0xbbca334cbba434bd
.quad 0xbb993505bb64361f,0xbbe23179bbc333c6,0xbbb73438bb883564,0xbbf32f40bbdb320d,0xbbd132d2bba834a5,0xbbfd2b11bbed304e,0xbbe5312ebbc333c6,0xbc009a48bbf92d1a
.quad 0xbbf42f0ebbd9323e,0xbbfcabd9bbff2648,0xbbfd2b75bbea30b2,0xbbf1afa4bbffa7da,0xbc001e48bbf62e46,0xbbe0b1aabbf8ad7e,0xbbfea9e3bbfe2a48,0xbbc7b37dbbecb080
.quad 0xbadd381dbaa73872,0xbb3b36d7bb0e378b,0xbb1d3753bae93807,0xbb7435cebb4b3693,0xbb553665bb253732,0xbba434bdbb803593,0xbb863570bb5a364e,0xbbca334cbbab348d
.quad 0xbbaf3475bb883564,0xbbe63115bbce3303,0xbbd032eabbaf3475,0xbbf82db0bbe830e4,0xbbe830e4bbce3303,0xbc0024b6bbf82d7e,0xbbf82db0bbe63115,0xbbfdaaacbc0024b6
.quad 0xbbff2648bbf62e46,0xbbf1afd6bbfeaa48,0xbbfea91bbbff28b6,0xbbdab226bbf2af72,0xbbf5aeaabbffa648,0xbbb9b42cbbddb1db,0xbbe3b160bbf8ad7e,0xbb8fb540bbc0b3f7
.quad 0xbbc9b365bbeab0b2,0xbb5ab64ebb99b505,0xbba6b4b1bbd4b2a1,0xbb1db753bb69b608,0xbb7bb5abbbb6b444,0xbad6b828bb30b705,0xbb49b69ebb91b534,0xba87b8a0baf0b7f9
.quad 0xbb883564bb64361f,0xbbc333c6bba834a5,0xbbb73438bb993505,0xbbe5312ebbd132d2,0xbbdb320dbbc333c6,0xbbf92d1abbed304e,0xbbf32f40bbe23179,0xbc009a48bbfd2b11
.quad 0xbbff28b6bbf62e46,0xbbf8ad7ebbffa648,0xbbfea91bbbff2648,0xbbe3b160bbf5aeaa,0xbbf2af72bbfeaa48,0xbbc0b3f7bbddb1db,0xbbdab226bbf1afd6,0xbb8fb540bbb9b42c
.quad 0xbbb6b444bbd9b23e,0xbb50b67cbb88b564,0xbb86b570bbb6b444,0xbb05b7acbb4bb693,0xbb4bb693bb88b564,0xbaaeb867bb02b7b7,0xbb05b7acbb50b67c,0xba4bb8f1baaeb867
.quad 0xbab5b85dbb0eb78b,0xb9dcb972ba4fb8ec,0xba5ab8ddbac2b848,0xb964b9e9b9e5b969,0xb9f6b956ba6db8c4,0xb8e2ba56b972b9dc,0xb989b9c7ba0fb93a,0xb858bab8b8f6ba47
.quad 0xbbea30b2bbd9323e,0xbbfe2a48bbf62e46,0xbbfd2b75bbf42f0e,0xbbfea9e3bc001e48,0xbbffa7dabbff2648,0xbbecb080bbf8ad7e,0xbbf1afa4bbfcabd9,0xbbc7b37dbbe0b1aa
.quad 0xbbd4b2a1bbeab0b2,0xbb91b534bbb6b444,0xbba6b4b1bbc9b365,0xbb49b69ebb7bb5ab,0xbb69b608bb99b505,0xbaf0b7f9bb30b705,0xbb1db753bb5ab64e,0xba87b8a0bad6b828
.quad 0xbac2b848bb0eb78b,0xba0fb93aba6db8c4,0xba5ab8ddbab5b85d,0xb989b9c7b9f6b956,0xb9e5b969ba4fb8ec,0xb8f6ba47b972b9dc,0xb964b9e9b9dcb972,0xb858bab8b8e2ba56
.quad 0xb8d8ba5eb95fb9ed,0xb75ebb1ab848bac2,0xb842bac6b8d8ba5e,0xb5fdbb6bb748bb20,0xb748bb20b848bac2,0xb48dbbabb5f1bb6e,0xb5fdbb6bb75ebb1a,0xb226bbdab48dbbab
.quad 0x80003c0080003c00,0x80003c0080003c00,0xae783bf6ae463bf6,0xaedc3bf4aeaa3bf5,0xb26f3bd6b23e3bd9,0xb2d23bd1b2a13bd4,0xb4c93ba2b4a53ba8,0xb5113b97b4ed3b9d
.quad 0xb64e3b5ab61f3b64,0xb6aa3b46b67c3b50,0xb7c23affb78b3b0e,0xb8173ae0b7f93af0,0xb8913a92b8723aa7,0xb8ce3a65b8b03a7c,0xb9353a13b9133a2f,0xb97639d8b95639f6
.quad 0xb9cb3984b9a839a8,0xba0f393ab9ed395f,0xba5238e7ba2f3913,0xba95388cba7438ba,0xbac9383dbaa73872,0xbb0837a1bae93807,0xbb2e3710bb0e378b,0xbb673614bb4b3693
.quad 0xbb803593bb64361f,0xbbaf3475bb993505,0xbbbe3408bba834a5,0xbbe13191bbd132d2,0xbbe830e4bbd9323e,0xbbfb2c51bbf42f0e,0xbbfd2aacbbf62e46,0xbbfea91bbc001e48
.quad 0x80003c0080003c00,0x80003c0080003c00,0xaf403bf3af0e3bf4,0xafa43bf1af723bf2,0xb3343bcbb3033bce,0xb3963bc6b3653bc9,0xb5583b8ab5343b91,0xb59f3b7db57c3b84
.quad 0xb7053b30b6d73b3b,0xb75e3b1ab7323b25,0xb84d3abfb8323ad0,0xb8813a9cb8673aae,0xb9093a37b8ec3a4f,0xb9433a07b9273a1f,0xb9b5399bb99639ba,0xb9f2395bb9d4397b
.quad 0xba4f38ecba2f3913,0xba8a389bba6d38c4,0xbad3382dbab5385d,0xbb0b3796baf037f9,0xbb4136c1bb253732,0xbb7235dabb5a364e,0xbb973511bb803593,0xbbbe3408bbab348d
.quad 0xbbd432a1bbc333c6,0xbbed304ebbe23179,0xbbf72e14bbed304e,0xbc0023dbbbfd2b11,0xbc00a4b6bbff2648,0xbbf5aeaabbfcabd9,0xbbeeb036bbf8ad7e,0xbbcdb31bbbe0b1aa
.quad 0x80003c0080003c00,0x80003c0080003c00,0xb0043bf0afd63bf1,0xb0363beeb01d3bef,0xb3f73bc0b3c63bc3,0xb42c3bb9b4143bbc,0xb5e53b70b5c23b77,0xb62b3b62b6083b69
.quad 0xb7b73b02b78b3b0e,0xb8073ae9b7e33af6,0xb8b53a78b89b3a8a,0xb8e73a52b8ce3a65,0xb97b39d4b95f39ed,0xb9b1399fb99639ba,0xba2b3918ba0f393a,0xba6238d3ba4738f6
.quad 0xbac23848baa73872,0xbaf637e3badd381d,0xbb3e36ccbb253732,0xbb6b35fdbb553665,0xbb9d34edbb883564,0xbbc033f7bbaf3475,0xbbdc31f4bbce3303,0xbbf12fa4bbe830e4
.quad 0xbbfc2bd9bbf62e46,0xbc00a248bbff2648,0xbbfcac1fbbffa648,0xbbebb099bbf5aeaa,0xbbdbb20dbbeab0b2,0xbbb2b45dbbc9b365,0xbb9bb4f9bbb6b444,0xbb58b659bb7bb5ab
.quad 0x80003c0080003c00,0x80003c0080003c00,0xb0673bedb04e3bed,0xb0993bebb0803bec,0xb45d3bb2b4443bb6,0xb48d3babb4753baf,0xb6703b53b64e3b5a,0xb6b53b43b6933b4b
.quad 0xb8323ad0b81d3add,0xb85d3ab5b8483ac2,0xb9183a2bb9003a3f,0xb9483a02b9303a17,0xb9e53969b9cb3984,0xba173930b9fe394d,0xba95388cba7c38b0,0xbac63842baae3867
.quad 0xbb253732bb0e378b,0xbb50367cbb3b36d7,0xbb933529bb803593,0xbbb43451bba434bd,0xbbdb320dbbce3303,0xbbef301dbbe63115,0xbbfd2aacbbf82d7e,0xbc00a3dbbc0024b6
.quad 0xbbf8ad7ebbfeaa48,0xbbe6b115bbf1afd6,0xbbcdb31bbbddb1db,0xbba2b4c9bbb9b42c,0xbb7bb5abbb99b505,0xbb36b6eebb5ab64e,0xbb05b7acbb30b705,0xbaa3b877bad6b828
.quad 0xbbfeaa48bc000000,0xbbeab0b2bbf6ae46,0xbbe9b0cbbbf6ae46,0xbbbeb408bbd6b26f,0xbbc0b3f7bbd9b23e,0xbb7bb5abbba0b4d5,0xbb82b587bba8b4a5,0xbb22b73dbb55b665
.quad 0xbb30b705bb64b61f,0xbab5b85dbaf6b7e3,0xbaccb838bb0eb78b,0xba33b90eba83b8a6,0xba56b8e2baa7b872,0xb99fb9b1b9feb94d,0xb9d0b980ba2fb913,0xb8fbba43b969b9e5
.quad 0xb93aba0fb9a8b9a8,0xb848bac2b8c4ba6d,0xb896ba8eb913ba2f,0xb710bb2eb812bae3,0xb7cdbafcb872baa7,0xb57cbb84b6aabb46,0xb659bb58b78bbb0e,0xb3aebbc4b51dbb95
.quad 0xb4d5bba0b61fbb64,0xb04ebbedb303bbce,0xb288bbd5b4a5bba8,0xa711bbffaf72bbf2,0xaeaabbf5b23ebbd9,0x2d1abbf9a248bc00,0x9a48bc00ae46bbf6,0x31f4bbdc2de2bbf7
.quad 0xbbc3b3c6bbd9b23e,0xbb88b564bba8b4a5,0xbb7db59fbba0b4d5,0xbb28b726bb55b665,0xbb20b748bb50b67c,0xbaaeb867bae9b807,0xbaaab86dbae9b807,0xba1bb92bba65b8ce
.quad 0xba1fb927ba6db8c4,0xb972b9dcb9cbb984,0xb980b9d0b9dcb972,0xb8b5ba78b91dba27,0xb8ceba65b93aba0f,0xb7cdbafcb85dbab5,0xb80dbae6b887ba99,0xb614bb67b71bbb2b
.quad 0xb67cbb50b78bbb0e,0xb444bbb6b564bb88,0xb4c9bba2b5f1bb6e,0xb0cbbbe9b334bbcb,0xb20dbbdbb444bbb6,0xa7dabbffaf0ebbf4,0xace7bbfab115bbe6,0x2db0bbf81e48bc00
.quad 0x28b6bbffaa48bbfe,0x32a1bbd42fd6bbf1,0x30cbbbe92bd9bbfc,0x3529bb933396bbc6,0x342cbbb93179bbe2,0x36eebb363593bb80,0x35e5bb703475bbaf,0x384dbabf3748bb20
.quad 0xbb3bb6d7bb64b61f,0xbaddb81dbb0eb78b,0xbabfb84dbaf6b7e3,0xba43b8fbba83b8a6,0xba27b91dba6db8c4,0xb98db9c3b9dcb972,0xb976b9d8b9cbb984,0xb8bfba71b91dba27
.quad 0xb8b0ba7cb913ba2f,0xb7b7bb02b848bac2,0xb7acbb05b848bac2,0xb5cebb74b6c1bb41,0xb5dabb72b6d7bb3b,0xb396bbc6b4d5bba0,0xb3dfbbc1b505bb99,0xaedcbbf4b1aabbe0
.quad 0xafd6bbf1b23ebbd9,0x2648bbffaa48bbfe,0x1a48bc00acb5bbfa,0x30fdbbe72d1abbf9,0x301dbbef2a48bbfe,0x348dbbab32a1bbd4,0x3408bbbe3179bbe2,0x3687bb4e354cbb8c
.quad 0x35f1bb6e34a5bba8,0x3832bad03732bb25,0x37c2baff367cbb50,0x390eba33387cbaa0,0x38baba74381dbadd,0x39d4b97b394db9fe,0x3980b9d038ecba4f,0x3a7fb8ab3a07b943
.quad 0xba6db8c4baa7b872,0xb9edb95fba2fb913,0xb9b5b99bb9feb94d,0xb918ba2bb969b9e5,0xb8e2ba56b93aba0f,0xb828bad6b887ba99,0xb7eebaf3b85dbab5,0xb642bb5db71bbb2b
.quad 0xb5f1bb6eb6d7bb3b,0xb414bbbcb505bb99,0xb3aebbc4b4d5bba0,0xaf40bbf3b1aabbe0,0xaeaabbf5b179bbe2,0x27dabbffa8b6bbff,0x2852bbffa8b6bbff,0x3191bbe12eaabbf5
.quad 0x3179bbe22e46bbf6,0x3505bb9933c6bbc3,0x34e1bb9e3365bbc9,0x3726bb283608bb69,0x36eebb3635c2bb77,0x3891ba923807bae9,0x386dbaaa37b7bb02,0x3976b9d838f6ba47
.quad 0x394db9fe38c4ba6d,0x3a3fb90039cbb984,0x3a13b9353996b9ba,0x3ae6b80d3a83b8a6,0x3abcb8523a4fb8ec,0x3b69b6083b1ab75e,0x3b43b6b53ae9b807,0x3bc4b3ae3b8cb54c
.quad 0x80003c0080003c00,0x80003c0080003c00,0xb0cb3be9b0b23bea,0xb0fd3be7b0e43be8,0xb4bd3ba4b4a53ba8,0xb4ed3b9db4d53ba0,0xb6f93b33b6d73b3b,0xb73d3b22b71b3b2b
.quad 0xb8873a99b8723aa7,0xb8b03a7cb89b3a8a,0xb97639d8b95f39ed,0xb9a439adb98d39c3,0xba4738f6ba2f3913,0xba7438baba5e38d8,0xbaf337eebadd381d,0xbb1d3753bb0837a1
.quad 0xbb7735c2bb64361f,0xbb993505bb883564,0xbbd032eabbc333c6,0xbbe5312ebbdb320d,0xbbfb2c51bbf62e46,0xbc001e48bbff28b6,0xbbf9ad4cbbfeaa48,0xbbe9b0cbbbf2af72
.quad 0xbbc9b365bbd9b23e,0xbba0b4d5bbb6b444,0xbb6bb5fdbb88b564,0xbb28b726bb4bb693,0xbae3b812bb0eb78b,0xba83b8a6bab5b85d,0xba33b90eba6db8c4,0xb9b5b99bb9f6b956
.quad 0x80003c0080003c00,0x80003c0080003c00,0xb12e3be5b1153be6,0xb1603be3b1473be4,0xb51d3b95b5053b99,0xb54c3b8cb5343b91,0xb7803b11b75e3b1a,0xb7c23affb7a13b08
.quad 0xb8d83a5eb8c43a6d,0xb9003a3fb8ec3a4f,0xb9d03980b9ba3996,0xb9fa3951b9e53969,0xbaa0387cba8a389b,0xbac9383dbab5385d,0xbb4336b5bb303705,0xbb673614bb553665
.quad 0xbbb63444bba834a5,0xbbce3303bbc333c6,0xbbf42edcbbed304e,0xbbfd2aacbbf92d1a,0xbbfdab11bbffa648,0xbbf2af72bbf8ad7e,0xbbd0b2eabbddb1db,0xbbadb481bbc0b3f7
.quad 0xbb6eb5f1bb88b564,0xbb30b705bb50b67c,0xbad9b822bb02b7b7,0xba7fb8abbaaeb867,0xba17b930ba4fb8ec,0xb99fb9b1b9dcb972,0xb92bba1bb972b9dc,0xb896ba8eb8e2ba56
.quad 0x80003c0080003c00,0x80003c0080003c00,0xb1913be1b1793be2,0xb1c33bdfb1aa3be0,0xb57c3b84b5643b88,0xb5ab3b7bb5933b80,0xb8023aedb7e33af6,0xb8223ad9b8123ae3
.quad 0xb9273a1fb9133a2f,0xb94d39feb93a3a0f,0xba233922ba0f393a,0xba4b38f1ba373909,0xbaf037f9badd381d,0xbb143775bb0237b7,0xbb863570bb7735c2,0xbba234c9bb95351d
.quad 0xbbe23179bbd9323e,0xbbf12fd6bbea30b2,0xbc009a48bbff2648,0xbbfdab75bbffa7da,0xbbe0b1aabbeab0b2,0xbbc6b396bbd4b2a1,0xbb82b587bb99b505,0xbb4eb687bb69b608
.quad 0xbae9b807bb0eb78b,0xba99b887bac2b848,0xba1bb92bba4fb8ec,0xb9adb9a4b9e5b969,0xb91dba27b95fb9ed,0xb891ba92b8d8ba5e,0xb7eebaf3b848bac2,0xb69ebb49b748bb20
.quad 0x80003c0080003c00,0x80003c0080003c00,0xb1f43bdcb1db3bdd,0xb2263bdab20d3bdb,0xb5da3b72b5c23b77,0xb6083b69b5f13b6e,0xb8423ac6b8323ad0,0xb8623ab1b8523abc
.quad 0xb97239dcb95f39ed,0xb99639bab98439cb,0xba7138bfba5e38d8,0xba95388cba8338a6,0xbb3636eebb253732,0xbb553665bb4636aa,0xbbbb3420bbaf3475,0xbbd032eabbc63396
.quad 0xbbfa2cb5bbf62e46,0xbbff2648bbfe2a48,0xbbf3af40bbf8ad7e,0xbbe3b160bbecb080,0xbba4b4bdbbb6b444,0xbb7bb5abbb91b534,0xbb11b780bb30b705,0xbaccb838baf0b7f9
.quad 0xba3fb900ba6db8c4,0xb9dcb972ba0fb93a,0xb935ba13b972b9dc,0xb8b5ba78b8f6ba47,0xb7f9baf0b848bac2,0xb6c1bb41b75ebb1a,0xb540bb8fb5f1bb6e,0xb3aebbc4b48dbbab
.quad 0xb95fb9edb9a8b9a8,0xb8c4ba6db913ba2f,0xb86dbaaab8c4ba6d,0xb76abb17b812bae3,0xb6c1bb41b78bbb0e,0xb51dbb95b5f1bb6e,0xb481bbadb564bb88,0xb160bbe3b334bbcb
.quad 0xb04ebbedb23ebbd9,0xa248bc00acb5bbfa,0x23dbbc00aa48bbfe,0x3099bbeb2d1abbf9,0x3147bbe42e46bbf6,0x34bdbba43365bbc9,0x34f9bb9b33c6bbc3,0x3710bb2e3608bb69
.quad 0x3732bb25361fbb64,0x389bba8a381dbadd,0x38a0ba87381dbadd,0x3992b9be391dba27,0x398db9c33913ba2f,0x3a65b8ce39feb94d,0x3a5ab8dd39edb95f,0x3b11b7803abcb852
.quad 0x3b02b7b73aa7b872,0x3b91b5343b50b67c,0x3b82b5873b3bb6d7,0x3be1b1913bb9b42c,0x3bd6b26f3ba8b4a5,0x3c00a4b63bf4af0e,0x3bfdaaac3beab0b2,0x3bed30673bfe297f
.quad 0xb81dbaddb872baa7,0xb6d7bb3bb78bbb0e,0xb5e5bb70b6aabb46,0xb451bbb4b51dbb95,0xb2d2bbd1b444bbb6,0xaeaabbf5b115bbe6,0xaaacbbfdaf0ebbf4,0x2c1fbbfc1e48bc00
.quad 0x2f0ebbf42a48bbfe,0x3365bbc93179bbe2,0x3451bbb432a1bbd4,0x3642bb5d354cbb8c,0x36c1bb4135c2bb77,0x3852babc37b7bb02,0x3881ba9c3807bae9,0x3964b9e938f6ba47
.quad 0x3984b9cb3913ba2f,0x3a4fb8ec39edb95f,0x3a62b8d339feb94d,0x3b0bb7963abcb852,0x3b14b7753ac2b848,0x3b95b51d3b5ab64e,0x3b97b5113b5ab64e,0x3be7b0fd3bc6b396
.quad 0x3be6b1153bc3b3c6,0x3c0022483bfaacb5,0x3c001a483bf8ad7e,0x3bdf31c33bf72de2,0x3be431473bfa2cb5,0x3b84357c3bbc3414,0x3b9335293bc93365,0x3af337ee3b4b3693
.quad 0xb564bb88b61fbb64,0xb3c6bbc3b4a5bba8,0xb160bbe3b303bbce,0xac1fbbfcaf72bbf2,0x1e48bc00aa48bbfe,0x2f72bbf22bd9bbfc,0x31c3bbdf2fd6bbf1,0x34b1bba63396bbc6
.quad 0x3593bb8034a5bba8,0x375ebb1a367cbb50,0x380dbae63732bb25,0x38e7ba52387cbaa0,0x3930ba1738c4ba6d,0x39f6b9563996b9ba,0x3a2bb91839cbb984,0x3ad3b82d3a83b8a6
.quad 0x3af6b7e33aa7b872,0x3b77b5c23b3bb6d7,0x3b8ab5583b50b67c,0x3bdcb1f43bb9b42c,0x3be4b1473bc3b3c6,0x3c009e483bf8ad7e,0x3c0020b63bfaacb5,0x3be131913bf72de2
.quad 0x3bdd31db3bf62e46,0x3b8035933bb63444,0x3b7d359f3bb63444,0x3ae038173b3636ee,0x3ae338123b3b36d7,0x3a0739433a7c38b0,0x3a1339353a8a389b,0x38fb3a43398d39c3
.quad 0xb0b2bbeab23ebbd9,0xaa48bbfeae46bbf6,0x291bbbfea248bc00,0x3099bbeb2de2bbf7,0x3334bbcb3179bbe2,0x354cbb8c3475bbaf,0x3670bb533593bb80,0x380dbae63748bb20
.quad 0x3887ba99381dbadd,0x394db9fe38ecba4f,0x39adb9a4394db9fe,0x3a5ab8dd3a07b943,0x3aa0b87c3a4fb8ec,0x3b2bb71b3ae9b807,0x3b58b6593b1ab75e,0x3bb7b4383b8cb54c
.quad 0x3bceb3033ba8b4a5,0x3bfaacb53beab0b2,0x3bffa8523bf4af0e,0x3bf12fa43bfe297f,0x3be830e43bfa2cb5,0x3b9d34ed3bc93365,0x3b8a35583bbc3414,0x3aff37c23b4b3693
.quad 0x3ae938073b3b36d7,0x3a1f39273a8a389b,0x3a0b393e3a7c38b0,0x39053a3b398d39c3,0x38f63a47398439cb,0x37753b14385d3ab5,0x376a3b17385d3ab5,0x34993baa36083b69
.quad 0x3c0000003c00,0x3c0000003c00,0x1a483c0000003c00,0x20b63c001e483c00,0x1e483c0000003c00,0x24b63c0022483c00,0x20b63c0000003c00,0x27113bff24b63c00
.quad 0x22483c0000003c00,0x28b63bff26483bff,0x23db3c0000003c00,0x29e33bfe27da3bff,0x24b63c0000003c00,0x2b113bfd28b63bff,0x257f3c0000003c00,0x2c1f3bfc297f3bfe
.quad 0x26483bff00003c00,0x2cb53bfa2a483bfe,0x27113bff00003c00,0x2d4c3bf92b113bfd,0x27da3bff00003c00,0x2de23bf72bd93bfc,0x28523bff00003c00,0x2e783bf62c513bfb
.quad 0x28b63bff00003c00,0x2f0e3bf42cb53bfa,0x291b3bfe00003c00,0x2fa43bf12d1a3bf9,0x297f3bfe00003c00,0x301d3bef2d7e3bf8,0x29e33bfe00003c00,0x30673bed2de23bf7
.quad 0x3c0000003c00,0x3c0000003c00,0x23db3c0022483c00,0x257f3c0024b63c00,0x27da3bff26483bff,0x297f3bfe28b63bff,0x29e33bfe28b63bff,0x2c1f3bfc2b113bfd
.quad 0x2bd93bfc2a483bfe,0x2d7e3bf82cb53bfa,0x2ce73bfa2bd93bfc,0x2edc3bf42de23bf7,0x2de23bf72cb53bfa,0x301d3bef2f0e3bf4,0x2edc3bf42d7e3bf8,0x30cb3be9301d3bef
.quad 0x2fd63bf12e463bf6,0x31793be230b23bea,0x30673bed2f0e3bf4,0x32263bda31473be4,0x30e43be82fd63bf1,0x32d23bd131db3bdd,0x31603be3304e3bed,0x337d3bc7326f3bd6
.quad 0x31db3bdd30b23bea,0x34143bbc33033bce,0x32573bd731153be6,0x34693bb133963bc6,0x32d23bd131793be2,0x34bd3ba434143bbc,0x334c3bca31db3bdd,0x35113b97345d3bb2
.quad 0x3c0000003c00,0x3c0000003c00,0x27113bff26483bff,0x28523bff27da3bff,0x2b113bfd2a483bfe,0x2c513bfb2bd93bfc,0x2d4c3bf92cb53bfa,0x2e783bf62de23bf7
.quad 0x2f0e3bf42e463bf6,0x304e3bed2fd63bf1,0x30673bed2fd63bf1,0x31603be330e43be8,0x31473be430b23bea,0x326f3bd631db3bdd,0x32263bda31793be2,0x337d3bc732d23bd1
.quad 0x33033bce323e3bd9,0x34443bb633c63bc3,0x33df3bc133033bce,0x34c93ba2345d3bb2,0x345d3bb233c63bc3,0x354c3b8c34d53ba0,0x34c93ba234443bb6,0x35ce3b74354c3b8c
.quad 0x35343b9134a53ba8,0x364e3b5a35c23b77,0x359f3b7d35053b99,0x36cc3b3e36373b5f,0x36083b6935643b88,0x37483b2036aa3b46,0x36703b5335c23b77,0x37c23aff371b3b2b
.quad 0x3c0000003c00,0x3c0000003c00,0x291b3bfe28b63bff,0x29e33bfe297f3bfe,0x2d1a3bf92cb53bfa,0x2de23bf72d7e3bf8,0x2fa43bf12f0e3bf4,0x30673bed301d3bef
.quad 0x31153be630b23bea,0x31db3bdd31793be2,0x32573bd731db3bdd,0x334c3bca32d23bd1,0x33963bc633033bce,0x345d3bb234143bbc,0x34693bb134143bbc,0x35113b9734bd3ba4
.quad 0x35053b9934a53ba8,0x35c23b7735643b88,0x359f3b7d35343b91,0x36703b5336083b69,0x36373b5f35c23b77,0x371b3b2b36aa3b46,0x36cc3b3e364e3b5a,0x37c23aff37483b20
.quad 0x375e3b1a36d73b3b,0x38323ad037e33af6,0x37ee3af3375e3b1a,0x38813a9c383d3ac9,0x383d3ac937e33af6,0x38ce3a6538873a99,0x38813a9c38323ad0,0x39183a2b38ce3a65
.quad 0x3c0000003c00,0x3c0000003c00,0x2aac3bfd2a483bfe,0x2b753bfd2b113bfd,0x2eaa3bf52e463bf6,0x2f723bf22f0e3bf4,0x30fd3be730b23bea,0x31913be131473be4
.quad 0x32a13bd4323e3bd9,0x33653bc933033bce,0x34203bbb33c63bc3,0x34993baa345d3bb2,0x34ed3b9d34a53ba8,0x357c3b8435343b91,0x35b63b7935643b88,0x36593b5836083b69
.quad 0x367c3b50361f3b64,0x37323b2536d73b3b,0x373d3b2236d73b3b,0x38023aed37a13b08,0x37f93af0378b3b0e,0x38673aae38323ad0,0x38583ab8381d3add,0x38c93a6938913a92
.quad 0x38b03a7c38723aa7,0x39273a1f38ec3a4f,0x39053a3b38c43a6d,0x398039d039433a07,0x395639f639133a2f,0x39d4397b399639ba,0x39a439ad395f39ed,0x3a23392239e53969
.quad 0x3c0000003c00,0x3c0000003c00,0x2c1f3bfc2bd93bfc,0x2c833bfb2c513bfb,0x301d3bef2fd63bf1,0x30803bec304e3bed,0x32263bda31db3bdd,0x32b93bd2326f3bd6
.quad 0x34143bbc33c63bc3,0x34753baf34443bb6,0x35113b9734d53ba0,0x35873b82354c3b8c,0x36083b6935c23b77,0x36933b4b364e3b5a,0x36f93b3336aa3b46,0x37963b0b37483b20
.quad 0x37e33af6378b3b0e,0x38483ac2381d3add,0x38623ab138323ad0,0x38bf3a7138913a92,0x38ce3a65389b3a8a,0x39303a1739003a3f,0x39353a1339003a3f,0x399b39b5396939e5
.quad 0x399639ba395f39ed,0x39fe394d39cb3984,0x39f2395b39ba3996,0x3a5a38dd3a27391d,0x3a4738f63a0f393a,0x3aae38673a7c38b0,0x3a95388c3a5e38d8,0x3af937d83ac9383d
.quad 0x3c0000003c00,0x3c0000003c00,0x2ce73bfa2cb53bfa,0x2d4c3bf92d1a3bf9,0x30e43be830b23bea,0x31473be431153be6,0x334c3bca33033bce,0x33df3bc133963bc6
.quad 0x34d53ba034a53ba8,0x35343b9135053b99,0x35fd3b6b35c23b77,0x36703b5336373b5f,0x371b3b2b36d73b3b,0x37a13b08375e3b1a,0x38173ae037e33af6,0x38623ab1383d3ac9
.quad 0x389b3a8a38723aa7,0x38ec3a4f38c43a6d,0x39183a2b38ec3a4f,0x396d39e139433a07,0x398d39c3395f39ed,0x39e5396939ba3996,0x39fa395139cb3984,0x3a5238e73a27391d
.quad 0x3a5e38d83a2f3913,0x3ab5385d3a8a389b,0x3ab838583a8a389b,0x3b0b37963ae33812,0x3b0837a13add381d,0x3b5536653b303705,0x3b4e36873b253732,0x3b9335293b7235da
.quad 0x3c0000003c00,0x3c0000003c00,0x2db03bf82d7e3bf8,0x2e143bf72de23bf7,0x31aa3be031793be2,0x320d3bdb31db3bdd,0x34383bb734143bbc,0x34813bad345d3bb2
.quad 0x35933b8035643b88,0x35f13b6e35c23b77,0x36e33b3936aa3b46,0x37533b1d371b3b2b,0x38123ae337e33af6,0x38523abc38323ad0,0x38ab3a7f38873a99,0x38f13a4b38ce3a65
.quad 0x393a3a0f39133a2f,0x398439cb395f39ed,0x39be3992399639ba,0x3a0b393e39e53969,0x3a3739093a0f393a,0x3a8338a63a5e38d8,0x3aa338773a7c38b0,0x3aed38023ac9383d
.quad 0x3b0237b73add381d,0x3b4636aa3b253732,0x3b5336703b303705,0x3b8f35403b7235da,0x3b95351d3b7735c2,0x3bc633963baf3475,0x3bc7337d3baf3475,0x3beb30993bdb320d
.quad 0x2a483bfe00003c00,0x30b23bea2e463bf6,0x2aac3bfd00003c00,0x30fd3be72eaa3bf5,0x2b113bfd00003c00,0x31473be42f0e3bf4,0x2b753bfd00003c00,0x31913be12f723bf2
.quad 0x2bd93bfc00003c00,0x31db3bdd2fd63bf1,0x2c1f3bfc00003c00,0x32263bda301d3bef,0x2c513bfb00003c00,0x326f3bd6304e3bed,0x2c833bfb00003c00,0x32b93bd230803bec
.quad 0x2cb53bfa00003c00,0x33033bce30b23bea,0x2ce73bfa00003c00,0x334c3bca30e43be8,0x2d1a3bf900003c00,0x33963bc631153be6,0x2d4c3bf900003c00,0x33df3bc131473be4
.quad 0x2d7e3bf800003c00,0x34143bbc31793be2,0x2db03bf800003c00,0x34383bb731aa3be0,0x2de23bf700003c00,0x345d3bb231db3bdd,0x2e143bf700003c00,0x34813bad320d3bdb
.quad 0x33c63bc3323e3bd9,0x35643b8834a53ba8,0x34203bbb32a13bd4,0x35b63b7934ed3b9d,0x345d3bb233033bce,0x36083b6935343b91,0x34993baa33653bc9,0x36593b58357c3b84
.quad 0x34d53ba033c63bc3,0x36aa3b4635c23b77,0x35113b9734143bbc,0x36f93b3336083b69,0x354c3b8c34443bb6,0x37483b20364e3b5a,0x35873b8234753baf,0x37963b0b36933b4b
.quad 0x35c23b7734a53ba8,0x37e33af636d73b3b,0x35fd3b6b34d53ba0,0x38173ae0371b3b2b,0x36373b5f35053b99,0x383d3ac9375e3b1a,0x36703b5335343b91,0x38623ab137a13b08
.quad 0x36aa3b4635643b88,0x38873a9937e33af6,0x36e33b3935933b80,0x38ab3a7f38123ae3,0x371b3b2b35c23b77,0x38ce3a6538323ad0,0x37533b1d35f13b6e,0x38f13a4b38523abc
.quad 0x36d73b3b361f3b64,0x381d3add378b3b0e,0x373d3b22367c3b50,0x38583ab837f93af0,0x37a13b0836d73b3b,0x38913a9238323ad0,0x38023aed37323b25,0x38c93a6938673aae
.quad 0x38323ad0378b3b0e,0x39003a3f389b3a8a,0x38623ab137e33af6,0x39353a1338ce3a65,0x38913a92381d3add,0x396939e539003a3f,0x38bf3a7138483ac2,0x399b39b539303a17
.quad 0x38ec3a4f38723aa7,0x39cb3984395f39ed,0x39183a2b389b3a8a,0x39fa3951398d39c3,0x39433a0738c43a6d,0x3a27391d39ba3996,0x396d39e138ec3a4f,0x3a5238e739e53969
.quad 0x399639ba39133a2f,0x3a7c38b03a0f393a,0x39be3992393a3a0f,0x3aa338773a373909,0x39e53969395f39ed,0x3ac9383d3a5e38d8,0x3a0b393e398439cb,0x3aed38023a8338a6
.quad 0x38c43a6d38723aa7,0x395f39ed39133a2f,0x39053a3b38b03a7c,0x39a439ad395639f6,0x39433a0738ec3a4f,0x39e53969399639ba,0x398039d039273a1f,0x3a23392239d4397b
.quad 0x39ba3996395f39ed,0x3a5e38d83a0f393a,0x39f2395b399639ba,0x3a95388c3a4738f6,0x3a27391d39cb3984,0x3ac9383d3a7c38b0,0x3a5a38dd39fe394d,0x3af937d83aae3867
.quad 0x3a8a389b3a2f3913,0x3b2537323add381d,0x3ab838583a5e38d8,0x3b4e36873b0837a1,0x3ae338123a8a389b,0x3b7235da3b303705,0x3b0b37963ab5385d,0x3b9335293b553665
.quad 0x3b3037053add381d,0x3baf34753b7735c2,0x3b5336703b0237b7,0x3bc7337d3b95351d,0x3b7235da3b253732,0x3bdb320d3baf3475,0x3b8f35403b4636aa,0x3beb30993bc63396
.quad 0x39ed395f39a839a8,0x3a6d38c43a2f3913,0x3a33390e39ed395f,0x3ab138623a7438ba,0x3a7438ba3a2f3913,0x3af037f93ab5385d,0x3ab138623a6d38c4,0x3b2837263af037f9
.quad 0x3ae938073aa73872,0x3b5a364e3b253732,0x3b1d37533add381d,0x3b8635703b553665,0x3b4b36933b0e378b,0x3bab348d3b803593,0x3b7435ce3b3b36d7,0x3bca334c3ba434bd
.quad 0x3b9935053b64361f,0x3be231793bc333c6,0x3bb734383b883564,0x3bf32f403bdb320d,0x3bd132d23ba834a5,0x3bfd2b113bed304e,0x3be5312e3bc333c6,0x3c009a483bf92d1a
.quad 0x3bf42f0e3bd9323e,0x3bfcabd93bff2648,0x3bfd2b753bea30b2,0x3bf1afa43bffa7da,0x3c001e483bf62e46,0x3be0b1aa3bf8ad7e,0x3bfea9e33bfe2a48,0x3bc7b37d3becb080
.quad 0x3add381d3aa73872,0x3b3b36d73b0e378b,0x3b1d37533ae93807,0x3b7435ce3b4b3693,0x3b5536653b253732,0x3ba434bd3b803593,0x3b8635703b5a364e,0x3bca334c3bab348d
.quad 0x3baf34753b883564,0x3be631153bce3303,0x3bd032ea3baf3475,0x3bf82db03be830e4,0x3be830e43bce3303,0x3c0024b63bf82d7e,0x3bf82db03be63115,0x3bfdaaac3c0024b6
.quad 0x3bff26483bf62e46,0x3bf1afd63bfeaa48,0x3bfea91b3bff28b6,0x3bdab2263bf2af72,0x3bf5aeaa3bffa648,0x3bb9b42c3bddb1db,0x3be3b1603bf8ad7e,0x3b8fb5403bc0b3f7
.quad 0x3bc9b3653beab0b2,0x3b5ab64e3b99b505,0x3ba6b4b13bd4b2a1,0x3b1db7533b69b608,0x3b7bb5ab3bb6b444,0x3ad6b8283b30b705,0x3b49b69e3b91b534,0x3a87b8a03af0b7f9
.quad 0x3b8835643b64361f,0x3bc333c63ba834a5,0x3bb734383b993505,0x3be5312e3bd132d2,0x3bdb320d3bc333c6,0x3bf92d1a3bed304e,0x3bf32f403be23179,0x3c009a483bfd2b11
.quad 0x3bff28b63bf62e46,0x3bf8ad7e3bffa648,0x3bfea91b3bff2648,0x3be3b1603bf5aeaa,0x3bf2af723bfeaa48,0x3bc0b3f73bddb1db,0x3bdab2263bf1afd6,0x3b8fb5403bb9b42c
.quad 0x3bb6b4443bd9b23e,0x3b50b67c3b88b564,0x3b86b5703bb6b444,0x3b05b7ac3b4bb693,0x3b4bb6933b88b564,0x3aaeb8673b02b7b7,0x3b05b7ac3b50b67c,0x3a4bb8f13aaeb867
.quad 0x3ab5b85d3b0eb78b,0x39dcb9723a4fb8ec,0x3a5ab8dd3ac2b848,0x3964b9e939e5b969,0x39f6b9563a6db8c4,0x38e2ba563972b9dc,0x3989b9c73a0fb93a,0x3858bab838f6ba47
.quad 0x3bea30b23bd9323e,0x3bfe2a483bf62e46,0x3bfd2b753bf42f0e,0x3bfea9e33c001e48,0x3bffa7da3bff2648,0x3becb0803bf8ad7e,0x3bf1afa43bfcabd9,0x3bc7b37d3be0b1aa
.quad 0x3bd4b2a13beab0b2,0x3b91b5343bb6b444,0x3ba6b4b13bc9b365,0x3b49b69e3b7bb5ab,0x3b69b6083b99b505,0x3af0b7f93b30b705,0x3b1db7533b5ab64e,0x3a87b8a03ad6b828
.quad 0x3ac2b8483b0eb78b,0x3a0fb93a3a6db8c4,0x3a5ab8dd3ab5b85d,0x3989b9c739f6b956,0x39e5b9693a4fb8ec,0x38f6ba473972b9dc,0x3964b9e939dcb972,0x3858bab838e2ba56
.quad 0x38d8ba5e395fb9ed,0x375ebb1a3848bac2,0x3842bac638d8ba5e,0x35fdbb6b3748bb20,0x3748bb203848bac2,0x348dbbab35f1bb6e,0x35fdbb6b375ebb1a,0x3226bbda348dbbab
.quad 0x2e463bf600003c00,0x34a53ba8323e3bd9,0x2e783bf600003c00,0x34c93ba2326f3bd6,0x2eaa3bf500003c00,0x34ed3b9d32a13bd4,0x2edc3bf400003c00,0x35113b9732d23bd1
.quad 0x2f0e3bf400003c00,0x35343b9133033bce,0x2f403bf300003c00,0x35583b8a33343bcb,0x2f723bf200003c00,0x357c3b8433653bc9,0x2fa43bf100003c00,0x359f3b7d33963bc6
.quad 0x2fd63bf100003c00,0x35c23b7733c63bc3,0x30043bf000003c00,0x35e53b7033f73bc0,0x301d3bef00003c00,0x36083b6934143bbc,0x30363bee00003c00,0x362b3b62342c3bb9
.quad 0x304e3bed00003c00,0x364e3b5a34443bb6,0x30673bed00003c00,0x36703b53345d3bb2,0x30803bec00003c00,0x36933b4b34753baf,0x30993beb00003c00,0x36b53b43348d3bab
.quad 0x378b3b0e361f3b64,0x39133a2f38723aa7,0x37c23aff364e3b5a,0x39353a1338913a92,0x37f93af0367c3b50,0x395639f638b03a7c,0x38173ae036aa3b46,0x397639d838ce3a65
.quad 0x38323ad036d73b3b,0x399639ba38ec3a4f,0x384d3abf37053b30,0x39b5399b39093a37,0x38673aae37323b25,0x39d4397b39273a1f,0x38813a9c375e3b1a,0x39f2395b39433a07
.quad 0x389b3a8a378b3b0e,0x3a0f393a395f39ed,0x38b53a7837b73b02,0x3a2b3918397b39d4,0x38ce3a6537e33af6,0x3a4738f6399639ba,0x38e73a5238073ae9,0x3a6238d339b1399f
.quad 0x39003a3f381d3add,0x3a7c38b039cb3984,0x39183a2b38323ad0,0x3a95388c39e53969,0x39303a1738483ac2,0x3aae386739fe394d,0x39483a02385d3ab5,0x3ac638423a173930
.quad 0x3a2f391339a839a8,0x3b0e378b3aa73872,0x3a5238e739cb3984,0x3b2e37103ac9383d,0x3a7438ba39ed395f,0x3b4b36933ae93807,0x3a95388c3a0f393a,0x3b6736143b0837a1
.quad 0x3ab5385d3a2f3913,0x3b8035933b253732,0x3ad3382d3a4f38ec,0x3b9735113b4136c1,0x3af037f93a6d38c4,0x3bab348d3b5a364e,0x3b0b37963a8a389b,0x3bbe34083b7235da
.quad 0x3b2537323aa73872,0x3bce33033b883564,0x3b3e36cc3ac23848,0x3bdc31f43b9d34ed,0x3b5536653add381d,0x3be830e43baf3475,0x3b6b35fd3af637e3,0x3bf12fa43bc033f7
.quad 0x3b8035933b0e378b,0x3bf82d7e3bce3303,0x3b9335293b253732,0x3bfd2aac3bdb320d,0x3ba434bd3b3b36d7,0x3c0024b63be63115,0x3bb434513b50367c,0x3c00a3db3bef301d
.quad 0x3ba834a53b64361f,0x3bf62e463bd9323e,0x3bbe34083b803593,0x3bfd2aac3be830e4,0x3bd132d23b993505,0x3c001e483bf42f0e,0x3be131913baf3475,0x3bfea91b3bfb2c51
.quad 0x3bed304e3bc333c6,0x3bf8ad7e3bff2648,0x3bf72e143bd432a1,0x3beeb0363c00a4b6,0x3bfd2b113be23179,0x3be0b1aa3bfcabd9,0x3c0023db3bed304e,0x3bcdb31b3bf5aeaa
.quad 0x3bffa6483bf62e46,0x3bb6b4443beab0b2,0x3bfcac1f3bfc2bd9,0x3b9bb4f93bdbb20d,0x3bf5aeaa3bff2648,0x3b7bb5ab3bc9b365,0x3bebb0993c00a248,0x3b58b6593bb2b45d
.quad 0x3bddb1db3bfeaa48,0x3b30b7053b99b505,0x3bcdb31b3bf8ad7e,0x3b05b7ac3b7bb5ab,0x3bb9b42c3bf1afd6,0x3ad6b8283b5ab64e,0x3ba2b4c93be6b115,0x3aa3b8773b36b6ee
.quad 0x3bf6ae463c000000,0x3ba8b4a53bd9b23e,0x3be9b0cb3bfeaa48,0x3b82b5873bc0b3f7,0x3bd6b26f3bf6ae46,0x3b55b6653ba0b4d5,0x3bbeb4083beab0b2,0x3b22b73d3b7bb5ab
.quad 0x3ba0b4d53bd9b23e,0x3ae9b8073b50b67c,0x3b7db59f3bc3b3c6,0x3aaab86d3b20b748,0x3b55b6653ba8b4a5,0x3a65b8ce3ae9b807,0x3b28b7263b88b564,0x3a1bb92b3aaeb867
.quad 0x3af6b7e33b64b61f,0x39cbb9843a6db8c4,0x3abfb84d3b3bb6d7,0x3976b9d83a27b91d,0x3a83b8a63b0eb78b,0x391dba2739dcb972,0x3a43b8fb3addb81d,0x38bfba71398db9c3
.quad 0x39feb94d3aa7b872,0x385dbab5393aba0f,0x39b5b99b3a6db8c4,0x37eebaf338e2ba56,0x3969b9e53a2fb913,0x371bbb2b3887ba99,0x3918ba2b39edb95f,0x3642bb5d3828bad6
.quad 0x3b0eb78b3b64b61f,0x3a2fb9133aa7b872,0x3accb8383b30b705,0x39d0b9803a56b8e2,0x3a83b8a63af6b7e3,0x3969b9e539feb94d,0x3a33b90e3ab5b85d,0x38fbba43399fb9b1
.quad 0x39dcb9723a6db8c4,0x3887ba99393aba0f,0x3980b9d03a1fb927,0x380dbae638ceba65,0x391dba2739cbb984,0x371bbb2b385dbab5,0x38b5ba783972b9dc,0x3614bb6737cdbafc
.quad 0x3848bac23913ba2f,0x3505bb9936d7bb3b,0x37acbb0538b0ba7c,0x33dfbbc135dabb72,0x36c1bb413848bac2,0x31aabbe034d5bba0,0x35cebb7437b7bb02,0x2edcbbf43396bbc6
.quad 0x34d5bba036d7bb3b,0x28b6bbff3179bbe2,0x33aebbc435f1bb6e,0xa852bbff2eaabbf5,0x31aabbe03505bb99,0xaeaabbf528b6bbff,0x2f40bbf33414bbbc,0xb191bbe1a7dabbff
.quad 0x3913ba2f39a8b9a8,0x378bbb0e3872baa7,0x3896ba8e393aba0f,0x3659bb5837cdbafc,0x3812bae338c4ba6d,0x351dbb9536aabb46,0x3710bb2e3848bac2,0x33aebbc4357cbb84
.quad 0x35f1bb6e378bbb0e,0x3115bbe63444bbb6,0x34c9bba2367cbb50,0x2ce7bbfa320dbbdb,0x3334bbcb3564bb88,0x9e48bc002f0ebbf4,0x30cbbbe93444bbb6,0xadb0bbf827dabbff
.quad 0x2cb5bbfa323ebbd9,0xb179bbe2aa48bbfe,0x9a48bc002fd6bbf1,0xb408bbbeb01dbbef,0xad1abbf92a48bbfe,0xb54cbb8cb2a1bbd4,0xb0fdbbe7a648bbff,0xb687bb4eb48dbbab
.quad 0xb365bbc9ae46bbf6,0xb7b7bb02b5c2bb77,0xb4e1bb9eb179bbe2,0xb86dbaaab6eebb36,0xb608bb69b3c6bbc3,0xb8f6ba47b807bae9,0xb726bb28b505bb99,0xb976b9d8b891ba92
.quad 0x34a5bba8361fbb64,0x2e46bbf6323ebbd9,0x3288bbd534d5bba0,0x1a48bc002eaabbf5,0x2f72bbf23303bbce,0xade2bbf72248bc00,0x2711bbff304ebbed,0xb1f4bbdcad1abbf9
.quad 0xabd9bbfc2a48bbfe,0xb475bbafb179bbe2,0xb0cbbbe9a8b6bbff,0xb5e5bb70b42cbbb9,0xb396bbc6afd6bbf1,0xb748bb20b593bb80,0xb529bb93b2a1bbd4,0xb84dbabfb6eebb36
.quad 0xb67cbb50b4a5bba8,0xb8ecba4fb81dbadd,0xb7c2baffb5f1bb6e,0xb980b9d0b8baba74,0xb87cbaa0b732bb25,0xba07b943b94db9fe,0xb90eba33b832bad0,0xba7fb8abb9d4b97b
.quad 0xb996b9bab8c4ba6d,0xbae9b807ba4fb8ec,0xba13b935b94db9fe,0xbb43b6b5babcb852,0xba83b8a6b9cbb984,0xbb8cb54cbb1ab75e,0xbae6b80dba3fb900,0xbbc4b3aebb69b608
.quad 0x30b23bea00003c00,0x36d73b3b34a53ba8,0x30cb3be900003c00,0x36f93b3334bd3ba4,0x30e43be800003c00,0x371b3b2b34d53ba0,0x30fd3be700003c00,0x373d3b2234ed3b9d
.quad 0x31153be600003c00,0x375e3b1a35053b99,0x312e3be500003c00,0x37803b11351d3b95,0x31473be400003c00,0x37a13b0835343b91,0x31603be300003c00,0x37c23aff354c3b8c
.quad 0x31793be200003c00,0x37e33af635643b88,0x31913be100003c00,0x38023aed357c3b84,0x31aa3be000003c00,0x38123ae335933b80,0x31c33bdf00003c00,0x38223ad935ab3b7b
.quad 0x31db3bdd00003c00,0x38323ad035c23b77,0x31f43bdc00003c00,0x38423ac635da3b72,0x320d3bdb00003c00,0x38523abc35f13b6e,0x32263bda00003c00,0x38623ab136083b69
.quad 0x395f39ed38723aa7,0x3add381d3a2f3913,0x397639d838873a99,0x3af337ee3a4738f6,0x398d39c3389b3a8a,0x3b0837a13a5e38d8,0x39a439ad38b03a7c,0x3b1d37533a7438ba
.quad 0x39ba399638c43a6d,0x3b3037053a8a389b,0x39d0398038d83a5e,0x3b4336b53aa0387c,0x39e5396938ec3a4f,0x3b5536653ab5385d,0x39fa395139003a3f,0x3b6736143ac9383d
.quad 0x3a0f393a39133a2f,0x3b7735c23add381d,0x3a23392239273a1f,0x3b8635703af037f9,0x3a373909393a3a0f,0x3b95351d3b0237b7,0x3a4b38f1394d39fe,0x3ba234c93b143775
.quad 0x3a5e38d8395f39ed,0x3baf34753b253732,0x3a7138bf397239dc,0x3bbb34203b3636ee,0x3a8338a6398439cb,0x3bc633963b4636aa,0x3a95388c399639ba,0x3bd032ea3b553665
.quad 0x3bc333c63b64361f,0x3bfeaa483bf62e46,0x3bd032ea3b7735c2,0x3bf9ad4c3bfb2c51,0x3bdb320d3b883564,0x3bf2af723bff28b6,0x3be5312e3b993505,0x3be9b0cb3c001e48
.quad 0x3bed304e3ba834a5,0x3bddb1db3bffa648,0x3bf42edc3bb63444,0x3bd0b2ea3bfdab11,0x3bf92d1a3bc333c6,0x3bc0b3f73bf8ad7e,0x3bfd2aac3bce3303,0x3badb4813bf2af72
.quad 0x3bff26483bd9323e,0x3b99b5053beab0b2,0x3c009a483be23179,0x3b82b5873be0b1aa,0x3bffa7da3bea30b2,0x3b69b6083bd4b2a1,0x3bfdab753bf12fd6,0x3b4eb6873bc6b396
.quad 0x3bf8ad7e3bf62e46,0x3b30b7053bb6b444,0x3bf3af403bfa2cb5,0x3b11b7803ba4b4bd,0x3becb0803bfe2a48,0x3af0b7f93b91b534,0x3be3b1603bff2648,0x3accb8383b7bb5ab
.quad 0x3b88b5643bd9b23e,0x3a6db8c43b0eb78b,0x3b6bb5fd3bc9b365,0x3a33b90e3ae3b812,0x3b4bb6933bb6b444,0x39f6b9563ab5b85d,0x3b28b7263ba0b4d5,0x39b5b99b3a83b8a6
.quad 0x3b02b7b73b88b564,0x3972b9dc3a4fb8ec,0x3ad9b8223b6eb5f1,0x392bba1b3a17b930,0x3aaeb8673b50b67c,0x38e2ba5639dcb972,0x3a7fb8ab3b30b705,0x3896ba8e399fb9b1
.quad 0x3a4fb8ec3b0eb78b,0x3848bac2395fb9ed,0x3a1bb92b3ae9b807,0x37eebaf3391dba27,0x39e5b9693ac2b848,0x3748bb2038d8ba5e,0x39adb9a43a99b887,0x369ebb493891ba92
.quad 0x3972b9dc3a6db8c4,0x35f1bb6e3848bac2,0x3935ba133a3fb900,0x3540bb8f37f9baf0,0x38f6ba473a0fb93a,0x348dbbab375ebb1a,0x38b5ba7839dcb972,0x33aebbc436c1bb41
.quad 0x38c4ba6d39a8b9a8,0x3564bb88378bbb0e,0x386dbaaa395fb9ed,0x3481bbad36c1bb41,0x3812bae33913ba2f,0x3334bbcb35f1bb6e,0x376abb1738c4ba6d,0x3160bbe3351dbb95
.quad 0x36aabb463872baa7,0x2f0ebbf43444bbb6,0x35e5bb70381dbadd,0x2aacbbfd32d2bbd1,0x351dbb95378bbb0e,0x9e48bc003115bbe6,0x3451bbb436d7bb3b,0xac1fbbfc2eaabbf5
.quad 0x3303bbce361fbb64,0xafd6bbf12a48bbfe,0x3160bbe33564bb88,0xb1c3bbdf9e48bc00,0x2f72bbf234a5bba8,0xb396bbc6abd9bbfc,0x2c1fbbfc33c6bbc3,0xb4b1bba6af72bbf2
.quad 0x2248bc00323ebbd9,0xb593bb80b179bbe2,0xa91bbbfe30b2bbea,0xb670bb53b334bbcb,0xade2bbf72e46bbf6,0xb748bb20b475bbaf,0xb099bbeb2a48bbfe,0xb80dbae6b54cbb8c
.quad 0x2a48bbfe323ebbd9,0xb3c6bbc3ae46bbf6,0xa3dbbc00304ebbed,0xb4f9bb9bb147bbe4,0xad1abbf92cb5bbfa,0xb608bb69b365bbc9,0xb099bbeb2248bc00,0xb710bb2eb4bdbba4
.quad 0xb2a1bbd4aa48bbfe,0xb807bae9b5c2bb77,0xb451bbb4af0ebbf4,0xb881ba9cb6c1bb41,0xb54cbb8cb179bbe2,0xb8f6ba47b7b7bb02,0xb642bb5db365bbc9,0xb964b9e9b852babc
.quad 0xb732bb25b4a5bba8,0xb9cbb984b8c4ba6d,0xb80dbae6b593bb80,0xba2bb918b930ba17,0xb87cbaa0b67cbb50,0xba83b8a6b996b9ba,0xb8e7ba52b75ebb1a,0xbad3b82db9f6b956
.quad 0xb94db9feb81dbadd,0xbb1ab75eba4fb8ec,0xb9adb9a4b887ba99,0xbb58b659baa0b87c,0xba07b943b8ecba4f,0xbb8cb54cbae9b807,0xba5ab8ddb94db9fe,0xbbb7b438bb2bb71b
.quad 0xb81dbaddb61fbb64,0xb9edb95fb913ba2f,0xb8a0ba87b732bb25,0xba5ab8ddb98db9c3,0xb91dba27b81dbadd,0xbabcb852b9feb94d,0xb992b9beb89bba8a,0xbb11b780ba65b8ce
.quad 0xb9feb94db913ba2f,0xbb5ab64ebac2b848,0xba62b8d3b984b9cb,0xbb97b511bb14b775,0xbabcb852b9edb95f,0xbbc6b396bb5ab64e,0xbb0bb796ba4fb8ec,0xbbe7b0fdbb95b51d
.quad 0xbb50b67cbaa7b872,0xbbfaacb5bbc3b3c6,0xbb8ab558baf6b7e3,0xbc0020b6bbe4b147,0xbbb9b42cbb3bb6d7,0xbbf72de2bbf8ad7e,0xbbdcb1f4bb77b5c2,0xbbe13191bc009e48
.quad 0xbbf4af0ebba8b4a5,0xbbbc3414bbfa2cb5,0xbbffa852bbceb303,0xbb8a3558bbe830e4,0xbbfe297fbbeab0b2,0xbb4b3693bbc93365,0xbbf12fa4bbfaacb5,0xbaff37c2bb9d34ed
.quad 0xbb3bb6d7baa7b872,0xbbeab0b2bba8b4a5,0xbb82b587bb02b7b7,0xbbfdaaacbbd6b26f,0xbbb9b42cbb50b67c,0xbbfe297fbbf4af0e,0xbbe1b191bb91b534,0xbbed3067bc00a4b6
.quad 0xbbf8ad7ebbc3b3c6,0xbbc93365bbfa2cb5,0xbc001a48bbe6b115,0xbb933529bbe43147,0xbbf72de2bbfaacb5,0xbb4b3693bbbc3414,0xbbdf31c3bc002248,0xbaf337eebb84357c
.quad 0xbbb63444bbf62e46,0xba8a389bbb3b36d7,0xbb7d359fbbdd31db,0xba133935bae33812,0xbb3636eebbb63444,0xb98d39c3ba7c38b0,0xbae03817bb803593,0xb8fb3a43ba073943
.quad 0xba7c38b0bb3b36d7,0xb85d3ab5b98439cb,0xba0b393ebae93807,0xb76a3b17b8f63a47,0xb98d39c3ba8a389b,0xb6083b69b85d3ab5,0xb9053a3bba1f3927,0xb4993baab7753b14
.quad 0x42000000,0x0,0x0,0x0,0x0,0x0,0x0,0x0
.quad 0x0,0x0,0x0,0x0,0x0,0x0,0x0,0x0
.quad 0x0,0x0,0x0,0x0,0x0,0x0,0x0,0x0
.quad 0x0,0x0,0x0,0x0,0x0,0x0,0x0,0x0
.quad 0x0,0x0,0x0,0x0,0x0,0x0,0x0,0x0
.quad 0x0,0x0,0x0,0x0,0x0,0x0,0x0,0x0
.quad 0x0,0x0,0x0,0x0,0x0,0x0,0x0,0x0
.quad 0x0,0x0,0x0,0x0,0x0,0x0,0x0,0x0
.quad 0x0,0x0,0x0,0x0,0x0,0x0,0x0,0x0
.quad 0x0,0x0,0x0,0x0,0x0,0x0,0x0,0x0
.quad 0x0,0x0,0x0,0x0,0x0,0x0,0x0,0x0
.quad 0x0,0x0,0x0,0x0,0x0,0x0,0x0,0x0
.quad 0x0,0x0,0x0,0x0,0x0,0x0,0x0,0x0
.quad 0x0,0x0,0x0,0x0,0x0,0x0,0x0,0x0
.quad 0x0,0x0,0x0,0x0,0x0,0x0,0x0,0x0
.quad 0x0,0x0,0x0,0x0,0x0,0x0,0x0,0x0
.quad 0x0,0x0,0x0,0x0,0x0,0x0,0x0,0x0
.quad 0x0,0x0,0x0,0x0,0x0,0x0,0x0,0x0
.quad 0x0,0x0,0x0,0x0,0x0,0x0,0x0,0x0
.quad 0x0,0x0,0x0,0x0,0x0,0x0,0x0,0x0
.quad 0x0,0x0,0x0,0x0,0x0,0x0,0x0,0x0
.quad 0x0,0x0,0x0,0x0,0x0,0x0,0x0,0x0
.quad 0x0,0x0,0x0,0x0,0x0,0x0,0x0,0x0
.quad 0x0,0x0,0x0,0x0,0x0,0x0,0x0,0x0
.quad 0x0,0x0,0x0,0x0,0x0,0x0,0x0,0x0
.quad 0x0,0x0,0x0,0x0,0x0,0x0,0x0,0x0
.quad 0x0,0x0,0x0,0x0,0x0,0x0,0x0,0x0
.quad 0x0,0x0,0x0,0x0,0x0,0x0,0x0,0x0
.quad 0x0,0x0,0x0,0x0,0x0,0x0,0x0,0x0
.quad 0x0,0x0,0x0,0x0,0x0,0x0,0x0,0x0
.quad 0x0,0x0,0x0,0x0,0x0,0x0,0x0,0x0
.quad 0x0,0x0,0x0,0x0,0x0,0x0,0x0,0x0
.section .rodata,"a"
.p2align 6
.amdhsa_kernel recurrent_scan__spectral_gfnet__glu_gated_reglu__prompt_kernel
  .amdhsa_next_free_vgpr 256
  .amdhsa_next_free_sgpr 102
  .amdhsa_accum_offset 256
  .amdhsa_group_segment_fixed_size 0
  .amdhsa_kernarg_size 80
  .amdhsa_user_sgpr_count 2
  .amdhsa_user_sgpr_kernarg_segment_ptr 1
  .amdhsa_system_sgpr_workgroup_id_x 1
.end_amdhsa_kernel
```
